```python
import torch

def _softmax(x, axis=-1):
    return torch.softmax(x, dim=axis)
def _gelu(x):
    return torch.nn.functional.gelu(x, approximate="tanh")
def _silu(x):
    return torch.nn.functional.silu(x)
def _sigmoid(x):
    return torch.sigmoid(x)
def _layernorm(x, axis=-1, eps=1e-5):
    m = x.mean(dim=axis, keepdim=True)
    v = x.var(dim=axis, keepdim=True, unbiased=False)
    return (x - m) / torch.sqrt(v + eps)
def _scatter_add(tgt, idx, src, axis=0):
    return tgt.clone().index_add_(axis, idx, src)
def _segment_sum(src, seg, n):
    out = torch.zeros((n,) + src.shape[1:], dtype=src.dtype)
    return out.index_add_(0, seg, src)
def _pad(x, pw):
    flat = tuple(v for pair in reversed(pw) for v in pair)
    return torch.nn.functional.pad(x, flat)

kernel_name = 'sequential_preLN__softmax_full_mha__glu_gated_swiglu__prompt'

def setup_inputs():

    _w = (lambda a: (lambda t: t.to(torch.bfloat16) if t.is_floating_point() else t)(torch.as_tensor(a)))
    def _A_setup():
        B, S, D = 1, 2048, 640
        return {
            "x": _w((lambda *s: torch.randn(*s, dtype=torch.bfloat16) * 0.05)(B, S, D)),
            "wqkv": _w((lambda *s: torch.randn(*s, dtype=torch.bfloat16) * 0.05)(D, 3 * D)),
            "wo": _w((lambda *s: torch.randn(*s, dtype=torch.bfloat16) * 0.05)(D, D)),
        }
    _A_in = _A_setup()

    def _B_setup():
        B, S, D, F = 1, 2048, 640, 1728
        return {
            "x": _w((lambda *s: torch.randn(*s, dtype=torch.bfloat16) * 0.05)(B, S, D)),
            "w1": _w((lambda *s: torch.randn(*s, dtype=torch.bfloat16) * 0.4)(D, F) * (2.0 / D) ** 0.5),
            "w3": _w((lambda *s: torch.randn(*s, dtype=torch.bfloat16) * 0.4)(D, F) * (2.0 / D) ** 0.5),
            "w2": _w((lambda *s: torch.randn(*s, dtype=torch.bfloat16) * 0.4)(F, D) * (2.0 / F) ** 0.5),
        }
    _B_in = _B_setup()

    return {
        "A_x": _A_in["x"],
        "A_wqkv": _A_in["wqkv"],
        "A_wo": _A_in["wo"],
        "B_x": _B_in["x"],
        "B_w1": _B_in["w1"],
        "B_w3": _B_in["w3"],
        "B_w2": _B_in["w2"],
    }

def reference(A_x, A_wqkv, A_wo, B_x, B_w1, B_w3, B_w2):
    def _A_ref(x, wqkv, wo):
        B, S, D = x.shape
        H = 32; Dh = D // H
        qkv = (lambda x, *d: x.permute(*d))((x @ wqkv).reshape(B, S, 3, H, Dh), 2, 0, 3, 1, 4)
        q, k, v = qkv[0], qkv[1], qkv[2]
        scale = Dh ** -0.5
        scores = torch.einsum("bhqd,bhkd->bhqk", q, k) * scale
        p = _softmax(scores, axis=-1)
        o = torch.einsum("bhqk,bhkd->bhqd", p, v)
        return (lambda x, *d: x.permute(*d))(o, 0, 2, 1, 3).reshape(B, S, D) @ wo

    def _B_ref(x, w1, w3, w2):
        gate = torch.einsum("bsd,df->bsf", x, w1)
        up = torch.einsum("bsd,df->bsf", x, w3)
        h = _silu(gate) * up
        out = torch.einsum("bsf,fd->bsd", h, w2)
        return out

    x = A_x
    h = x + _A_ref(_layernorm(x, axis=-1), A_wqkv, A_wo)
    h2 = h + _B_ref(_layernorm(h, axis=-1), B_w1, B_w3, B_w2)
    return h2
```

```asm
; @launch kernel=sequential_preLN__softmax_full_mha__glu_gated_swiglu__prompt_kernel grid=(256,1,1) block=(512,1,1) lds=149504
.amdgcn_target "amdgcn-amd-amdhsa--gfx950"
.text
.globl sequential_preLN__softmax_full_mha__glu_gated_swiglu__prompt_kernel
.p2align 8
.type sequential_preLN__softmax_full_mha__glu_gated_swiglu__prompt_kernel,@function
sequential_preLN__softmax_full_mha__glu_gated_swiglu__prompt_kernel:
  s_cmp_ge_u32 s2, 256
  s_cbranch_scc1 mega_END
  s_load_dwordx4 s[4:7], s[0:1], 0
  s_load_dwordx2 s[24:25], s[0:1], 72
  s_and_b32 s32, s2, 7
  s_lshr_b32 s33, s2, 3
  s_lshr_b32 s34, s32, 2
  s_lshl_b32 s34, s34, 3
  s_and_b32 s35, s33, 7
  s_add_u32 s20, s34, s35
  s_and_b32 s34, s32, 3
  s_lshl_b32 s34, s34, 2
  s_lshr_b32 s35, s33, 3
  s_add_u32 s21, s34, s35
  s_load_dwordx2 s[26:27], s[0:1], 64
  v_lshrrev_b32 v136, 6, v0
  v_and_b32 v1, 63, v0
  v_readfirstlane_b32 s22, v136
  v_and_b32 v2, 31, v1
  v_lshrrev_b32 v3, 5, v1
  s_lshr_b32 s23, s22, 2
  s_and_b32 s28, s22, 3
  s_lshl_b32 s29, s22, 11
  s_cmp_eq_u32 s22, 7
  s_cbranch_scc0 p1_kernel_ct_1
  s_getpc_b64 s[50:51]
p1_kernel_pc_2:
  s_add_u32 s50, s50, p2_kernel-p1_kernel_pc_2
  s_addc_u32 s51, s51, 0
  s_lshr_b32 s52, s2, 3
  s_lshl_b32 s52, s52, 13
  s_cmp_ge_u32 s52, p5_kernel_CODE_END-p2_kernel
  s_cbranch_scc1 p1_kernel_ct_1
  v_lshl_add_u32 v200, v1, 7, s52
  v_min_u32 v200, p5_kernel_CODE_END-p2_kernel-4, v200
  global_load_dword v200, v200, s[50:51]
p1_kernel_ct_1:
  s_lshl_b32 s32, s20, 7
  s_lshl_b32 s33, s22, 4
  s_add_u32 s32, s32, s33
  v_lshrrev_b32 v136, 3, v1
  v_add_u32 v136, s32, v136
  v_mul_u32_u24 v136, 1280, v136
  v_and_b32 v137, 7, v1
  v_lshrrev_b32 v138, 4, v1
  v_xor_b32 v137, v137, v138
  v_lshl_add_u32 v4, v137, 4, v136
  v_xor_b32 v137, 4, v137
  v_lshl_add_u32 v5, v137, 4, v136
  v_add_u32 v5, 10240, v5
  s_lshl_b32 s33, s22, 3
  v_add_u32 v136, s33, v138
  v_mul_u32_u24 v136, 3840, v136
  s_lshl_b32 s34, s21, 8
  v_add_u32 v136, s34, v136
  v_bfe_u32 v137, v1, 2, 2
  v_xor_b32 v137, v137, v138
  v_lshl_add_u32 v136, v137, 6, v136
  v_and_b32 v137, 3, v1
  v_lshl_add_u32 v6, v137, 4, v136
  v_add_u32 v7, 15360, v6
  s_waitcnt lgkmcnt(0)
  s_mov_b32 s8, s4
  s_and_b32 s9, s5, 0xffff
  s_mov_b32 s10, 0x280000
  s_mov_b32 s11, 0x20000
  s_mov_b32 s12, s6
  s_and_b32 s13, s7, 0xffff
  s_mov_b32 s14, 0x258000
  s_mov_b32 s15, 0x20000
  s_mov_b32 s16, s24
  s_and_b32 s17, s25, 0xffff
  s_mov_b32 s18, 0x1c00000
  s_mov_b32 s19, 0x20000
  s_mov_b32 s40, s26
  s_and_b32 s41, s27, 0xffff
  s_mov_b32 s42, 0x100
  s_mov_b32 s43, 0x20000
  s_mov_b32 s88, s26
  s_and_b32 s89, s27, 0xffff
  s_mov_b32 s90, 0x100
  s_mov_b32 s91, 0x20000
  s_mov_b32 s101, 0
  s_mov_b32 s95, 0
  s_cmp_ge_u32 s21, 15
  s_cbranch_scc1 p1_kernel_idle
  s_cmp_eq_u32 s2, 0
  s_cbranch_scc0 p1_kernel_t0_3
  s_cmp_eq_u32 s22, 2
  s_cbranch_scc0 p1_kernel_t0_3
  v_mov_b32 v142, 0x1be8000
  buffer_load_dword v143, v142, s[16:19], 0 offen sc1
  s_waitcnt vmcnt(0)
  v_add_u32 v143, 1, v143
  v_max_u32 v143, 1, v143
  s_mov_b64 exec, 1
  buffer_store_dword v143, v142, s[16:19], 0 offen sc1
  v_mov_b32 v142, 0
  buffer_store_dword v143, v142, s[40:43], 0 offen sc1
  s_mov_b64 exec, -1
  s_nop 1
p1_kernel_t0_3:
  s_lshr_b32 s32, s2, 3
  s_and_b32 s33, s32, 7
  s_lshr_b32 s32, s32, 3
  s_add_u32 s32, s32, s33
  s_mul_i32 s33, s32, 52
  s_lshr_b32 s33, s33, 8
  s_mul_i32 s33, s33, 5
  s_sub_u32 s39, s32, s33
  s_mov_b32 s38, 0
  s_lshl_b32 s30, s38, 7
  s_add_u32 m0, s29, 0
  s_mul_i32 s31, s38, 245760
  buffer_load_dwordx4 v4, s[8:11], s30 offen lds
  s_add_u32 m0, s29, 1024
  s_nop 0
  buffer_load_dwordx4 v5, s[8:11], s30 offen lds
  s_add_u32 m0, s29, 16384
  s_nop 0
  buffer_load_dwordx4 v6, s[12:15], s31 offen lds
  s_add_u32 m0, s29, 17408
  s_nop 0
  buffer_load_dwordx4 v7, s[12:15], s31 offen lds
  s_mov_b32 s38, 1
  s_lshl_b32 s30, s38, 7
  s_add_u32 m0, s29, 32768
  s_mul_i32 s31, s38, 245760
  buffer_load_dwordx4 v4, s[8:11], s30 offen lds
  s_add_u32 m0, s29, 33792
  s_nop 0
  buffer_load_dwordx4 v5, s[8:11], s30 offen lds
  s_add_u32 m0, s29, 49152
  s_nop 0
  buffer_load_dwordx4 v6, s[12:15], s31 offen lds
  s_add_u32 m0, s29, 50176
  s_nop 0
  buffer_load_dwordx4 v7, s[12:15], s31 offen lds
  v_mov_b32 v44, 0x3f803f80
  v_mov_b32 v45, 0x3f803f80
  v_mov_b32 v46, 0x3f803f80
  v_mov_b32 v47, 0x3f803f80
  s_lshl_b32 s32, s23, 6
  v_add_u32 v136, s32, v2
  v_lshlrev_b32 v136, 7, v136
  v_bfe_u32 v137, v2, 1, 3
  v_xor_b32 v137, v137, v3
  v_xor_b32 v138, 0, v137
  v_lshl_add_u32 v8, v138, 4, v136
  v_add_u32 v12, 0x10000, v8
  v_xor_b32 v138, 2, v137
  v_lshl_add_u32 v9, v138, 4, v136
  v_add_u32 v13, 0x10000, v9
  v_xor_b32 v138, 4, v137
  v_lshl_add_u32 v10, v138, 4, v136
  v_add_u32 v14, 0x10000, v10
  v_xor_b32 v138, 6, v137
  v_lshl_add_u32 v11, v138, 4, v136
  v_add_u32 v15, 0x10000, v11
  v_bfe_u32 v136, v1, 2, 2
  v_lshl_add_u32 v137, v3, 3, v136
  v_lshlrev_b32 v137, 8, v137
  v_xor_b32 v136, s28, v136
  v_lshl_add_u32 v137, v136, 6, v137
  v_bfe_u32 v136, v1, 4, 1
  v_lshl_add_u32 v137, v136, 5, v137
  v_and_b32 v136, 3, v1
  v_lshl_add_u32 v137, v136, 3, v137
  v_add_u32 v16, 16384, v137
  v_add_u32 v17, 0x10000, v16
  s_cmp_ge_u32 s21, 10
  s_cbranch_scc1 p1_kernel_V
  s_cmp_eq_u32 s23, 1
  s_cselect_b64 vcc, -1, 0
  s_waitcnt vmcnt(4)
  s_barrier
  s_mov_b32 s38, 2
  s_lshl_b32 s30, s38, 7
  s_add_u32 m0, s29, 65536
  s_mul_i32 s31, s38, 245760
  buffer_load_dwordx4 v4, s[8:11], s30 offen lds
  s_add_u32 m0, s29, 66560
  s_nop 0
  buffer_load_dwordx4 v5, s[8:11], s30 offen lds
  s_add_u32 m0, s29, 81920
  s_nop 0
  buffer_load_dwordx4 v6, s[12:15], s31 offen lds
  s_add_u32 m0, s29, 82944
  s_nop 0
  buffer_load_dwordx4 v7, s[12:15], s31 offen lds
  ds_read_b128 v[176:179], v8 offset:0
  ds_read_b128 v[180:183], v8 offset:4096
  ds_read_b64_tr_b16 v[192:193], v16 offset:0
  ds_read_b64_tr_b16 v[194:195], v16 offset:1024
  s_waitcnt lgkmcnt(0)
  v_mfma_f32_32x32x16_bf16 v[144:159], v[192:195], v[176:179], 0
  ds_read_b128 v[184:187], v9 offset:0
  ds_read_b128 v[188:191], v9 offset:4096
  v_mfma_f32_32x32x16_bf16 v[160:175], v[192:195], v[180:183], 0
  ds_read_b64_tr_b16 v[196:197], v16 offset:4096
  ds_read_b64_tr_b16 v[198:199], v16 offset:5120
  s_cbranch_vccnz p1_kernel_qk_cm_4
  v_mfma_f32_32x32x16_bf16 v[28:43], v[192:195], v[44:47], 0
p1_kernel_qk_cm_4:
  s_waitcnt lgkmcnt(0)
  v_mfma_f32_32x32x16_bf16 v[144:159], v[196:199], v[184:187], v[144:159]
  ds_read_b128 v[176:179], v10 offset:0
  ds_read_b128 v[180:183], v10 offset:4096
  v_mfma_f32_32x32x16_bf16 v[160:175], v[196:199], v[188:191], v[160:175]
  ds_read_b64_tr_b16 v[192:193], v16 offset:8192
  ds_read_b64_tr_b16 v[194:195], v16 offset:9216
  s_cbranch_vccnz p1_kernel_qk_cm_5
  v_mfma_f32_32x32x16_bf16 v[28:43], v[196:199], v[44:47], v[28:43]
p1_kernel_qk_cm_5:
  s_waitcnt lgkmcnt(0)
  v_mfma_f32_32x32x16_bf16 v[144:159], v[192:195], v[176:179], v[144:159]
  ds_read_b128 v[184:187], v11 offset:0
  ds_read_b128 v[188:191], v11 offset:4096
  v_mfma_f32_32x32x16_bf16 v[160:175], v[192:195], v[180:183], v[160:175]
  ds_read_b64_tr_b16 v[196:197], v16 offset:12288
  ds_read_b64_tr_b16 v[198:199], v16 offset:13312
  s_cbranch_vccnz p1_kernel_qk_cm_6
  v_mfma_f32_32x32x16_bf16 v[28:43], v[192:195], v[44:47], v[28:43]
p1_kernel_qk_cm_6:
  s_waitcnt lgkmcnt(0)
  s_waitcnt vmcnt(4)
  s_barrier
  v_mfma_f32_32x32x16_bf16 v[144:159], v[196:199], v[184:187], v[144:159]
  ds_read_b128 v[176:179], v8 offset:32768
  ds_read_b128 v[180:183], v8 offset:36864
  ds_read_b64_tr_b16 v[192:193], v16 offset:32768
  ds_read_b64_tr_b16 v[194:195], v16 offset:33792
  v_mfma_f32_32x32x16_bf16 v[160:175], v[196:199], v[188:191], v[160:175]
  s_mov_b32 s38, 3
  s_lshl_b32 s30, s38, 7
  s_add_u32 m0, s29, 98304
  s_cbranch_vccnz p1_kernel_qk_cm_7
  v_mfma_f32_32x32x16_bf16 v[28:43], v[196:199], v[44:47], v[28:43]
p1_kernel_qk_cm_7:
  s_waitcnt lgkmcnt(0)
  v_mfma_f32_32x32x16_bf16 v[144:159], v[192:195], v[176:179], v[144:159]
  ds_read_b128 v[184:187], v9 offset:32768
  ds_read_b128 v[188:191], v9 offset:36864
  ds_read_b64_tr_b16 v[196:197], v16 offset:36864
  ds_read_b64_tr_b16 v[198:199], v16 offset:37888
  v_mfma_f32_32x32x16_bf16 v[160:175], v[192:195], v[180:183], v[160:175]
  s_mul_i32 s31, s38, 245760
  buffer_load_dwordx4 v4, s[8:11], s30 offen lds
  s_add_u32 m0, s29, 99328
  s_nop 0
  s_cbranch_vccnz p1_kernel_qk_cm_8
  v_mfma_f32_32x32x16_bf16 v[28:43], v[192:195], v[44:47], v[28:43]
p1_kernel_qk_cm_8:
  s_waitcnt lgkmcnt(0)
  v_mfma_f32_32x32x16_bf16 v[144:159], v[196:199], v[184:187], v[144:159]
  ds_read_b128 v[176:179], v10 offset:32768
  ds_read_b128 v[180:183], v10 offset:36864
  ds_read_b64_tr_b16 v[192:193], v16 offset:40960
  ds_read_b64_tr_b16 v[194:195], v16 offset:41984
  v_mfma_f32_32x32x16_bf16 v[160:175], v[196:199], v[188:191], v[160:175]
  buffer_load_dwordx4 v5, s[8:11], s30 offen lds
  s_add_u32 m0, s29, 114688
  s_nop 0
  s_cbranch_vccnz p1_kernel_qk_cm_9
  v_mfma_f32_32x32x16_bf16 v[28:43], v[196:199], v[44:47], v[28:43]
p1_kernel_qk_cm_9:
  s_waitcnt lgkmcnt(0)
  v_mfma_f32_32x32x16_bf16 v[144:159], v[192:195], v[176:179], v[144:159]
  ds_read_b128 v[184:187], v11 offset:32768
  ds_read_b128 v[188:191], v11 offset:36864
  ds_read_b64_tr_b16 v[196:197], v16 offset:45056
  ds_read_b64_tr_b16 v[198:199], v16 offset:46080
  v_mfma_f32_32x32x16_bf16 v[160:175], v[192:195], v[180:183], v[160:175]
  buffer_load_dwordx4 v6, s[12:15], s31 offen lds
  s_add_u32 m0, s29, 115712
  s_nop 0
  buffer_load_dwordx4 v7, s[12:15], s31 offen lds
  s_cbranch_vccnz p1_kernel_qk_cm_10
  v_mfma_f32_32x32x16_bf16 v[28:43], v[192:195], v[44:47], v[28:43]
p1_kernel_qk_cm_10:
  s_waitcnt lgkmcnt(0)
  s_waitcnt vmcnt(4)
  s_barrier
  v_mfma_f32_32x32x16_bf16 v[144:159], v[196:199], v[184:187], v[144:159]
  ds_read_b128 v[176:179], v12 offset:0
  ds_read_b128 v[180:183], v12 offset:4096
  ds_read_b64_tr_b16 v[192:193], v17 offset:0
  ds_read_b64_tr_b16 v[194:195], v17 offset:1024
  v_mfma_f32_32x32x16_bf16 v[160:175], v[196:199], v[188:191], v[160:175]
  s_mov_b32 s38, 4
  s_lshl_b32 s30, s38, 7
  s_add_u32 m0, s29, 0
  s_cbranch_vccnz p1_kernel_qk_cm_11
  v_mfma_f32_32x32x16_bf16 v[28:43], v[196:199], v[44:47], v[28:43]
p1_kernel_qk_cm_11:
  s_waitcnt lgkmcnt(0)
  v_mfma_f32_32x32x16_bf16 v[144:159], v[192:195], v[176:179], v[144:159]
  ds_read_b128 v[184:187], v13 offset:0
  ds_read_b128 v[188:191], v13 offset:4096
  ds_read_b64_tr_b16 v[196:197], v17 offset:4096
  ds_read_b64_tr_b16 v[198:199], v17 offset:5120
  v_mfma_f32_32x32x16_bf16 v[160:175], v[192:195], v[180:183], v[160:175]
  s_mul_i32 s31, s38, 245760
  buffer_load_dwordx4 v4, s[8:11], s30 offen lds
  s_add_u32 m0, s29, 1024
  s_nop 0
  s_cbranch_vccnz p1_kernel_qk_cm_12
  v_mfma_f32_32x32x16_bf16 v[28:43], v[192:195], v[44:47], v[28:43]
p1_kernel_qk_cm_12:
  s_waitcnt lgkmcnt(0)
  v_mfma_f32_32x32x16_bf16 v[144:159], v[196:199], v[184:187], v[144:159]
  ds_read_b128 v[176:179], v14 offset:0
  ds_read_b128 v[180:183], v14 offset:4096
  ds_read_b64_tr_b16 v[192:193], v17 offset:8192
  ds_read_b64_tr_b16 v[194:195], v17 offset:9216
  v_mfma_f32_32x32x16_bf16 v[160:175], v[196:199], v[188:191], v[160:175]
  buffer_load_dwordx4 v5, s[8:11], s30 offen lds
  s_add_u32 m0, s29, 16384
  s_nop 0
  s_cbranch_vccnz p1_kernel_qk_cm_13
  v_mfma_f32_32x32x16_bf16 v[28:43], v[196:199], v[44:47], v[28:43]
p1_kernel_qk_cm_13:
  s_waitcnt lgkmcnt(0)
  v_mfma_f32_32x32x16_bf16 v[144:159], v[192:195], v[176:179], v[144:159]
  ds_read_b128 v[184:187], v15 offset:0
  ds_read_b128 v[188:191], v15 offset:4096
  ds_read_b64_tr_b16 v[196:197], v17 offset:12288
  ds_read_b64_tr_b16 v[198:199], v17 offset:13312
  v_mfma_f32_32x32x16_bf16 v[160:175], v[192:195], v[180:183], v[160:175]
  buffer_load_dwordx4 v6, s[12:15], s31 offen lds
  s_add_u32 m0, s29, 17408
  s_nop 0
  buffer_load_dwordx4 v7, s[12:15], s31 offen lds
  s_cbranch_vccnz p1_kernel_qk_cm_14
  v_mfma_f32_32x32x16_bf16 v[28:43], v[192:195], v[44:47], v[28:43]
p1_kernel_qk_cm_14:
  s_waitcnt lgkmcnt(0)
  s_waitcnt vmcnt(4)
  s_barrier
  v_mfma_f32_32x32x16_bf16 v[144:159], v[196:199], v[184:187], v[144:159]
  ds_read_b128 v[176:179], v12 offset:32768
  ds_read_b128 v[180:183], v12 offset:36864
  ds_read_b64_tr_b16 v[192:193], v17 offset:32768
  ds_read_b64_tr_b16 v[194:195], v17 offset:33792
  v_mfma_f32_32x32x16_bf16 v[160:175], v[196:199], v[188:191], v[160:175]
  s_add_u32 s38, s39, 5
  s_lshl_b32 s30, s38, 7
  s_add_u32 m0, s29, 32768
  s_cbranch_vccnz p1_kernel_qk_cm_15
  v_mfma_f32_32x32x16_bf16 v[28:43], v[196:199], v[44:47], v[28:43]
p1_kernel_qk_cm_15:
  s_waitcnt lgkmcnt(0)
  v_mfma_f32_32x32x16_bf16 v[144:159], v[192:195], v[176:179], v[144:159]
  ds_read_b128 v[184:187], v13 offset:32768
  ds_read_b128 v[188:191], v13 offset:36864
  ds_read_b64_tr_b16 v[196:197], v17 offset:36864
  ds_read_b64_tr_b16 v[198:199], v17 offset:37888
  v_mfma_f32_32x32x16_bf16 v[160:175], v[192:195], v[180:183], v[160:175]
  s_mul_i32 s31, s38, 245760
  buffer_load_dwordx4 v4, s[8:11], s30 offen lds
  s_add_u32 m0, s29, 33792
  s_nop 0
  s_cbranch_vccnz p1_kernel_qk_cm_16
  v_mfma_f32_32x32x16_bf16 v[28:43], v[192:195], v[44:47], v[28:43]
p1_kernel_qk_cm_16:
  s_waitcnt lgkmcnt(0)
  v_mfma_f32_32x32x16_bf16 v[144:159], v[196:199], v[184:187], v[144:159]
  ds_read_b128 v[176:179], v14 offset:32768
  ds_read_b128 v[180:183], v14 offset:36864
  ds_read_b64_tr_b16 v[192:193], v17 offset:40960
  ds_read_b64_tr_b16 v[194:195], v17 offset:41984
  v_mfma_f32_32x32x16_bf16 v[160:175], v[196:199], v[188:191], v[160:175]
  buffer_load_dwordx4 v5, s[8:11], s30 offen lds
  s_add_u32 m0, s29, 49152
  s_nop 0
  s_cbranch_vccnz p1_kernel_qk_cm_17
  v_mfma_f32_32x32x16_bf16 v[28:43], v[196:199], v[44:47], v[28:43]
p1_kernel_qk_cm_17:
  s_waitcnt lgkmcnt(0)
  v_mfma_f32_32x32x16_bf16 v[144:159], v[192:195], v[176:179], v[144:159]
  ds_read_b128 v[184:187], v15 offset:32768
  ds_read_b128 v[188:191], v15 offset:36864
  ds_read_b64_tr_b16 v[196:197], v17 offset:45056
  ds_read_b64_tr_b16 v[198:199], v17 offset:46080
  v_mfma_f32_32x32x16_bf16 v[160:175], v[192:195], v[180:183], v[160:175]
  buffer_load_dwordx4 v6, s[12:15], s31 offen lds
  s_add_u32 m0, s29, 50176
  s_nop 0
  buffer_load_dwordx4 v7, s[12:15], s31 offen lds
  s_cbranch_vccnz p1_kernel_qk_cm_18
  v_mfma_f32_32x32x16_bf16 v[28:43], v[192:195], v[44:47], v[28:43]
p1_kernel_qk_cm_18:
  s_waitcnt lgkmcnt(0)
  s_waitcnt vmcnt(4)
  s_barrier
  v_mfma_f32_32x32x16_bf16 v[144:159], v[196:199], v[184:187], v[144:159]
  ds_read_b128 v[176:179], v8 offset:0
  ds_read_b128 v[180:183], v8 offset:4096
  ds_read_b64_tr_b16 v[192:193], v16 offset:0
  ds_read_b64_tr_b16 v[194:195], v16 offset:1024
  v_mfma_f32_32x32x16_bf16 v[160:175], v[196:199], v[188:191], v[160:175]
  s_add_u32 s38, s39, 1
  s_cmp_ge_u32 s38, 5
  s_cselect_b32 s100, 5, 0
  s_sub_u32 s38, s38, s100
  s_cbranch_vccnz p1_kernel_qk_cm_19
  v_mfma_f32_32x32x16_bf16 v[28:43], v[196:199], v[44:47], v[28:43]
p1_kernel_qk_cm_19:
  s_waitcnt lgkmcnt(0)
  v_mfma_f32_32x32x16_bf16 v[144:159], v[192:195], v[176:179], v[144:159]
  ds_read_b128 v[184:187], v9 offset:0
  ds_read_b128 v[188:191], v9 offset:4096
  ds_read_b64_tr_b16 v[196:197], v16 offset:4096
  ds_read_b64_tr_b16 v[198:199], v16 offset:5120
  s_add_u32 s38, s38, 5
  v_mfma_f32_32x32x16_bf16 v[160:175], v[192:195], v[180:183], v[160:175]
  s_lshl_b32 s30, s38, 7
  s_add_u32 m0, s29, 65536
  s_mul_i32 s31, s38, 245760
  buffer_load_dwordx4 v4, s[8:11], s30 offen lds
  s_cbranch_vccnz p1_kernel_qk_cm_20
  v_mfma_f32_32x32x16_bf16 v[28:43], v[192:195], v[44:47], v[28:43]
p1_kernel_qk_cm_20:
  s_waitcnt lgkmcnt(0)
  v_mfma_f32_32x32x16_bf16 v[144:159], v[196:199], v[184:187], v[144:159]
  ds_read_b128 v[176:179], v10 offset:0
  ds_read_b128 v[180:183], v10 offset:4096
  ds_read_b64_tr_b16 v[192:193], v16 offset:8192
  ds_read_b64_tr_b16 v[194:195], v16 offset:9216
  v_mfma_f32_32x32x16_bf16 v[160:175], v[196:199], v[188:191], v[160:175]
  s_add_u32 m0, s29, 66560
  s_nop 0
  buffer_load_dwordx4 v5, s[8:11], s30 offen lds
  s_cbranch_vccnz p1_kernel_qk_cm_21
  v_mfma_f32_32x32x16_bf16 v[28:43], v[196:199], v[44:47], v[28:43]
p1_kernel_qk_cm_21:
  s_waitcnt lgkmcnt(0)
  v_mfma_f32_32x32x16_bf16 v[144:159], v[192:195], v[176:179], v[144:159]
  ds_read_b128 v[184:187], v11 offset:0
  ds_read_b128 v[188:191], v11 offset:4096
  ds_read_b64_tr_b16 v[196:197], v16 offset:12288
  ds_read_b64_tr_b16 v[198:199], v16 offset:13312
  s_add_u32 m0, s29, 81920
  v_mfma_f32_32x32x16_bf16 v[160:175], v[192:195], v[180:183], v[160:175]
  s_nop 0
  buffer_load_dwordx4 v6, s[12:15], s31 offen lds
  s_add_u32 m0, s29, 82944
  s_nop 0
  buffer_load_dwordx4 v7, s[12:15], s31 offen lds
  s_cbranch_vccnz p1_kernel_qk_cm_22
  v_mfma_f32_32x32x16_bf16 v[28:43], v[192:195], v[44:47], v[28:43]
p1_kernel_qk_cm_22:
  s_waitcnt lgkmcnt(0)
  s_waitcnt vmcnt(4)
  s_barrier
  v_mfma_f32_32x32x16_bf16 v[144:159], v[196:199], v[184:187], v[144:159]
  ds_read_b128 v[176:179], v8 offset:32768
  ds_read_b128 v[180:183], v8 offset:36864
  ds_read_b64_tr_b16 v[192:193], v16 offset:32768
  ds_read_b64_tr_b16 v[194:195], v16 offset:33792
  v_mfma_f32_32x32x16_bf16 v[160:175], v[196:199], v[188:191], v[160:175]
  s_add_u32 s38, s39, 2
  s_cmp_ge_u32 s38, 5
  s_cselect_b32 s100, 5, 0
  s_sub_u32 s38, s38, s100
  s_cbranch_vccnz p1_kernel_qk_cm_23
  v_mfma_f32_32x32x16_bf16 v[28:43], v[196:199], v[44:47], v[28:43]
p1_kernel_qk_cm_23:
  s_waitcnt lgkmcnt(0)
  v_mfma_f32_32x32x16_bf16 v[144:159], v[192:195], v[176:179], v[144:159]
  ds_read_b128 v[184:187], v9 offset:32768
  ds_read_b128 v[188:191], v9 offset:36864
  ds_read_b64_tr_b16 v[196:197], v16 offset:36864
  ds_read_b64_tr_b16 v[198:199], v16 offset:37888
  s_add_u32 s38, s38, 5
  v_mfma_f32_32x32x16_bf16 v[160:175], v[192:195], v[180:183], v[160:175]
  s_lshl_b32 s30, s38, 7
  s_add_u32 m0, s29, 98304
  s_mul_i32 s31, s38, 245760
  buffer_load_dwordx4 v4, s[8:11], s30 offen lds
  s_cbranch_vccnz p1_kernel_qk_cm_24
  v_mfma_f32_32x32x16_bf16 v[28:43], v[192:195], v[44:47], v[28:43]
p1_kernel_qk_cm_24:
  s_waitcnt lgkmcnt(0)
  v_mfma_f32_32x32x16_bf16 v[144:159], v[196:199], v[184:187], v[144:159]
  ds_read_b128 v[176:179], v10 offset:32768
  ds_read_b128 v[180:183], v10 offset:36864
  ds_read_b64_tr_b16 v[192:193], v16 offset:40960
  ds_read_b64_tr_b16 v[194:195], v16 offset:41984
  v_mfma_f32_32x32x16_bf16 v[160:175], v[196:199], v[188:191], v[160:175]
  s_add_u32 m0, s29, 99328
  s_nop 0
  buffer_load_dwordx4 v5, s[8:11], s30 offen lds
  s_cbranch_vccnz p1_kernel_qk_cm_25
  v_mfma_f32_32x32x16_bf16 v[28:43], v[196:199], v[44:47], v[28:43]
p1_kernel_qk_cm_25:
  s_waitcnt lgkmcnt(0)
  v_mfma_f32_32x32x16_bf16 v[144:159], v[192:195], v[176:179], v[144:159]
  ds_read_b128 v[184:187], v11 offset:32768
  ds_read_b128 v[188:191], v11 offset:36864
  ds_read_b64_tr_b16 v[196:197], v16 offset:45056
  ds_read_b64_tr_b16 v[198:199], v16 offset:46080
  s_add_u32 m0, s29, 114688
  v_mfma_f32_32x32x16_bf16 v[160:175], v[192:195], v[180:183], v[160:175]
  s_nop 0
  buffer_load_dwordx4 v6, s[12:15], s31 offen lds
  s_add_u32 m0, s29, 115712
  s_nop 0
  buffer_load_dwordx4 v7, s[12:15], s31 offen lds
  s_cbranch_vccnz p1_kernel_qk_cm_26
  v_mfma_f32_32x32x16_bf16 v[28:43], v[192:195], v[44:47], v[28:43]
p1_kernel_qk_cm_26:
  s_waitcnt lgkmcnt(0)
  s_waitcnt vmcnt(4)
  s_barrier
  v_mfma_f32_32x32x16_bf16 v[144:159], v[196:199], v[184:187], v[144:159]
  ds_read_b128 v[176:179], v12 offset:0
  ds_read_b128 v[180:183], v12 offset:4096
  ds_read_b64_tr_b16 v[192:193], v17 offset:0
  ds_read_b64_tr_b16 v[194:195], v17 offset:1024
  v_mfma_f32_32x32x16_bf16 v[160:175], v[196:199], v[188:191], v[160:175]
  s_add_u32 s38, s39, 3
  s_cmp_ge_u32 s38, 5
  s_cselect_b32 s100, 5, 0
  s_sub_u32 s38, s38, s100
  s_cbranch_vccnz p1_kernel_qk_cm_27
  v_mfma_f32_32x32x16_bf16 v[28:43], v[196:199], v[44:47], v[28:43]
p1_kernel_qk_cm_27:
  s_waitcnt lgkmcnt(0)
  v_mfma_f32_32x32x16_bf16 v[144:159], v[192:195], v[176:179], v[144:159]
  ds_read_b128 v[184:187], v13 offset:0
  ds_read_b128 v[188:191], v13 offset:4096
  ds_read_b64_tr_b16 v[196:197], v17 offset:4096
  ds_read_b64_tr_b16 v[198:199], v17 offset:5120
  s_add_u32 s38, s38, 5
  v_mfma_f32_32x32x16_bf16 v[160:175], v[192:195], v[180:183], v[160:175]
  s_lshl_b32 s30, s38, 7
  s_add_u32 m0, s29, 0
  s_mul_i32 s31, s38, 245760
  buffer_load_dwordx4 v4, s[8:11], s30 offen lds
  s_cbranch_vccnz p1_kernel_qk_cm_28
  v_mfma_f32_32x32x16_bf16 v[28:43], v[192:195], v[44:47], v[28:43]
p1_kernel_qk_cm_28:
  s_waitcnt lgkmcnt(0)
  v_mfma_f32_32x32x16_bf16 v[144:159], v[196:199], v[184:187], v[144:159]
  ds_read_b128 v[176:179], v14 offset:0
  ds_read_b128 v[180:183], v14 offset:4096
  ds_read_b64_tr_b16 v[192:193], v17 offset:8192
  ds_read_b64_tr_b16 v[194:195], v17 offset:9216
  v_mfma_f32_32x32x16_bf16 v[160:175], v[196:199], v[188:191], v[160:175]
  s_add_u32 m0, s29, 1024
  s_nop 0
  buffer_load_dwordx4 v5, s[8:11], s30 offen lds
  s_cbranch_vccnz p1_kernel_qk_cm_29
  v_mfma_f32_32x32x16_bf16 v[28:43], v[196:199], v[44:47], v[28:43]
p1_kernel_qk_cm_29:
  s_waitcnt lgkmcnt(0)
  v_mfma_f32_32x32x16_bf16 v[144:159], v[192:195], v[176:179], v[144:159]
  ds_read_b128 v[184:187], v15 offset:0
  ds_read_b128 v[188:191], v15 offset:4096
  ds_read_b64_tr_b16 v[196:197], v17 offset:12288
  ds_read_b64_tr_b16 v[198:199], v17 offset:13312
  s_add_u32 m0, s29, 16384
  v_mfma_f32_32x32x16_bf16 v[160:175], v[192:195], v[180:183], v[160:175]
  s_nop 0
  buffer_load_dwordx4 v6, s[12:15], s31 offen lds
  s_add_u32 m0, s29, 17408
  s_nop 0
  buffer_load_dwordx4 v7, s[12:15], s31 offen lds
  s_cbranch_vccnz p1_kernel_qk_cm_30
  v_mfma_f32_32x32x16_bf16 v[28:43], v[192:195], v[44:47], v[28:43]
p1_kernel_qk_cm_30:
  s_waitcnt lgkmcnt(0)
  s_waitcnt vmcnt(4)
  s_barrier
  s_add_u32 s38, s39, 4
  s_cmp_ge_u32 s38, 5
  s_cselect_b32 s100, 5, 0
  s_sub_u32 s38, s38, s100
  s_add_u32 s38, s38, 5
  s_lshl_b32 s30, s38, 7
  s_add_u32 m0, s29, 32768
  s_mul_i32 s31, s38, 245760
  buffer_load_dwordx4 v4, s[8:11], s30 offen lds
  s_add_u32 m0, s29, 33792
  s_nop 0
  buffer_load_dwordx4 v5, s[8:11], s30 offen lds
  s_add_u32 m0, s29, 49152
  s_nop 0
  buffer_load_dwordx4 v6, s[12:15], s31 offen lds
  s_add_u32 m0, s29, 50176
  s_nop 0
  buffer_load_dwordx4 v7, s[12:15], s31 offen lds
  s_cmp_eq_u32 s22, 0
  s_cbranch_scc0 p1_kernel_qk_fl_31
  s_and_b32 s32, s20, 12
  s_add_u32 s32, s32, 16
  v_mov_b32 v128, s32
  v_cmp_eq_u32 vcc, 1, v1
  v_mov_b32 v143, 0
  s_nop 0
  v_cndmask_b32 v128, v128, v143, vcc
  s_cmp_eq_u32 s23, 1
  s_cselect_b64 vcc, -1, 0
  buffer_load_dword v128, v128, s[40:43], 0 offen sc1
p1_kernel_qk_fl_31:
  v_mfma_f32_32x32x16_bf16 v[144:159], v[196:199], v[184:187], v[144:159]
  ds_read_b128 v[176:179], v12 offset:32768
  ds_read_b128 v[180:183], v12 offset:36864
  v_mfma_f32_32x32x16_bf16 v[160:175], v[196:199], v[188:191], v[160:175]
  ds_read_b64_tr_b16 v[192:193], v17 offset:32768
  ds_read_b64_tr_b16 v[194:195], v17 offset:33792
  s_cbranch_vccnz p1_kernel_qk_cm_32
  v_mfma_f32_32x32x16_bf16 v[28:43], v[196:199], v[44:47], v[28:43]
p1_kernel_qk_cm_32:
  s_waitcnt lgkmcnt(0)
  v_mfma_f32_32x32x16_bf16 v[144:159], v[192:195], v[176:179], v[144:159]
  ds_read_b128 v[184:187], v13 offset:32768
  ds_read_b128 v[188:191], v13 offset:36864
  v_mfma_f32_32x32x16_bf16 v[160:175], v[192:195], v[180:183], v[160:175]
  ds_read_b64_tr_b16 v[196:197], v17 offset:36864
  ds_read_b64_tr_b16 v[198:199], v17 offset:37888
  s_cbranch_vccnz p1_kernel_qk_cm_33
  v_mfma_f32_32x32x16_bf16 v[28:43], v[192:195], v[44:47], v[28:43]
p1_kernel_qk_cm_33:
  s_waitcnt lgkmcnt(0)
  v_mfma_f32_32x32x16_bf16 v[144:159], v[196:199], v[184:187], v[144:159]
  ds_read_b128 v[176:179], v14 offset:32768
  ds_read_b128 v[180:183], v14 offset:36864
  v_mfma_f32_32x32x16_bf16 v[160:175], v[196:199], v[188:191], v[160:175]
  ds_read_b64_tr_b16 v[192:193], v17 offset:40960
  ds_read_b64_tr_b16 v[194:195], v17 offset:41984
  s_cbranch_vccnz p1_kernel_qk_cm_34
  v_mfma_f32_32x32x16_bf16 v[28:43], v[196:199], v[44:47], v[28:43]
p1_kernel_qk_cm_34:
  s_waitcnt lgkmcnt(0)
  v_mfma_f32_32x32x16_bf16 v[144:159], v[192:195], v[176:179], v[144:159]
  ds_read_b128 v[184:187], v15 offset:32768
  ds_read_b128 v[188:191], v15 offset:36864
  v_mfma_f32_32x32x16_bf16 v[160:175], v[192:195], v[180:183], v[160:175]
  ds_read_b64_tr_b16 v[196:197], v17 offset:45056
  ds_read_b64_tr_b16 v[198:199], v17 offset:46080
  s_cbranch_vccnz p1_kernel_qk_cm_35
  v_mfma_f32_32x32x16_bf16 v[28:43], v[192:195], v[44:47], v[28:43]
p1_kernel_qk_cm_35:
  s_waitcnt lgkmcnt(0)
  s_cmp_eq_u32 s22, 0
  s_cbranch_scc1 p1_kernel_qk_wa_36
  s_waitcnt vmcnt(4)
  s_branch p1_kernel_qk_wb_37
p1_kernel_qk_wa_36:
  s_waitcnt vmcnt(5)
p1_kernel_qk_wb_37:
  s_barrier
  v_mfma_f32_32x32x16_bf16 v[144:159], v[196:199], v[184:187], v[144:159]
  ds_read_b128 v[176:179], v8 offset:0
  ds_read_b128 v[180:183], v8 offset:4096
  v_mfma_f32_32x32x16_bf16 v[160:175], v[196:199], v[188:191], v[160:175]
  ds_read_b64_tr_b16 v[192:193], v16 offset:0
  ds_read_b64_tr_b16 v[194:195], v16 offset:1024
  s_cbranch_vccnz p1_kernel_qk_cm_38
  v_mfma_f32_32x32x16_bf16 v[28:43], v[196:199], v[44:47], v[28:43]
p1_kernel_qk_cm_38:
  s_waitcnt lgkmcnt(0)
  v_mfma_f32_32x32x16_bf16 v[144:159], v[192:195], v[176:179], v[144:159]
  ds_read_b128 v[184:187], v9 offset:0
  ds_read_b128 v[188:191], v9 offset:4096
  v_mfma_f32_32x32x16_bf16 v[160:175], v[192:195], v[180:183], v[160:175]
  ds_read_b64_tr_b16 v[196:197], v16 offset:4096
  ds_read_b64_tr_b16 v[198:199], v16 offset:5120
  s_cbranch_vccnz p1_kernel_qk_cm_39
  v_mfma_f32_32x32x16_bf16 v[28:43], v[192:195], v[44:47], v[28:43]
p1_kernel_qk_cm_39:
  s_waitcnt lgkmcnt(0)
  v_mfma_f32_32x32x16_bf16 v[144:159], v[196:199], v[184:187], v[144:159]
  ds_read_b128 v[176:179], v10 offset:0
  ds_read_b128 v[180:183], v10 offset:4096
  v_mfma_f32_32x32x16_bf16 v[160:175], v[196:199], v[188:191], v[160:175]
  ds_read_b64_tr_b16 v[192:193], v16 offset:8192
  ds_read_b64_tr_b16 v[194:195], v16 offset:9216
  s_cbranch_vccnz p1_kernel_qk_cm_40
  v_mfma_f32_32x32x16_bf16 v[28:43], v[196:199], v[44:47], v[28:43]
p1_kernel_qk_cm_40:
  s_waitcnt lgkmcnt(0)
  v_mfma_f32_32x32x16_bf16 v[144:159], v[192:195], v[176:179], v[144:159]
  ds_read_b128 v[184:187], v11 offset:0
  ds_read_b128 v[188:191], v11 offset:4096
  v_mfma_f32_32x32x16_bf16 v[160:175], v[192:195], v[180:183], v[160:175]
  ds_read_b64_tr_b16 v[196:197], v16 offset:12288
  ds_read_b64_tr_b16 v[198:199], v16 offset:13312
  s_cbranch_vccnz p1_kernel_qk_cm_41
  v_mfma_f32_32x32x16_bf16 v[28:43], v[192:195], v[44:47], v[28:43]
p1_kernel_qk_cm_41:
  s_waitcnt lgkmcnt(0)
  s_waitcnt vmcnt(0)
  s_cmp_eq_u32 s22, 0
  s_cbranch_scc0 p1_kernel_qk_pe_42
  v_readlane_b32 s101, v128, 1
  v_readfirstlane_b32 s32, v128
  s_and_b32 s33, s20, 3
  s_lshl_b32 s33, s33, 3
  s_lshr_b32 s32, s32, s33
  s_and_b32 s44, s32, 1
  v_mov_b32 v142, 131072
  v_mov_b32 v143, s44
  ds_write_b32 v142, v143
  s_waitcnt lgkmcnt(0)
p1_kernel_qk_pe_42:
  s_barrier
  v_mov_b32 v142, 131072
  ds_read_b32 v143, v142
  s_waitcnt lgkmcnt(0)
  v_readfirstlane_b32 s44, v143
  s_lshl_b32 s45, s20, 10
  s_add_u32 s45, s45, 0x1b80000
  s_cmp_eq_u32 s44, 1
  s_cselect_b32 s45, s45, 0
  v_and_b32 v142, 127, v0
  v_lshlrev_b32 v143, 3, v142
  buffer_load_dwordx2 v[130:131], v143, s[16:19], s45 offen sc1
  v_mfma_f32_32x32x16_bf16 v[144:159], v[196:199], v[184:187], v[144:159]
  ds_read_b128 v[176:179], v8 offset:32768
  ds_read_b128 v[180:183], v8 offset:36864
  v_mfma_f32_32x32x16_bf16 v[160:175], v[196:199], v[188:191], v[160:175]
  ds_read_b64_tr_b16 v[192:193], v16 offset:32768
  ds_read_b64_tr_b16 v[194:195], v16 offset:33792
  s_cbranch_vccnz p1_kernel_qk_cm_43
  v_mfma_f32_32x32x16_bf16 v[28:43], v[196:199], v[44:47], v[28:43]
p1_kernel_qk_cm_43:
  s_waitcnt lgkmcnt(0)
  v_mfma_f32_32x32x16_bf16 v[144:159], v[192:195], v[176:179], v[144:159]
  ds_read_b128 v[184:187], v9 offset:32768
  ds_read_b128 v[188:191], v9 offset:36864
  v_mfma_f32_32x32x16_bf16 v[160:175], v[192:195], v[180:183], v[160:175]
  ds_read_b64_tr_b16 v[196:197], v16 offset:36864
  ds_read_b64_tr_b16 v[198:199], v16 offset:37888
  s_cbranch_vccnz p1_kernel_qk_cm_44
  v_mfma_f32_32x32x16_bf16 v[28:43], v[192:195], v[44:47], v[28:43]
p1_kernel_qk_cm_44:
  s_waitcnt lgkmcnt(0)
  v_mfma_f32_32x32x16_bf16 v[144:159], v[196:199], v[184:187], v[144:159]
  ds_read_b128 v[176:179], v10 offset:32768
  ds_read_b128 v[180:183], v10 offset:36864
  v_mfma_f32_32x32x16_bf16 v[160:175], v[196:199], v[188:191], v[160:175]
  ds_read_b64_tr_b16 v[192:193], v16 offset:40960
  ds_read_b64_tr_b16 v[194:195], v16 offset:41984
  s_cbranch_vccnz p1_kernel_qk_cm_45
  v_mfma_f32_32x32x16_bf16 v[28:43], v[196:199], v[44:47], v[28:43]
p1_kernel_qk_cm_45:
  s_waitcnt lgkmcnt(0)
  v_mfma_f32_32x32x16_bf16 v[144:159], v[192:195], v[176:179], v[144:159]
  ds_read_b128 v[184:187], v11 offset:32768
  ds_read_b128 v[188:191], v11 offset:36864
  v_mfma_f32_32x32x16_bf16 v[160:175], v[192:195], v[180:183], v[160:175]
  ds_read_b64_tr_b16 v[196:197], v16 offset:45056
  ds_read_b64_tr_b16 v[198:199], v16 offset:46080
  s_cbranch_vccnz p1_kernel_qk_cm_46
  v_mfma_f32_32x32x16_bf16 v[28:43], v[192:195], v[44:47], v[28:43]
p1_kernel_qk_cm_46:
  s_waitcnt lgkmcnt(0)
  v_mfma_f32_32x32x16_bf16 v[144:159], v[196:199], v[184:187], v[144:159]
  v_mfma_f32_32x32x16_bf16 v[160:175], v[196:199], v[188:191], v[160:175]
  s_cbranch_vccnz p1_kernel_qk_cm_47
  v_mfma_f32_32x32x16_bf16 v[28:43], v[196:199], v[44:47], v[28:43]
p1_kernel_qk_cm_47:
  s_waitcnt vmcnt(0)
  s_cmp_eq_u32 s44, 1
  s_cbranch_scc1 p1_kernel_qk_ok_48
  s_mov_b32 s48, 0
p1_kernel_qk_spin_49:
  s_and_b32 s32, s20, 12
  s_add_u32 s32, s32, 16
  v_mov_b32 v128, s32
  v_cmp_eq_u32 vcc, 1, v1
  v_mov_b32 v143, 0
  s_nop 0
  v_cndmask_b32 v128, v128, v143, vcc
  s_cmp_eq_u32 s23, 1
  s_cselect_b64 vcc, -1, 0
  buffer_load_dword v128, v128, s[40:43], 0 offen sc1
  s_waitcnt vmcnt(0)
  v_readlane_b32 s101, v128, 1
  v_readfirstlane_b32 s32, v128
  s_and_b32 s33, s20, 3
  s_lshl_b32 s33, s33, 3
  s_lshr_b32 s32, s32, s33
  s_and_b32 s44, s32, 1
  s_cmp_eq_u32 s44, 1
  s_cbranch_scc1 p1_kernel_qk_got_50
  s_sleep 2
  s_add_u32 s48, s48, 1
  s_cmp_lt_u32 s48, 0x40000
  s_cbranch_scc1 p1_kernel_qk_spin_49
  s_mov_b32 s44, 1
p1_kernel_qk_got_50:
  s_lshl_b32 s45, s20, 10
  s_add_u32 s45, s45, 0x1b80000
  s_cmp_eq_u32 s44, 1
  s_cselect_b32 s45, s45, 0
  v_and_b32 v142, 127, v0
  v_lshlrev_b32 v143, 3, v142
  buffer_load_dwordx2 v[130:131], v143, s[16:19], s45 offen sc1
  s_waitcnt vmcnt(0)
p1_kernel_qk_ok_48:
  s_lshl_b32 s32, s28, 12
  v_lshl_add_u32 v137, v1, 4, s32
  s_cmp_eq_u32 s23, 0
  s_cbranch_scc0 p1_kernel_csw_51
  ds_write_b128 v137, v[28:31] offset:16384
  ds_write_b128 v137, v[32:35] offset:17408
  ds_write_b128 v137, v[36:39] offset:18432
  ds_write_b128 v137, v[40:43] offset:19456
p1_kernel_csw_51:
  s_cmp_ge_u32 s22, 2
  s_cbranch_scc1 p1_kernel_redc_52
  v_lshlrev_b32 v136, 3, v0
  ds_write_b64 v136, v[130:131] offset:10240
p1_kernel_redc_52:
  s_waitcnt lgkmcnt(0)
  s_barrier
  s_cmp_eq_u32 s23, 1
  s_cbranch_scc0 p1_kernel_csr_53
  ds_read_b128 v[28:31], v137 offset:16384
  ds_read_b128 v[32:35], v137 offset:17408
  ds_read_b128 v[36:39], v137 offset:18432
  ds_read_b128 v[40:43], v137 offset:19456
  s_waitcnt lgkmcnt(0)
p1_kernel_csr_53:
  s_lshl_b32 s32, s23, 6
  v_add_u32 v136, s32, v2
  v_lshlrev_b32 v136, 3, v136
  ds_read_b64 v[192:193], v136 offset:10240
  ds_read_b64 v[194:195], v136 offset:10496
  s_cmp_ge_u32 s21, 5
  s_cselect_b32 s32, 0x280000, 0x0
  s_cselect_b32 s33, 0x280000, 0
  s_cselect_b32 s34, 1.0, 0x3ea52b5c
  s_cselect_b32 s35, 5, 0
  s_sub_u32 s35, s21, s35
  s_lshl_b32 s35, s35, 2
  s_add_u32 s35, s35, s28
  s_lshl_b32 s35, s35, 3
  s_add_u32 s33, s33, 0x200000
  s_lshl_b32 s36, s20, 2
  s_lshl_b32 s37, s23, 1
  s_add_u32 s36, s36, s37
  s_lshl_b32 s37, s36, 10
  s_add_u32 s37, s37, s32
  v_lshl_add_u32 v138, v1, 3, s37
  s_lshl_b32 s37, s36, 8
  s_add_u32 s37, s37, s33
  v_lshl_add_u32 v139, v2, 3, s37
  v_add_u32 v140, s35, v3
  s_waitcnt lgkmcnt(0)
  v_mul_f32 v193, s34, v193
  v_mul_f32 v195, s34, v195
  v_add_u32 v142, 0, v140
  v_mul_u32_u24 v141, 205, v142
  v_lshrrev_b32 v141, 10, v141
  v_mul_u32_u24 v143, 5, v141
  v_sub_u32 v142, v142, v143
  v_lshl_add_u32 v143, v141, 16, v138
  v_lshrrev_b32 v137, 1, v142
  v_lshl_add_u32 v143, v137, 9, v143
  v_lshl_add_u32 v141, v141, 14, v139
  v_cmp_eq_u32 vcc, 4, v142
  v_add_u32 v136, 1024, v143
  v_add_u32 v137, 256, v141
  v_cndmask_b32 v143, v143, v141, vcc
  v_cndmask_b32 v136, v136, v137, vcc
  v_fma_f32 v144, -v192, v28, v144
  v_fma_f32 v145, -v192, v29, v145
  v_fma_f32 v146, -v192, v30, v146
  v_fma_f32 v147, -v192, v31, v147
  v_mul_f32 v144, v193, v144
  v_mul_f32 v145, v193, v145
  v_mul_f32 v146, v193, v146
  v_mul_f32 v147, v193, v147
  v_cvt_pk_bf16_f32 v144, v144, v145
  v_cvt_pk_bf16_f32 v145, v146, v147
  buffer_store_dwordx2 v[144:145], v143, s[16:19], 0 offen sc1
  v_fma_f32 v160, -v194, v28, v160
  v_fma_f32 v161, -v194, v29, v161
  v_fma_f32 v162, -v194, v30, v162
  v_fma_f32 v163, -v194, v31, v163
  v_mul_f32 v160, v195, v160
  v_mul_f32 v161, v195, v161
  v_mul_f32 v162, v195, v162
  v_mul_f32 v163, v195, v163
  v_cvt_pk_bf16_f32 v160, v160, v161
  v_cvt_pk_bf16_f32 v161, v162, v163
  buffer_store_dwordx2 v[160:161], v136, s[16:19], 0 offen sc1
  v_add_u32 v142, 2, v140
  v_mul_u32_u24 v141, 205, v142
  v_lshrrev_b32 v141, 10, v141
  v_mul_u32_u24 v143, 5, v141
  v_sub_u32 v142, v142, v143
  v_lshl_add_u32 v143, v141, 16, v138
  v_lshrrev_b32 v137, 1, v142
  v_lshl_add_u32 v143, v137, 9, v143
  v_lshl_add_u32 v141, v141, 14, v139
  v_cmp_eq_u32 vcc, 4, v142
  v_add_u32 v136, 1024, v143
  v_add_u32 v137, 256, v141
  v_cndmask_b32 v143, v143, v141, vcc
  v_cndmask_b32 v136, v136, v137, vcc
  v_fma_f32 v148, -v192, v32, v148
  v_fma_f32 v149, -v192, v33, v149
  v_fma_f32 v150, -v192, v34, v150
  v_fma_f32 v151, -v192, v35, v151
  v_mul_f32 v148, v193, v148
  v_mul_f32 v149, v193, v149
  v_mul_f32 v150, v193, v150
  v_mul_f32 v151, v193, v151
  v_cvt_pk_bf16_f32 v148, v148, v149
  v_cvt_pk_bf16_f32 v149, v150, v151
  buffer_store_dwordx2 v[148:149], v143, s[16:19], 0 offen sc1
  v_fma_f32 v164, -v194, v32, v164
  v_fma_f32 v165, -v194, v33, v165
  v_fma_f32 v166, -v194, v34, v166
  v_fma_f32 v167, -v194, v35, v167
  v_mul_f32 v164, v195, v164
  v_mul_f32 v165, v195, v165
  v_mul_f32 v166, v195, v166
  v_mul_f32 v167, v195, v167
  v_cvt_pk_bf16_f32 v164, v164, v165
  v_cvt_pk_bf16_f32 v165, v166, v167
  buffer_store_dwordx2 v[164:165], v136, s[16:19], 0 offen sc1
  v_add_u32 v142, 4, v140
  v_mul_u32_u24 v141, 205, v142
  v_lshrrev_b32 v141, 10, v141
  v_mul_u32_u24 v143, 5, v141
  v_sub_u32 v142, v142, v143
  v_lshl_add_u32 v143, v141, 16, v138
  v_lshrrev_b32 v137, 1, v142
  v_lshl_add_u32 v143, v137, 9, v143
  v_lshl_add_u32 v141, v141, 14, v139
  v_cmp_eq_u32 vcc, 4, v142
  v_add_u32 v136, 1024, v143
  v_add_u32 v137, 256, v141
  v_cndmask_b32 v143, v143, v141, vcc
  v_cndmask_b32 v136, v136, v137, vcc
  v_fma_f32 v152, -v192, v36, v152
  v_fma_f32 v153, -v192, v37, v153
  v_fma_f32 v154, -v192, v38, v154
  v_fma_f32 v155, -v192, v39, v155
  v_mul_f32 v152, v193, v152
  v_mul_f32 v153, v193, v153
  v_mul_f32 v154, v193, v154
  v_mul_f32 v155, v193, v155
  v_cvt_pk_bf16_f32 v152, v152, v153
  v_cvt_pk_bf16_f32 v153, v154, v155
  buffer_store_dwordx2 v[152:153], v143, s[16:19], 0 offen sc1
  v_fma_f32 v168, -v194, v36, v168
  v_fma_f32 v169, -v194, v37, v169
  v_fma_f32 v170, -v194, v38, v170
  v_fma_f32 v171, -v194, v39, v171
  v_mul_f32 v168, v195, v168
  v_mul_f32 v169, v195, v169
  v_mul_f32 v170, v195, v170
  v_mul_f32 v171, v195, v171
  v_cvt_pk_bf16_f32 v168, v168, v169
  v_cvt_pk_bf16_f32 v169, v170, v171
  buffer_store_dwordx2 v[168:169], v136, s[16:19], 0 offen sc1
  v_add_u32 v142, 6, v140
  v_mul_u32_u24 v141, 205, v142
  v_lshrrev_b32 v141, 10, v141
  v_mul_u32_u24 v143, 5, v141
  v_sub_u32 v142, v142, v143
  v_lshl_add_u32 v143, v141, 16, v138
  v_lshrrev_b32 v137, 1, v142
  v_lshl_add_u32 v143, v137, 9, v143
  v_lshl_add_u32 v141, v141, 14, v139
  v_cmp_eq_u32 vcc, 4, v142
  v_add_u32 v136, 1024, v143
  v_add_u32 v137, 256, v141
  v_cndmask_b32 v143, v143, v141, vcc
  v_cndmask_b32 v136, v136, v137, vcc
  v_fma_f32 v156, -v192, v40, v156
  v_fma_f32 v157, -v192, v41, v157
  v_fma_f32 v158, -v192, v42, v158
  v_fma_f32 v159, -v192, v43, v159
  v_mul_f32 v156, v193, v156
  v_mul_f32 v157, v193, v157
  v_mul_f32 v158, v193, v158
  v_mul_f32 v159, v193, v159
  v_cvt_pk_bf16_f32 v156, v156, v157
  v_cvt_pk_bf16_f32 v157, v158, v159
  buffer_store_dwordx2 v[156:157], v143, s[16:19], 0 offen sc1
  v_fma_f32 v172, -v194, v40, v172
  v_fma_f32 v173, -v194, v41, v173
  v_fma_f32 v174, -v194, v42, v174
  v_fma_f32 v175, -v194, v43, v175
  v_mul_f32 v172, v195, v172
  v_mul_f32 v173, v195, v173
  v_mul_f32 v174, v195, v174
  v_mul_f32 v175, v195, v175
  v_cvt_pk_bf16_f32 v172, v172, v173
  v_cvt_pk_bf16_f32 v173, v174, v175
  buffer_store_dwordx2 v[172:173], v136, s[16:19], 0 offen sc1
  s_branch p1_kernel_done
p1_kernel_V:
  s_cmp_eq_u32 s23, 1
  s_cselect_b64 vcc, -1, 0
  s_waitcnt vmcnt(4)
  s_barrier
  s_mov_b32 s38, 2
  s_lshl_b32 s30, s38, 7
  s_add_u32 m0, s29, 65536
  s_mul_i32 s31, s38, 245760
  buffer_load_dwordx4 v4, s[8:11], s30 offen lds
  s_add_u32 m0, s29, 66560
  s_nop 0
  buffer_load_dwordx4 v5, s[8:11], s30 offen lds
  s_add_u32 m0, s29, 81920
  s_nop 0
  buffer_load_dwordx4 v6, s[12:15], s31 offen lds
  s_add_u32 m0, s29, 82944
  s_nop 0
  buffer_load_dwordx4 v7, s[12:15], s31 offen lds
  ds_read_b128 v[176:179], v8 offset:0
  ds_read_b128 v[180:183], v8 offset:4096
  ds_read_b64_tr_b16 v[192:193], v16 offset:0
  ds_read_b64_tr_b16 v[194:195], v16 offset:1024
  s_waitcnt lgkmcnt(0)
  v_mfma_f32_32x32x16_bf16 v[144:159], v[176:179], v[192:195], 0
  ds_read_b128 v[184:187], v9 offset:0
  ds_read_b128 v[188:191], v9 offset:4096
  v_mfma_f32_32x32x16_bf16 v[160:175], v[180:183], v[192:195], 0
  ds_read_b64_tr_b16 v[196:197], v16 offset:4096
  ds_read_b64_tr_b16 v[198:199], v16 offset:5120
  s_cbranch_vccnz p1_kernel_v_cm_54
  v_mfma_f32_32x32x16_bf16 v[28:43], v[44:47], v[192:195], 0
p1_kernel_v_cm_54:
  s_waitcnt lgkmcnt(0)
  v_mfma_f32_32x32x16_bf16 v[144:159], v[184:187], v[196:199], v[144:159]
  ds_read_b128 v[176:179], v10 offset:0
  ds_read_b128 v[180:183], v10 offset:4096
  v_mfma_f32_32x32x16_bf16 v[160:175], v[188:191], v[196:199], v[160:175]
  ds_read_b64_tr_b16 v[192:193], v16 offset:8192
  ds_read_b64_tr_b16 v[194:195], v16 offset:9216
  s_cbranch_vccnz p1_kernel_v_cm_55
  v_mfma_f32_32x32x16_bf16 v[28:43], v[44:47], v[196:199], v[28:43]
p1_kernel_v_cm_55:
  s_waitcnt lgkmcnt(0)
  v_mfma_f32_32x32x16_bf16 v[144:159], v[176:179], v[192:195], v[144:159]
  ds_read_b128 v[184:187], v11 offset:0
  ds_read_b128 v[188:191], v11 offset:4096
  v_mfma_f32_32x32x16_bf16 v[160:175], v[180:183], v[192:195], v[160:175]
  ds_read_b64_tr_b16 v[196:197], v16 offset:12288
  ds_read_b64_tr_b16 v[198:199], v16 offset:13312
  s_cbranch_vccnz p1_kernel_v_cm_56
  v_mfma_f32_32x32x16_bf16 v[28:43], v[44:47], v[192:195], v[28:43]
p1_kernel_v_cm_56:
  s_waitcnt lgkmcnt(0)
  s_waitcnt vmcnt(4)
  s_barrier
  v_mfma_f32_32x32x16_bf16 v[144:159], v[184:187], v[196:199], v[144:159]
  ds_read_b128 v[176:179], v8 offset:32768
  ds_read_b128 v[180:183], v8 offset:36864
  ds_read_b64_tr_b16 v[192:193], v16 offset:32768
  ds_read_b64_tr_b16 v[194:195], v16 offset:33792
  v_mfma_f32_32x32x16_bf16 v[160:175], v[188:191], v[196:199], v[160:175]
  s_mov_b32 s38, 3
  s_lshl_b32 s30, s38, 7
  s_add_u32 m0, s29, 98304
  s_cbranch_vccnz p1_kernel_v_cm_57
  v_mfma_f32_32x32x16_bf16 v[28:43], v[44:47], v[196:199], v[28:43]
p1_kernel_v_cm_57:
  s_waitcnt lgkmcnt(0)
  v_mfma_f32_32x32x16_bf16 v[144:159], v[176:179], v[192:195], v[144:159]
  ds_read_b128 v[184:187], v9 offset:32768
  ds_read_b128 v[188:191], v9 offset:36864
  ds_read_b64_tr_b16 v[196:197], v16 offset:36864
  ds_read_b64_tr_b16 v[198:199], v16 offset:37888
  v_mfma_f32_32x32x16_bf16 v[160:175], v[180:183], v[192:195], v[160:175]
  s_mul_i32 s31, s38, 245760
  buffer_load_dwordx4 v4, s[8:11], s30 offen lds
  s_add_u32 m0, s29, 99328
  s_nop 0
  s_cbranch_vccnz p1_kernel_v_cm_58
  v_mfma_f32_32x32x16_bf16 v[28:43], v[44:47], v[192:195], v[28:43]
p1_kernel_v_cm_58:
  s_waitcnt lgkmcnt(0)
  v_mfma_f32_32x32x16_bf16 v[144:159], v[184:187], v[196:199], v[144:159]
  ds_read_b128 v[176:179], v10 offset:32768
  ds_read_b128 v[180:183], v10 offset:36864
  ds_read_b64_tr_b16 v[192:193], v16 offset:40960
  ds_read_b64_tr_b16 v[194:195], v16 offset:41984
  v_mfma_f32_32x32x16_bf16 v[160:175], v[188:191], v[196:199], v[160:175]
  buffer_load_dwordx4 v5, s[8:11], s30 offen lds
  s_add_u32 m0, s29, 114688
  s_nop 0
  s_cbranch_vccnz p1_kernel_v_cm_59
  v_mfma_f32_32x32x16_bf16 v[28:43], v[44:47], v[196:199], v[28:43]
p1_kernel_v_cm_59:
  s_waitcnt lgkmcnt(0)
  v_mfma_f32_32x32x16_bf16 v[144:159], v[176:179], v[192:195], v[144:159]
  ds_read_b128 v[184:187], v11 offset:32768
  ds_read_b128 v[188:191], v11 offset:36864
  ds_read_b64_tr_b16 v[196:197], v16 offset:45056
  ds_read_b64_tr_b16 v[198:199], v16 offset:46080
  v_mfma_f32_32x32x16_bf16 v[160:175], v[180:183], v[192:195], v[160:175]
  buffer_load_dwordx4 v6, s[12:15], s31 offen lds
  s_add_u32 m0, s29, 115712
  s_nop 0
  buffer_load_dwordx4 v7, s[12:15], s31 offen lds
  s_cbranch_vccnz p1_kernel_v_cm_60
  v_mfma_f32_32x32x16_bf16 v[28:43], v[44:47], v[192:195], v[28:43]
p1_kernel_v_cm_60:
  s_waitcnt lgkmcnt(0)
  s_waitcnt vmcnt(4)
  s_barrier
  v_mfma_f32_32x32x16_bf16 v[144:159], v[184:187], v[196:199], v[144:159]
  ds_read_b128 v[176:179], v12 offset:0
  ds_read_b128 v[180:183], v12 offset:4096
  ds_read_b64_tr_b16 v[192:193], v17 offset:0
  ds_read_b64_tr_b16 v[194:195], v17 offset:1024
  v_mfma_f32_32x32x16_bf16 v[160:175], v[188:191], v[196:199], v[160:175]
  s_mov_b32 s38, 4
  s_lshl_b32 s30, s38, 7
  s_add_u32 m0, s29, 0
  s_cbranch_vccnz p1_kernel_v_cm_61
  v_mfma_f32_32x32x16_bf16 v[28:43], v[44:47], v[196:199], v[28:43]
p1_kernel_v_cm_61:
  s_waitcnt lgkmcnt(0)
  v_mfma_f32_32x32x16_bf16 v[144:159], v[176:179], v[192:195], v[144:159]
  ds_read_b128 v[184:187], v13 offset:0
  ds_read_b128 v[188:191], v13 offset:4096
  ds_read_b64_tr_b16 v[196:197], v17 offset:4096
  ds_read_b64_tr_b16 v[198:199], v17 offset:5120
  v_mfma_f32_32x32x16_bf16 v[160:175], v[180:183], v[192:195], v[160:175]
  s_mul_i32 s31, s38, 245760
  buffer_load_dwordx4 v4, s[8:11], s30 offen lds
  s_add_u32 m0, s29, 1024
  s_nop 0
  s_cbranch_vccnz p1_kernel_v_cm_62
  v_mfma_f32_32x32x16_bf16 v[28:43], v[44:47], v[192:195], v[28:43]
p1_kernel_v_cm_62:
  s_waitcnt lgkmcnt(0)
  v_mfma_f32_32x32x16_bf16 v[144:159], v[184:187], v[196:199], v[144:159]
  ds_read_b128 v[176:179], v14 offset:0
  ds_read_b128 v[180:183], v14 offset:4096
  ds_read_b64_tr_b16 v[192:193], v17 offset:8192
  ds_read_b64_tr_b16 v[194:195], v17 offset:9216
  v_mfma_f32_32x32x16_bf16 v[160:175], v[188:191], v[196:199], v[160:175]
  buffer_load_dwordx4 v5, s[8:11], s30 offen lds
  s_add_u32 m0, s29, 16384
  s_nop 0
  s_cbranch_vccnz p1_kernel_v_cm_63
  v_mfma_f32_32x32x16_bf16 v[28:43], v[44:47], v[196:199], v[28:43]
p1_kernel_v_cm_63:
  s_waitcnt lgkmcnt(0)
  v_mfma_f32_32x32x16_bf16 v[144:159], v[176:179], v[192:195], v[144:159]
  ds_read_b128 v[184:187], v15 offset:0
  ds_read_b128 v[188:191], v15 offset:4096
  ds_read_b64_tr_b16 v[196:197], v17 offset:12288
  ds_read_b64_tr_b16 v[198:199], v17 offset:13312
  v_mfma_f32_32x32x16_bf16 v[160:175], v[180:183], v[192:195], v[160:175]
  buffer_load_dwordx4 v6, s[12:15], s31 offen lds
  s_add_u32 m0, s29, 17408
  s_nop 0
  buffer_load_dwordx4 v7, s[12:15], s31 offen lds
  s_cbranch_vccnz p1_kernel_v_cm_64
  v_mfma_f32_32x32x16_bf16 v[28:43], v[44:47], v[192:195], v[28:43]
p1_kernel_v_cm_64:
  s_waitcnt lgkmcnt(0)
  s_waitcnt vmcnt(4)
  s_barrier
  v_mfma_f32_32x32x16_bf16 v[144:159], v[184:187], v[196:199], v[144:159]
  ds_read_b128 v[176:179], v12 offset:32768
  ds_read_b128 v[180:183], v12 offset:36864
  ds_read_b64_tr_b16 v[192:193], v17 offset:32768
  ds_read_b64_tr_b16 v[194:195], v17 offset:33792
  v_mfma_f32_32x32x16_bf16 v[160:175], v[188:191], v[196:199], v[160:175]
  s_add_u32 s38, s39, 5
  s_lshl_b32 s30, s38, 7
  s_add_u32 m0, s29, 32768
  s_cbranch_vccnz p1_kernel_v_cm_65
  v_mfma_f32_32x32x16_bf16 v[28:43], v[44:47], v[196:199], v[28:43]
p1_kernel_v_cm_65:
  s_waitcnt lgkmcnt(0)
  v_mfma_f32_32x32x16_bf16 v[144:159], v[176:179], v[192:195], v[144:159]
  ds_read_b128 v[184:187], v13 offset:32768
  ds_read_b128 v[188:191], v13 offset:36864
  ds_read_b64_tr_b16 v[196:197], v17 offset:36864
  ds_read_b64_tr_b16 v[198:199], v17 offset:37888
  v_mfma_f32_32x32x16_bf16 v[160:175], v[180:183], v[192:195], v[160:175]
  s_mul_i32 s31, s38, 245760
  buffer_load_dwordx4 v4, s[8:11], s30 offen lds
  s_add_u32 m0, s29, 33792
  s_nop 0
  s_cbranch_vccnz p1_kernel_v_cm_66
  v_mfma_f32_32x32x16_bf16 v[28:43], v[44:47], v[192:195], v[28:43]
p1_kernel_v_cm_66:
  s_waitcnt lgkmcnt(0)
  v_mfma_f32_32x32x16_bf16 v[144:159], v[184:187], v[196:199], v[144:159]
  ds_read_b128 v[176:179], v14 offset:32768
  ds_read_b128 v[180:183], v14 offset:36864
  ds_read_b64_tr_b16 v[192:193], v17 offset:40960
  ds_read_b64_tr_b16 v[194:195], v17 offset:41984
  v_mfma_f32_32x32x16_bf16 v[160:175], v[188:191], v[196:199], v[160:175]
  buffer_load_dwordx4 v5, s[8:11], s30 offen lds
  s_add_u32 m0, s29, 49152
  s_nop 0
  s_cbranch_vccnz p1_kernel_v_cm_67
  v_mfma_f32_32x32x16_bf16 v[28:43], v[44:47], v[196:199], v[28:43]
p1_kernel_v_cm_67:
  s_waitcnt lgkmcnt(0)
  v_mfma_f32_32x32x16_bf16 v[144:159], v[176:179], v[192:195], v[144:159]
  ds_read_b128 v[184:187], v15 offset:32768
  ds_read_b128 v[188:191], v15 offset:36864
  ds_read_b64_tr_b16 v[196:197], v17 offset:45056
  ds_read_b64_tr_b16 v[198:199], v17 offset:46080
  v_mfma_f32_32x32x16_bf16 v[160:175], v[180:183], v[192:195], v[160:175]
  buffer_load_dwordx4 v6, s[12:15], s31 offen lds
  s_add_u32 m0, s29, 50176
  s_nop 0
  buffer_load_dwordx4 v7, s[12:15], s31 offen lds
  s_cbranch_vccnz p1_kernel_v_cm_68
  v_mfma_f32_32x32x16_bf16 v[28:43], v[44:47], v[192:195], v[28:43]
p1_kernel_v_cm_68:
  s_waitcnt lgkmcnt(0)
  s_waitcnt vmcnt(4)
  s_barrier
  v_mfma_f32_32x32x16_bf16 v[144:159], v[184:187], v[196:199], v[144:159]
  ds_read_b128 v[176:179], v8 offset:0
  ds_read_b128 v[180:183], v8 offset:4096
  ds_read_b64_tr_b16 v[192:193], v16 offset:0
  ds_read_b64_tr_b16 v[194:195], v16 offset:1024
  v_mfma_f32_32x32x16_bf16 v[160:175], v[188:191], v[196:199], v[160:175]
  s_add_u32 s38, s39, 1
  s_cmp_ge_u32 s38, 5
  s_cselect_b32 s100, 5, 0
  s_sub_u32 s38, s38, s100
  s_cbranch_vccnz p1_kernel_v_cm_69
  v_mfma_f32_32x32x16_bf16 v[28:43], v[44:47], v[196:199], v[28:43]
p1_kernel_v_cm_69:
  s_waitcnt lgkmcnt(0)
  v_mfma_f32_32x32x16_bf16 v[144:159], v[176:179], v[192:195], v[144:159]
  ds_read_b128 v[184:187], v9 offset:0
  ds_read_b128 v[188:191], v9 offset:4096
  ds_read_b64_tr_b16 v[196:197], v16 offset:4096
  ds_read_b64_tr_b16 v[198:199], v16 offset:5120
  s_add_u32 s38, s38, 5
  v_mfma_f32_32x32x16_bf16 v[160:175], v[180:183], v[192:195], v[160:175]
  s_lshl_b32 s30, s38, 7
  s_add_u32 m0, s29, 65536
  s_mul_i32 s31, s38, 245760
  buffer_load_dwordx4 v4, s[8:11], s30 offen lds
  s_cbranch_vccnz p1_kernel_v_cm_70
  v_mfma_f32_32x32x16_bf16 v[28:43], v[44:47], v[192:195], v[28:43]
p1_kernel_v_cm_70:
  s_waitcnt lgkmcnt(0)
  v_mfma_f32_32x32x16_bf16 v[144:159], v[184:187], v[196:199], v[144:159]
  ds_read_b128 v[176:179], v10 offset:0
  ds_read_b128 v[180:183], v10 offset:4096
  ds_read_b64_tr_b16 v[192:193], v16 offset:8192
  ds_read_b64_tr_b16 v[194:195], v16 offset:9216
  v_mfma_f32_32x32x16_bf16 v[160:175], v[188:191], v[196:199], v[160:175]
  s_add_u32 m0, s29, 66560
  s_nop 0
  buffer_load_dwordx4 v5, s[8:11], s30 offen lds
  s_cbranch_vccnz p1_kernel_v_cm_71
  v_mfma_f32_32x32x16_bf16 v[28:43], v[44:47], v[196:199], v[28:43]
p1_kernel_v_cm_71:
  s_waitcnt lgkmcnt(0)
  v_mfma_f32_32x32x16_bf16 v[144:159], v[176:179], v[192:195], v[144:159]
  ds_read_b128 v[184:187], v11 offset:0
  ds_read_b128 v[188:191], v11 offset:4096
  ds_read_b64_tr_b16 v[196:197], v16 offset:12288
  ds_read_b64_tr_b16 v[198:199], v16 offset:13312
  s_add_u32 m0, s29, 81920
  v_mfma_f32_32x32x16_bf16 v[160:175], v[180:183], v[192:195], v[160:175]
  s_nop 0
  buffer_load_dwordx4 v6, s[12:15], s31 offen lds
  s_add_u32 m0, s29, 82944
  s_nop 0
  buffer_load_dwordx4 v7, s[12:15], s31 offen lds
  s_cbranch_vccnz p1_kernel_v_cm_72
  v_mfma_f32_32x32x16_bf16 v[28:43], v[44:47], v[192:195], v[28:43]
p1_kernel_v_cm_72:
  s_waitcnt lgkmcnt(0)
  s_waitcnt vmcnt(4)
  s_barrier
  v_mfma_f32_32x32x16_bf16 v[144:159], v[184:187], v[196:199], v[144:159]
  ds_read_b128 v[176:179], v8 offset:32768
  ds_read_b128 v[180:183], v8 offset:36864
  ds_read_b64_tr_b16 v[192:193], v16 offset:32768
  ds_read_b64_tr_b16 v[194:195], v16 offset:33792
  v_mfma_f32_32x32x16_bf16 v[160:175], v[188:191], v[196:199], v[160:175]
  s_add_u32 s38, s39, 2
  s_cmp_ge_u32 s38, 5
  s_cselect_b32 s100, 5, 0
  s_sub_u32 s38, s38, s100
  s_cbranch_vccnz p1_kernel_v_cm_73
  v_mfma_f32_32x32x16_bf16 v[28:43], v[44:47], v[196:199], v[28:43]
p1_kernel_v_cm_73:
  s_waitcnt lgkmcnt(0)
  v_mfma_f32_32x32x16_bf16 v[144:159], v[176:179], v[192:195], v[144:159]
  ds_read_b128 v[184:187], v9 offset:32768
  ds_read_b128 v[188:191], v9 offset:36864
  ds_read_b64_tr_b16 v[196:197], v16 offset:36864
  ds_read_b64_tr_b16 v[198:199], v16 offset:37888
  s_add_u32 s38, s38, 5
  v_mfma_f32_32x32x16_bf16 v[160:175], v[180:183], v[192:195], v[160:175]
  s_lshl_b32 s30, s38, 7
  s_add_u32 m0, s29, 98304
  s_mul_i32 s31, s38, 245760
  buffer_load_dwordx4 v4, s[8:11], s30 offen lds
  s_cbranch_vccnz p1_kernel_v_cm_74
  v_mfma_f32_32x32x16_bf16 v[28:43], v[44:47], v[192:195], v[28:43]
p1_kernel_v_cm_74:
  s_waitcnt lgkmcnt(0)
  v_mfma_f32_32x32x16_bf16 v[144:159], v[184:187], v[196:199], v[144:159]
  ds_read_b128 v[176:179], v10 offset:32768
  ds_read_b128 v[180:183], v10 offset:36864
  ds_read_b64_tr_b16 v[192:193], v16 offset:40960
  ds_read_b64_tr_b16 v[194:195], v16 offset:41984
  v_mfma_f32_32x32x16_bf16 v[160:175], v[188:191], v[196:199], v[160:175]
  s_add_u32 m0, s29, 99328
  s_nop 0
  buffer_load_dwordx4 v5, s[8:11], s30 offen lds
  s_cbranch_vccnz p1_kernel_v_cm_75
  v_mfma_f32_32x32x16_bf16 v[28:43], v[44:47], v[196:199], v[28:43]
p1_kernel_v_cm_75:
  s_waitcnt lgkmcnt(0)
  v_mfma_f32_32x32x16_bf16 v[144:159], v[176:179], v[192:195], v[144:159]
  ds_read_b128 v[184:187], v11 offset:32768
  ds_read_b128 v[188:191], v11 offset:36864
  ds_read_b64_tr_b16 v[196:197], v16 offset:45056
  ds_read_b64_tr_b16 v[198:199], v16 offset:46080
  s_add_u32 m0, s29, 114688
  v_mfma_f32_32x32x16_bf16 v[160:175], v[180:183], v[192:195], v[160:175]
  s_nop 0
  buffer_load_dwordx4 v6, s[12:15], s31 offen lds
  s_add_u32 m0, s29, 115712
  s_nop 0
  buffer_load_dwordx4 v7, s[12:15], s31 offen lds
  s_cbranch_vccnz p1_kernel_v_cm_76
  v_mfma_f32_32x32x16_bf16 v[28:43], v[44:47], v[192:195], v[28:43]
p1_kernel_v_cm_76:
  s_waitcnt lgkmcnt(0)
  s_waitcnt vmcnt(4)
  s_barrier
  v_mfma_f32_32x32x16_bf16 v[144:159], v[184:187], v[196:199], v[144:159]
  ds_read_b128 v[176:179], v12 offset:0
  ds_read_b128 v[180:183], v12 offset:4096
  ds_read_b64_tr_b16 v[192:193], v17 offset:0
  ds_read_b64_tr_b16 v[194:195], v17 offset:1024
  v_mfma_f32_32x32x16_bf16 v[160:175], v[188:191], v[196:199], v[160:175]
  s_add_u32 s38, s39, 3
  s_cmp_ge_u32 s38, 5
  s_cselect_b32 s100, 5, 0
  s_sub_u32 s38, s38, s100
  s_cbranch_vccnz p1_kernel_v_cm_77
  v_mfma_f32_32x32x16_bf16 v[28:43], v[44:47], v[196:199], v[28:43]
p1_kernel_v_cm_77:
  s_waitcnt lgkmcnt(0)
  v_mfma_f32_32x32x16_bf16 v[144:159], v[176:179], v[192:195], v[144:159]
  ds_read_b128 v[184:187], v13 offset:0
  ds_read_b128 v[188:191], v13 offset:4096
  ds_read_b64_tr_b16 v[196:197], v17 offset:4096
  ds_read_b64_tr_b16 v[198:199], v17 offset:5120
  s_add_u32 s38, s38, 5
  v_mfma_f32_32x32x16_bf16 v[160:175], v[180:183], v[192:195], v[160:175]
  s_lshl_b32 s30, s38, 7
  s_add_u32 m0, s29, 0
  s_mul_i32 s31, s38, 245760
  buffer_load_dwordx4 v4, s[8:11], s30 offen lds
  s_cbranch_vccnz p1_kernel_v_cm_78
  v_mfma_f32_32x32x16_bf16 v[28:43], v[44:47], v[192:195], v[28:43]
p1_kernel_v_cm_78:
  s_waitcnt lgkmcnt(0)
  v_mfma_f32_32x32x16_bf16 v[144:159], v[184:187], v[196:199], v[144:159]
  ds_read_b128 v[176:179], v14 offset:0
  ds_read_b128 v[180:183], v14 offset:4096
  ds_read_b64_tr_b16 v[192:193], v17 offset:8192
  ds_read_b64_tr_b16 v[194:195], v17 offset:9216
  v_mfma_f32_32x32x16_bf16 v[160:175], v[188:191], v[196:199], v[160:175]
  s_add_u32 m0, s29, 1024
  s_nop 0
  buffer_load_dwordx4 v5, s[8:11], s30 offen lds
  s_cbranch_vccnz p1_kernel_v_cm_79
  v_mfma_f32_32x32x16_bf16 v[28:43], v[44:47], v[196:199], v[28:43]
p1_kernel_v_cm_79:
  s_waitcnt lgkmcnt(0)
  v_mfma_f32_32x32x16_bf16 v[144:159], v[176:179], v[192:195], v[144:159]
  ds_read_b128 v[184:187], v15 offset:0
  ds_read_b128 v[188:191], v15 offset:4096
  ds_read_b64_tr_b16 v[196:197], v17 offset:12288
  ds_read_b64_tr_b16 v[198:199], v17 offset:13312
  s_add_u32 m0, s29, 16384
  v_mfma_f32_32x32x16_bf16 v[160:175], v[180:183], v[192:195], v[160:175]
  s_nop 0
  buffer_load_dwordx4 v6, s[12:15], s31 offen lds
  s_add_u32 m0, s29, 17408
  s_nop 0
  buffer_load_dwordx4 v7, s[12:15], s31 offen lds
  s_cbranch_vccnz p1_kernel_v_cm_80
  v_mfma_f32_32x32x16_bf16 v[28:43], v[44:47], v[192:195], v[28:43]
p1_kernel_v_cm_80:
  s_waitcnt lgkmcnt(0)
  s_waitcnt vmcnt(4)
  s_barrier
  s_add_u32 s38, s39, 4
  s_cmp_ge_u32 s38, 5
  s_cselect_b32 s100, 5, 0
  s_sub_u32 s38, s38, s100
  s_add_u32 s38, s38, 5
  s_lshl_b32 s30, s38, 7
  s_add_u32 m0, s29, 32768
  s_mul_i32 s31, s38, 245760
  buffer_load_dwordx4 v4, s[8:11], s30 offen lds
  s_add_u32 m0, s29, 33792
  s_nop 0
  buffer_load_dwordx4 v5, s[8:11], s30 offen lds
  s_add_u32 m0, s29, 49152
  s_nop 0
  buffer_load_dwordx4 v6, s[12:15], s31 offen lds
  s_add_u32 m0, s29, 50176
  s_nop 0
  buffer_load_dwordx4 v7, s[12:15], s31 offen lds
  s_cmp_eq_u32 s22, 0
  s_cbranch_scc0 p1_kernel_v_fl_81
  s_and_b32 s32, s20, 12
  s_add_u32 s32, s32, 16
  v_mov_b32 v128, s32
  v_cmp_eq_u32 vcc, 1, v1
  v_mov_b32 v143, 0
  s_nop 0
  v_cndmask_b32 v128, v128, v143, vcc
  s_cmp_eq_u32 s23, 1
  s_cselect_b64 vcc, -1, 0
  buffer_load_dword v128, v128, s[40:43], 0 offen sc1
p1_kernel_v_fl_81:
  v_mfma_f32_32x32x16_bf16 v[144:159], v[184:187], v[196:199], v[144:159]
  ds_read_b128 v[176:179], v12 offset:32768
  ds_read_b128 v[180:183], v12 offset:36864
  v_mfma_f32_32x32x16_bf16 v[160:175], v[188:191], v[196:199], v[160:175]
  ds_read_b64_tr_b16 v[192:193], v17 offset:32768
  ds_read_b64_tr_b16 v[194:195], v17 offset:33792
  s_cbranch_vccnz p1_kernel_v_cm_82
  v_mfma_f32_32x32x16_bf16 v[28:43], v[44:47], v[196:199], v[28:43]
p1_kernel_v_cm_82:
  s_waitcnt lgkmcnt(0)
  v_mfma_f32_32x32x16_bf16 v[144:159], v[176:179], v[192:195], v[144:159]
  ds_read_b128 v[184:187], v13 offset:32768
  ds_read_b128 v[188:191], v13 offset:36864
  v_mfma_f32_32x32x16_bf16 v[160:175], v[180:183], v[192:195], v[160:175]
  ds_read_b64_tr_b16 v[196:197], v17 offset:36864
  ds_read_b64_tr_b16 v[198:199], v17 offset:37888
  s_cbranch_vccnz p1_kernel_v_cm_83
  v_mfma_f32_32x32x16_bf16 v[28:43], v[44:47], v[192:195], v[28:43]
p1_kernel_v_cm_83:
  s_waitcnt lgkmcnt(0)
  v_mfma_f32_32x32x16_bf16 v[144:159], v[184:187], v[196:199], v[144:159]
  ds_read_b128 v[176:179], v14 offset:32768
  ds_read_b128 v[180:183], v14 offset:36864
  v_mfma_f32_32x32x16_bf16 v[160:175], v[188:191], v[196:199], v[160:175]
  ds_read_b64_tr_b16 v[192:193], v17 offset:40960
  ds_read_b64_tr_b16 v[194:195], v17 offset:41984
  s_cbranch_vccnz p1_kernel_v_cm_84
  v_mfma_f32_32x32x16_bf16 v[28:43], v[44:47], v[196:199], v[28:43]
p1_kernel_v_cm_84:
  s_waitcnt lgkmcnt(0)
  v_mfma_f32_32x32x16_bf16 v[144:159], v[176:179], v[192:195], v[144:159]
  ds_read_b128 v[184:187], v15 offset:32768
  ds_read_b128 v[188:191], v15 offset:36864
  v_mfma_f32_32x32x16_bf16 v[160:175], v[180:183], v[192:195], v[160:175]
  ds_read_b64_tr_b16 v[196:197], v17 offset:45056
  ds_read_b64_tr_b16 v[198:199], v17 offset:46080
  s_cbranch_vccnz p1_kernel_v_cm_85
  v_mfma_f32_32x32x16_bf16 v[28:43], v[44:47], v[192:195], v[28:43]
p1_kernel_v_cm_85:
  s_waitcnt lgkmcnt(0)
  s_cmp_eq_u32 s22, 0
  s_cbranch_scc1 p1_kernel_v_wa_86
  s_waitcnt vmcnt(4)
  s_branch p1_kernel_v_wb_87
p1_kernel_v_wa_86:
  s_waitcnt vmcnt(5)
p1_kernel_v_wb_87:
  s_barrier
  v_mfma_f32_32x32x16_bf16 v[144:159], v[184:187], v[196:199], v[144:159]
  ds_read_b128 v[176:179], v8 offset:0
  ds_read_b128 v[180:183], v8 offset:4096
  v_mfma_f32_32x32x16_bf16 v[160:175], v[188:191], v[196:199], v[160:175]
  ds_read_b64_tr_b16 v[192:193], v16 offset:0
  ds_read_b64_tr_b16 v[194:195], v16 offset:1024
  s_cbranch_vccnz p1_kernel_v_cm_88
  v_mfma_f32_32x32x16_bf16 v[28:43], v[44:47], v[196:199], v[28:43]
p1_kernel_v_cm_88:
  s_waitcnt lgkmcnt(0)
  v_mfma_f32_32x32x16_bf16 v[144:159], v[176:179], v[192:195], v[144:159]
  ds_read_b128 v[184:187], v9 offset:0
  ds_read_b128 v[188:191], v9 offset:4096
  v_mfma_f32_32x32x16_bf16 v[160:175], v[180:183], v[192:195], v[160:175]
  ds_read_b64_tr_b16 v[196:197], v16 offset:4096
  ds_read_b64_tr_b16 v[198:199], v16 offset:5120
  s_cbranch_vccnz p1_kernel_v_cm_89
  v_mfma_f32_32x32x16_bf16 v[28:43], v[44:47], v[192:195], v[28:43]
p1_kernel_v_cm_89:
  s_waitcnt lgkmcnt(0)
  v_mfma_f32_32x32x16_bf16 v[144:159], v[184:187], v[196:199], v[144:159]
  ds_read_b128 v[176:179], v10 offset:0
  ds_read_b128 v[180:183], v10 offset:4096
  v_mfma_f32_32x32x16_bf16 v[160:175], v[188:191], v[196:199], v[160:175]
  ds_read_b64_tr_b16 v[192:193], v16 offset:8192
  ds_read_b64_tr_b16 v[194:195], v16 offset:9216
  s_cbranch_vccnz p1_kernel_v_cm_90
  v_mfma_f32_32x32x16_bf16 v[28:43], v[44:47], v[196:199], v[28:43]
p1_kernel_v_cm_90:
  s_waitcnt lgkmcnt(0)
  v_mfma_f32_32x32x16_bf16 v[144:159], v[176:179], v[192:195], v[144:159]
  ds_read_b128 v[184:187], v11 offset:0
  ds_read_b128 v[188:191], v11 offset:4096
  v_mfma_f32_32x32x16_bf16 v[160:175], v[180:183], v[192:195], v[160:175]
  ds_read_b64_tr_b16 v[196:197], v16 offset:12288
  ds_read_b64_tr_b16 v[198:199], v16 offset:13312
  s_cbranch_vccnz p1_kernel_v_cm_91
  v_mfma_f32_32x32x16_bf16 v[28:43], v[44:47], v[192:195], v[28:43]
p1_kernel_v_cm_91:
  s_waitcnt lgkmcnt(0)
  s_waitcnt vmcnt(0)
  s_cmp_eq_u32 s22, 0
  s_cbranch_scc0 p1_kernel_v_pe_92
  v_readlane_b32 s101, v128, 1
  v_readfirstlane_b32 s32, v128
  s_and_b32 s33, s20, 3
  s_lshl_b32 s33, s33, 3
  s_lshr_b32 s32, s32, s33
  s_and_b32 s44, s32, 1
  v_mov_b32 v142, 131072
  v_mov_b32 v143, s44
  ds_write_b32 v142, v143
  s_waitcnt lgkmcnt(0)
p1_kernel_v_pe_92:
  s_barrier
  v_mov_b32 v142, 131072
  ds_read_b32 v143, v142
  s_waitcnt lgkmcnt(0)
  v_readfirstlane_b32 s44, v143
  s_lshl_b32 s45, s20, 10
  s_add_u32 s45, s45, 0x1b80000
  s_cmp_eq_u32 s44, 1
  s_cselect_b32 s45, s45, 0
  v_and_b32 v142, 127, v0
  v_lshlrev_b32 v143, 3, v142
  buffer_load_dwordx2 v[130:131], v143, s[16:19], s45 offen sc1
  v_mfma_f32_32x32x16_bf16 v[144:159], v[184:187], v[196:199], v[144:159]
  ds_read_b128 v[176:179], v8 offset:32768
  ds_read_b128 v[180:183], v8 offset:36864
  v_mfma_f32_32x32x16_bf16 v[160:175], v[188:191], v[196:199], v[160:175]
  ds_read_b64_tr_b16 v[192:193], v16 offset:32768
  ds_read_b64_tr_b16 v[194:195], v16 offset:33792
  s_cbranch_vccnz p1_kernel_v_cm_93
  v_mfma_f32_32x32x16_bf16 v[28:43], v[44:47], v[196:199], v[28:43]
p1_kernel_v_cm_93:
  s_waitcnt lgkmcnt(0)
  v_mfma_f32_32x32x16_bf16 v[144:159], v[176:179], v[192:195], v[144:159]
  ds_read_b128 v[184:187], v9 offset:32768
  ds_read_b128 v[188:191], v9 offset:36864
  v_mfma_f32_32x32x16_bf16 v[160:175], v[180:183], v[192:195], v[160:175]
  ds_read_b64_tr_b16 v[196:197], v16 offset:36864
  ds_read_b64_tr_b16 v[198:199], v16 offset:37888
  s_cbranch_vccnz p1_kernel_v_cm_94
  v_mfma_f32_32x32x16_bf16 v[28:43], v[44:47], v[192:195], v[28:43]
p1_kernel_v_cm_94:
  s_waitcnt lgkmcnt(0)
  v_mfma_f32_32x32x16_bf16 v[144:159], v[184:187], v[196:199], v[144:159]
  ds_read_b128 v[176:179], v10 offset:32768
  ds_read_b128 v[180:183], v10 offset:36864
  v_mfma_f32_32x32x16_bf16 v[160:175], v[188:191], v[196:199], v[160:175]
  ds_read_b64_tr_b16 v[192:193], v16 offset:40960
  ds_read_b64_tr_b16 v[194:195], v16 offset:41984
  s_cbranch_vccnz p1_kernel_v_cm_95
  v_mfma_f32_32x32x16_bf16 v[28:43], v[44:47], v[196:199], v[28:43]
p1_kernel_v_cm_95:
  s_waitcnt lgkmcnt(0)
  v_mfma_f32_32x32x16_bf16 v[144:159], v[176:179], v[192:195], v[144:159]
  ds_read_b128 v[184:187], v11 offset:32768
  ds_read_b128 v[188:191], v11 offset:36864
  v_mfma_f32_32x32x16_bf16 v[160:175], v[180:183], v[192:195], v[160:175]
  ds_read_b64_tr_b16 v[196:197], v16 offset:45056
  ds_read_b64_tr_b16 v[198:199], v16 offset:46080
  s_cbranch_vccnz p1_kernel_v_cm_96
  v_mfma_f32_32x32x16_bf16 v[28:43], v[44:47], v[192:195], v[28:43]
p1_kernel_v_cm_96:
  s_waitcnt lgkmcnt(0)
  v_mfma_f32_32x32x16_bf16 v[144:159], v[184:187], v[196:199], v[144:159]
  v_mfma_f32_32x32x16_bf16 v[160:175], v[188:191], v[196:199], v[160:175]
  s_cbranch_vccnz p1_kernel_v_cm_97
  v_mfma_f32_32x32x16_bf16 v[28:43], v[44:47], v[196:199], v[28:43]
p1_kernel_v_cm_97:
  s_waitcnt vmcnt(0)
  s_cmp_eq_u32 s44, 1
  s_cbranch_scc1 p1_kernel_v_ok_98
  s_mov_b32 s48, 0
p1_kernel_v_spin_99:
  s_and_b32 s32, s20, 12
  s_add_u32 s32, s32, 16
  v_mov_b32 v128, s32
  v_cmp_eq_u32 vcc, 1, v1
  v_mov_b32 v143, 0
  s_nop 0
  v_cndmask_b32 v128, v128, v143, vcc
  s_cmp_eq_u32 s23, 1
  s_cselect_b64 vcc, -1, 0
  buffer_load_dword v128, v128, s[40:43], 0 offen sc1
  s_waitcnt vmcnt(0)
  v_readlane_b32 s101, v128, 1
  v_readfirstlane_b32 s32, v128
  s_and_b32 s33, s20, 3
  s_lshl_b32 s33, s33, 3
  s_lshr_b32 s32, s32, s33
  s_and_b32 s44, s32, 1
  s_cmp_eq_u32 s44, 1
  s_cbranch_scc1 p1_kernel_v_got_100
  s_sleep 2
  s_add_u32 s48, s48, 1
  s_cmp_lt_u32 s48, 0x40000
  s_cbranch_scc1 p1_kernel_v_spin_99
  s_mov_b32 s44, 1
p1_kernel_v_got_100:
  s_lshl_b32 s45, s20, 10
  s_add_u32 s45, s45, 0x1b80000
  s_cmp_eq_u32 s44, 1
  s_cselect_b32 s45, s45, 0
  v_and_b32 v142, 127, v0
  v_lshlrev_b32 v143, 3, v142
  buffer_load_dwordx2 v[130:131], v143, s[16:19], s45 offen sc1
  s_waitcnt vmcnt(0)
p1_kernel_v_ok_98:
  s_lshl_b32 s32, s28, 12
  v_lshl_add_u32 v137, v1, 4, s32
  s_cmp_eq_u32 s23, 0
  s_cbranch_scc0 p1_kernel_csw_101
  ds_write_b128 v137, v[28:31] offset:16384
  ds_write_b128 v137, v[32:35] offset:17408
  ds_write_b128 v137, v[36:39] offset:18432
  ds_write_b128 v137, v[40:43] offset:19456
p1_kernel_csw_101:
  s_cmp_ge_u32 s22, 2
  s_cbranch_scc1 p1_kernel_redc_102
  v_lshlrev_b32 v136, 3, v0
  ds_write_b64 v136, v[130:131] offset:10240
p1_kernel_redc_102:
  s_waitcnt lgkmcnt(0)
  s_barrier
  s_cmp_eq_u32 s23, 1
  s_cbranch_scc0 p1_kernel_csr_103
  ds_read_b128 v[28:31], v137 offset:16384
  ds_read_b128 v[32:35], v137 offset:17408
  ds_read_b128 v[36:39], v137 offset:18432
  ds_read_b128 v[40:43], v137 offset:19456
  s_waitcnt lgkmcnt(0)
p1_kernel_csr_103:
  s_lshl_b32 s32, s28, 5
  v_add_u32 v136, s32, v2
  v_mov_b32 v24, v28
  s_sub_u32 s33, s21, 10
  s_lshl_b32 s33, s33, 7
  v_add_u32 v136, s33, v136
  v_mul_u32_u24 v138, 3277, v136
  v_lshrrev_b32 v138, 16, v138
  v_mul_u32_u24 v139, 20, v138
  v_sub_u32 v136, v136, v139
  v_mul_u32_u24 v138, 81920, v138
  v_lshl_add_u32 v138, v136, 4, v138
  v_mul_u32_u24 v139, 320, v3
  v_add_u32 v138, v138, v139
  s_lshl_b32 s32, s20, 2
  s_lshl_b32 s33, s23, 1
  s_add_u32 s32, s32, s33
  s_mul_i32 s32, s32, 1280
  s_add_u32 s32, s32, 0x500000
  v_add_u32 v138, s32, v138
  s_lshl_b32 s32, s23, 9
  v_lshl_add_u32 v140, v3, 5, s32
  ds_read_b128 v[176:179], v140 offset:10240
  ds_read_b128 v[180:183], v140 offset:10256
  ds_read_b128 v[184:187], v140 offset:10304
  ds_read_b128 v[188:191], v140 offset:10320
  s_waitcnt lgkmcnt(0)
  v_fma_f32 v144, -v176, v24, v144
  v_fma_f32 v145, -v178, v24, v145
  v_fma_f32 v146, -v180, v24, v146
  v_fma_f32 v147, -v182, v24, v147
  v_mul_f32 v144, v177, v144
  v_mul_f32 v145, v179, v145
  v_mul_f32 v146, v181, v146
  v_mul_f32 v147, v183, v147
  v_fma_f32 v148, -v184, v24, v148
  v_fma_f32 v149, -v186, v24, v149
  v_fma_f32 v150, -v188, v24, v150
  v_fma_f32 v151, -v190, v24, v151
  v_mul_f32 v148, v185, v148
  v_mul_f32 v149, v187, v149
  v_mul_f32 v150, v189, v150
  v_mul_f32 v151, v191, v151
  v_cvt_pk_bf16_f32 v144, v144, v145
  v_cvt_pk_bf16_f32 v145, v146, v147
  v_cvt_pk_bf16_f32 v146, v148, v149
  v_cvt_pk_bf16_f32 v147, v150, v151
  buffer_store_dwordx4 v[144:147], v138, s[16:19], 0 offen offset:0 sc1
  ds_read_b128 v[176:179], v140 offset:10368
  ds_read_b128 v[180:183], v140 offset:10384
  ds_read_b128 v[184:187], v140 offset:10432
  ds_read_b128 v[188:191], v140 offset:10448
  s_waitcnt lgkmcnt(0)
  v_fma_f32 v152, -v176, v24, v152
  v_fma_f32 v153, -v178, v24, v153
  v_fma_f32 v154, -v180, v24, v154
  v_fma_f32 v155, -v182, v24, v155
  v_mul_f32 v152, v177, v152
  v_mul_f32 v153, v179, v153
  v_mul_f32 v154, v181, v154
  v_mul_f32 v155, v183, v155
  v_fma_f32 v156, -v184, v24, v156
  v_fma_f32 v157, -v186, v24, v157
  v_fma_f32 v158, -v188, v24, v158
  v_fma_f32 v159, -v190, v24, v159
  v_mul_f32 v156, v185, v156
  v_mul_f32 v157, v187, v157
  v_mul_f32 v158, v189, v158
  v_mul_f32 v159, v191, v159
  v_cvt_pk_bf16_f32 v152, v152, v153
  v_cvt_pk_bf16_f32 v153, v154, v155
  v_cvt_pk_bf16_f32 v154, v156, v157
  v_cvt_pk_bf16_f32 v155, v158, v159
  buffer_store_dwordx4 v[152:155], v138, s[16:19], 0 offen offset:640 sc1
  ds_read_b128 v[176:179], v140 offset:10496
  ds_read_b128 v[180:183], v140 offset:10512
  ds_read_b128 v[184:187], v140 offset:10560
  ds_read_b128 v[188:191], v140 offset:10576
  s_waitcnt lgkmcnt(0)
  v_fma_f32 v160, -v176, v24, v160
  v_fma_f32 v161, -v178, v24, v161
  v_fma_f32 v162, -v180, v24, v162
  v_fma_f32 v163, -v182, v24, v163
  v_mul_f32 v160, v177, v160
  v_mul_f32 v161, v179, v161
  v_mul_f32 v162, v181, v162
  v_mul_f32 v163, v183, v163
  v_fma_f32 v164, -v184, v24, v164
  v_fma_f32 v165, -v186, v24, v165
  v_fma_f32 v166, -v188, v24, v166
  v_fma_f32 v167, -v190, v24, v167
  v_mul_f32 v164, v185, v164
  v_mul_f32 v165, v187, v165
  v_mul_f32 v166, v189, v166
  v_mul_f32 v167, v191, v167
  v_cvt_pk_bf16_f32 v160, v160, v161
  v_cvt_pk_bf16_f32 v161, v162, v163
  v_cvt_pk_bf16_f32 v162, v164, v165
  v_cvt_pk_bf16_f32 v163, v166, v167
  buffer_store_dwordx4 v[160:163], v138, s[16:19], 0 offen offset:1280 sc1
  ds_read_b128 v[176:179], v140 offset:10624
  ds_read_b128 v[180:183], v140 offset:10640
  ds_read_b128 v[184:187], v140 offset:10688
  ds_read_b128 v[188:191], v140 offset:10704
  s_waitcnt lgkmcnt(0)
  v_fma_f32 v168, -v176, v24, v168
  v_fma_f32 v169, -v178, v24, v169
  v_fma_f32 v170, -v180, v24, v170
  v_fma_f32 v171, -v182, v24, v171
  v_mul_f32 v168, v177, v168
  v_mul_f32 v169, v179, v169
  v_mul_f32 v170, v181, v170
  v_mul_f32 v171, v183, v171
  v_fma_f32 v172, -v184, v24, v172
  v_fma_f32 v173, -v186, v24, v173
  v_fma_f32 v174, -v188, v24, v174
  v_fma_f32 v175, -v190, v24, v175
  v_mul_f32 v172, v185, v172
  v_mul_f32 v173, v187, v173
  v_mul_f32 v174, v189, v174
  v_mul_f32 v175, v191, v175
  v_cvt_pk_bf16_f32 v168, v168, v169
  v_cvt_pk_bf16_f32 v169, v170, v171
  v_cvt_pk_bf16_f32 v170, v172, v173
  v_cvt_pk_bf16_f32 v171, v174, v175
  buffer_store_dwordx4 v[168:171], v138, s[16:19], 0 offen offset:1920 sc1
p1_kernel_done:
  s_mul_i32 s32, s20, 15
  s_add_u32 s32, s32, s21
  s_mov_b32 s94, s32
  s_mov_b32 s95, 1
  s_branch p1_kernel_next
p1_kernel_idle:
  v_lshrrev_b32 v136, 4, v1
  s_lshl_b32 s32, s20, 7
  s_lshl_b32 s33, s22, 4
  s_add_u32 s47, s32, s33
  v_add_u32 v136, s47, v136
  v_mul_u32_u24 v136, 1280, v136
  v_and_b32 v137, 15, v1
  v_lshl_add_u32 v136, v137, 4, v136
  s_mov_b32 s32, 0
  buffer_load_dwordx4 v[48:51], v136, s[8:11], s32 offen offset:0
  buffer_load_dwordx4 v[52:55], v136, s[8:11], s32 offen offset:256
  buffer_load_dwordx4 v[56:59], v136, s[8:11], s32 offen offset:512
  buffer_load_dwordx4 v[60:63], v136, s[8:11], s32 offen offset:768
  buffer_load_dwordx4 v[64:67], v136, s[8:11], s32 offen offset:1024
  s_mov_b32 s32, 5120
  buffer_load_dwordx4 v[68:71], v136, s[8:11], s32 offen offset:0
  buffer_load_dwordx4 v[72:75], v136, s[8:11], s32 offen offset:256
  buffer_load_dwordx4 v[76:79], v136, s[8:11], s32 offen offset:512
  buffer_load_dwordx4 v[80:83], v136, s[8:11], s32 offen offset:768
  buffer_load_dwordx4 v[84:87], v136, s[8:11], s32 offen offset:1024
  s_mov_b32 s32, 10240
  buffer_load_dwordx4 v[88:91], v136, s[8:11], s32 offen offset:0
  buffer_load_dwordx4 v[92:95], v136, s[8:11], s32 offen offset:256
  buffer_load_dwordx4 v[96:99], v136, s[8:11], s32 offen offset:512
  buffer_load_dwordx4 v[100:103], v136, s[8:11], s32 offen offset:768
  buffer_load_dwordx4 v[104:107], v136, s[8:11], s32 offen offset:1024
  s_mov_b32 s32, 15360
  buffer_load_dwordx4 v[108:111], v136, s[8:11], s32 offen offset:0
  buffer_load_dwordx4 v[112:115], v136, s[8:11], s32 offen offset:256
  buffer_load_dwordx4 v[116:119], v136, s[8:11], s32 offen offset:512
  buffer_load_dwordx4 v[120:123], v136, s[8:11], s32 offen offset:768
  buffer_load_dwordx4 v[124:127], v136, s[8:11], s32 offen offset:1024
  v_mov_b32 v18, 0x3f803f80
  v_mov_b32 v144, 0
  v_mov_b32 v145, 0
  v_mov_b32 v146, 0
  v_mov_b32 v147, 0
  v_mov_b32 v148, 0
  v_mov_b32 v149, 0
  v_mov_b32 v150, 0
  v_mov_b32 v151, 0
  s_waitcnt vmcnt(15)
  v_dot2c_f32_bf16 v144, v48, v18
  v_dot2c_f32_bf16 v145, v48, v48
  v_dot2c_f32_bf16 v144, v49, v18
  v_dot2c_f32_bf16 v145, v49, v49
  v_dot2c_f32_bf16 v144, v50, v18
  v_dot2c_f32_bf16 v145, v50, v50
  v_dot2c_f32_bf16 v144, v51, v18
  v_dot2c_f32_bf16 v145, v51, v51
  v_dot2c_f32_bf16 v144, v52, v18
  v_dot2c_f32_bf16 v145, v52, v52
  v_dot2c_f32_bf16 v144, v53, v18
  v_dot2c_f32_bf16 v145, v53, v53
  v_dot2c_f32_bf16 v144, v54, v18
  v_dot2c_f32_bf16 v145, v54, v54
  v_dot2c_f32_bf16 v144, v55, v18
  v_dot2c_f32_bf16 v145, v55, v55
  v_dot2c_f32_bf16 v144, v56, v18
  v_dot2c_f32_bf16 v145, v56, v56
  v_dot2c_f32_bf16 v144, v57, v18
  v_dot2c_f32_bf16 v145, v57, v57
  v_dot2c_f32_bf16 v144, v58, v18
  v_dot2c_f32_bf16 v145, v58, v58
  v_dot2c_f32_bf16 v144, v59, v18
  v_dot2c_f32_bf16 v145, v59, v59
  v_dot2c_f32_bf16 v144, v60, v18
  v_dot2c_f32_bf16 v145, v60, v60
  v_dot2c_f32_bf16 v144, v61, v18
  v_dot2c_f32_bf16 v145, v61, v61
  v_dot2c_f32_bf16 v144, v62, v18
  v_dot2c_f32_bf16 v145, v62, v62
  v_dot2c_f32_bf16 v144, v63, v18
  v_dot2c_f32_bf16 v145, v63, v63
  v_dot2c_f32_bf16 v144, v64, v18
  v_dot2c_f32_bf16 v145, v64, v64
  v_dot2c_f32_bf16 v144, v65, v18
  v_dot2c_f32_bf16 v145, v65, v65
  v_dot2c_f32_bf16 v144, v66, v18
  v_dot2c_f32_bf16 v145, v66, v66
  v_dot2c_f32_bf16 v144, v67, v18
  v_dot2c_f32_bf16 v145, v67, v67
  s_waitcnt vmcnt(10)
  v_dot2c_f32_bf16 v146, v68, v18
  v_dot2c_f32_bf16 v147, v68, v68
  v_dot2c_f32_bf16 v146, v69, v18
  v_dot2c_f32_bf16 v147, v69, v69
  v_dot2c_f32_bf16 v146, v70, v18
  v_dot2c_f32_bf16 v147, v70, v70
  v_dot2c_f32_bf16 v146, v71, v18
  v_dot2c_f32_bf16 v147, v71, v71
  v_dot2c_f32_bf16 v146, v72, v18
  v_dot2c_f32_bf16 v147, v72, v72
  v_dot2c_f32_bf16 v146, v73, v18
  v_dot2c_f32_bf16 v147, v73, v73
  v_dot2c_f32_bf16 v146, v74, v18
  v_dot2c_f32_bf16 v147, v74, v74
  v_dot2c_f32_bf16 v146, v75, v18
  v_dot2c_f32_bf16 v147, v75, v75
  v_dot2c_f32_bf16 v146, v76, v18
  v_dot2c_f32_bf16 v147, v76, v76
  v_dot2c_f32_bf16 v146, v77, v18
  v_dot2c_f32_bf16 v147, v77, v77
  v_dot2c_f32_bf16 v146, v78, v18
  v_dot2c_f32_bf16 v147, v78, v78
  v_dot2c_f32_bf16 v146, v79, v18
  v_dot2c_f32_bf16 v147, v79, v79
  v_dot2c_f32_bf16 v146, v80, v18
  v_dot2c_f32_bf16 v147, v80, v80
  v_dot2c_f32_bf16 v146, v81, v18
  v_dot2c_f32_bf16 v147, v81, v81
  v_dot2c_f32_bf16 v146, v82, v18
  v_dot2c_f32_bf16 v147, v82, v82
  v_dot2c_f32_bf16 v146, v83, v18
  v_dot2c_f32_bf16 v147, v83, v83
  v_dot2c_f32_bf16 v146, v84, v18
  v_dot2c_f32_bf16 v147, v84, v84
  v_dot2c_f32_bf16 v146, v85, v18
  v_dot2c_f32_bf16 v147, v85, v85
  v_dot2c_f32_bf16 v146, v86, v18
  v_dot2c_f32_bf16 v147, v86, v86
  v_dot2c_f32_bf16 v146, v87, v18
  v_dot2c_f32_bf16 v147, v87, v87
  s_waitcnt vmcnt(5)
  v_dot2c_f32_bf16 v148, v88, v18
  v_dot2c_f32_bf16 v149, v88, v88
  v_dot2c_f32_bf16 v148, v89, v18
  v_dot2c_f32_bf16 v149, v89, v89
  v_dot2c_f32_bf16 v148, v90, v18
  v_dot2c_f32_bf16 v149, v90, v90
  v_dot2c_f32_bf16 v148, v91, v18
  v_dot2c_f32_bf16 v149, v91, v91
  v_dot2c_f32_bf16 v148, v92, v18
  v_dot2c_f32_bf16 v149, v92, v92
  v_dot2c_f32_bf16 v148, v93, v18
  v_dot2c_f32_bf16 v149, v93, v93
  v_dot2c_f32_bf16 v148, v94, v18
  v_dot2c_f32_bf16 v149, v94, v94
  v_dot2c_f32_bf16 v148, v95, v18
  v_dot2c_f32_bf16 v149, v95, v95
  v_dot2c_f32_bf16 v148, v96, v18
  v_dot2c_f32_bf16 v149, v96, v96
  v_dot2c_f32_bf16 v148, v97, v18
  v_dot2c_f32_bf16 v149, v97, v97
  v_dot2c_f32_bf16 v148, v98, v18
  v_dot2c_f32_bf16 v149, v98, v98
  v_dot2c_f32_bf16 v148, v99, v18
  v_dot2c_f32_bf16 v149, v99, v99
  v_dot2c_f32_bf16 v148, v100, v18
  v_dot2c_f32_bf16 v149, v100, v100
  v_dot2c_f32_bf16 v148, v101, v18
  v_dot2c_f32_bf16 v149, v101, v101
  v_dot2c_f32_bf16 v148, v102, v18
  v_dot2c_f32_bf16 v149, v102, v102
  v_dot2c_f32_bf16 v148, v103, v18
  v_dot2c_f32_bf16 v149, v103, v103
  v_dot2c_f32_bf16 v148, v104, v18
  v_dot2c_f32_bf16 v149, v104, v104
  v_dot2c_f32_bf16 v148, v105, v18
  v_dot2c_f32_bf16 v149, v105, v105
  v_dot2c_f32_bf16 v148, v106, v18
  v_dot2c_f32_bf16 v149, v106, v106
  v_dot2c_f32_bf16 v148, v107, v18
  v_dot2c_f32_bf16 v149, v107, v107
  s_waitcnt vmcnt(0)
  v_dot2c_f32_bf16 v150, v108, v18
  v_dot2c_f32_bf16 v151, v108, v108
  v_dot2c_f32_bf16 v150, v109, v18
  v_dot2c_f32_bf16 v151, v109, v109
  v_dot2c_f32_bf16 v150, v110, v18
  v_dot2c_f32_bf16 v151, v110, v110
  v_dot2c_f32_bf16 v150, v111, v18
  v_dot2c_f32_bf16 v151, v111, v111
  v_dot2c_f32_bf16 v150, v112, v18
  v_dot2c_f32_bf16 v151, v112, v112
  v_dot2c_f32_bf16 v150, v113, v18
  v_dot2c_f32_bf16 v151, v113, v113
  v_dot2c_f32_bf16 v150, v114, v18
  v_dot2c_f32_bf16 v151, v114, v114
  v_dot2c_f32_bf16 v150, v115, v18
  v_dot2c_f32_bf16 v151, v115, v115
  v_dot2c_f32_bf16 v150, v116, v18
  v_dot2c_f32_bf16 v151, v116, v116
  v_dot2c_f32_bf16 v150, v117, v18
  v_dot2c_f32_bf16 v151, v117, v117
  v_dot2c_f32_bf16 v150, v118, v18
  v_dot2c_f32_bf16 v151, v118, v118
  v_dot2c_f32_bf16 v150, v119, v18
  v_dot2c_f32_bf16 v151, v119, v119
  v_dot2c_f32_bf16 v150, v120, v18
  v_dot2c_f32_bf16 v151, v120, v120
  v_dot2c_f32_bf16 v150, v121, v18
  v_dot2c_f32_bf16 v151, v121, v121
  v_dot2c_f32_bf16 v150, v122, v18
  v_dot2c_f32_bf16 v151, v122, v122
  v_dot2c_f32_bf16 v150, v123, v18
  v_dot2c_f32_bf16 v151, v123, v123
  v_dot2c_f32_bf16 v150, v124, v18
  v_dot2c_f32_bf16 v151, v124, v124
  v_dot2c_f32_bf16 v150, v125, v18
  v_dot2c_f32_bf16 v151, v125, v125
  v_dot2c_f32_bf16 v150, v126, v18
  v_dot2c_f32_bf16 v151, v126, v126
  v_dot2c_f32_bf16 v150, v127, v18
  v_dot2c_f32_bf16 v151, v127, v127
  s_nop 2
  v_add_f32_dpp v144, v144, v144 row_ror:8 row_mask:0xf bank_mask:0xf
  v_add_f32_dpp v145, v145, v145 row_ror:8 row_mask:0xf bank_mask:0xf
  v_add_f32_dpp v146, v146, v146 row_ror:8 row_mask:0xf bank_mask:0xf
  v_add_f32_dpp v147, v147, v147 row_ror:8 row_mask:0xf bank_mask:0xf
  v_add_f32_dpp v148, v148, v148 row_ror:8 row_mask:0xf bank_mask:0xf
  v_add_f32_dpp v149, v149, v149 row_ror:8 row_mask:0xf bank_mask:0xf
  v_add_f32_dpp v150, v150, v150 row_ror:8 row_mask:0xf bank_mask:0xf
  v_add_f32_dpp v151, v151, v151 row_ror:8 row_mask:0xf bank_mask:0xf
  v_add_f32_dpp v144, v144, v144 row_ror:4 row_mask:0xf bank_mask:0xf
  v_add_f32_dpp v145, v145, v145 row_ror:4 row_mask:0xf bank_mask:0xf
  v_add_f32_dpp v146, v146, v146 row_ror:4 row_mask:0xf bank_mask:0xf
  v_add_f32_dpp v147, v147, v147 row_ror:4 row_mask:0xf bank_mask:0xf
  v_add_f32_dpp v148, v148, v148 row_ror:4 row_mask:0xf bank_mask:0xf
  v_add_f32_dpp v149, v149, v149 row_ror:4 row_mask:0xf bank_mask:0xf
  v_add_f32_dpp v150, v150, v150 row_ror:4 row_mask:0xf bank_mask:0xf
  v_add_f32_dpp v151, v151, v151 row_ror:4 row_mask:0xf bank_mask:0xf
  v_add_f32_dpp v144, v144, v144 row_ror:2 row_mask:0xf bank_mask:0xf
  v_add_f32_dpp v145, v145, v145 row_ror:2 row_mask:0xf bank_mask:0xf
  v_add_f32_dpp v146, v146, v146 row_ror:2 row_mask:0xf bank_mask:0xf
  v_add_f32_dpp v147, v147, v147 row_ror:2 row_mask:0xf bank_mask:0xf
  v_add_f32_dpp v148, v148, v148 row_ror:2 row_mask:0xf bank_mask:0xf
  v_add_f32_dpp v149, v149, v149 row_ror:2 row_mask:0xf bank_mask:0xf
  v_add_f32_dpp v150, v150, v150 row_ror:2 row_mask:0xf bank_mask:0xf
  v_add_f32_dpp v151, v151, v151 row_ror:2 row_mask:0xf bank_mask:0xf
  v_add_f32_dpp v144, v144, v144 row_ror:1 row_mask:0xf bank_mask:0xf
  v_add_f32_dpp v145, v145, v145 row_ror:1 row_mask:0xf bank_mask:0xf
  v_add_f32_dpp v146, v146, v146 row_ror:1 row_mask:0xf bank_mask:0xf
  v_add_f32_dpp v147, v147, v147 row_ror:1 row_mask:0xf bank_mask:0xf
  v_add_f32_dpp v148, v148, v148 row_ror:1 row_mask:0xf bank_mask:0xf
  v_add_f32_dpp v149, v149, v149 row_ror:1 row_mask:0xf bank_mask:0xf
  v_add_f32_dpp v150, v150, v150 row_ror:1 row_mask:0xf bank_mask:0xf
  v_add_f32_dpp v151, v151, v151 row_ror:1 row_mask:0xf bank_mask:0xf
  v_mul_f32 v144, 0x3acccccd, v144
  v_mul_f32 v145, 0x3acccccd, v145
  v_fma_f32 v145, -v144, v144, v145
  v_max_f32 v145, 0, v145
  v_add_f32 v145, 0x3727c5ac, v145
  v_rsq_f32 v145, v145
  v_mul_f32 v146, 0x3acccccd, v146
  v_mul_f32 v147, 0x3acccccd, v147
  v_fma_f32 v147, -v146, v146, v147
  v_max_f32 v147, 0, v147
  v_add_f32 v147, 0x3727c5ac, v147
  v_rsq_f32 v147, v147
  v_mul_f32 v148, 0x3acccccd, v148
  v_mul_f32 v149, 0x3acccccd, v149
  v_fma_f32 v149, -v148, v148, v149
  v_max_f32 v149, 0, v149
  v_add_f32 v149, 0x3727c5ac, v149
  v_rsq_f32 v149, v149
  v_mul_f32 v150, 0x3acccccd, v150
  v_mul_f32 v151, 0x3acccccd, v151
  v_fma_f32 v151, -v150, v150, v151
  v_max_f32 v151, 0, v151
  v_add_f32 v151, 0x3727c5ac, v151
  v_rsq_f32 v151, v151
  v_lshrrev_b32 v136, 4, v1
  v_lshlrev_b32 v136, 3, v136
  s_lshl_b32 s32, s47, 3
  s_add_u32 s32, s32, 0x1b80000
  s_mov_b32 exec_lo, 0x00010001
  s_mov_b32 exec_hi, 0x00010001
  buffer_store_dwordx2 v[144:145], v136, s[16:19], s32 offen offset:0 sc1
  buffer_store_dwordx2 v[146:147], v136, s[16:19], s32 offen offset:32 sc1
  buffer_store_dwordx2 v[148:149], v136, s[16:19], s32 offen offset:64 sc1
  buffer_store_dwordx2 v[150:151], v136, s[16:19], s32 offen offset:96 sc1
  s_mov_b64 exec, -1
  s_waitcnt vmcnt(0)
  s_barrier
  s_cmp_eq_u32 s22, 0
  s_cbranch_scc0 p1_kernel_idl_104
  v_mov_b32 v142, 0
  v_mov_b32 v143, 1
  s_mov_b64 exec, 1
  buffer_store_byte v143, v142, s[40:43], s20 offen offset:16 sc1
  s_mov_b64 exec, -1
p1_kernel_idl_104:
p1_kernel_next:
p1_kernel_CODE_END:
p2_kernel:
  s_load_dwordx2 s[24:25], s[0:1], 72
  s_load_dwordx2 s[64:65], s[0:1], 16
  s_load_dwordx4 s[68:71], s[0:1], 32
  s_load_dwordx2 s[66:67], s[0:1], 48
  s_and_b32 s32, s2, 7
  s_lshr_b32 s33, s2, 3
  s_lshl_b32 s20, s32, 2
  s_lshr_b32 s34, s33, 3
  s_add_u32 s20, s20, s34
  s_and_b32 s21, s33, 7
  v_lshrrev_b32 v14, 6, v0
  v_and_b32 v1, 63, v0
  v_readfirstlane_b32 s22, v14
  v_and_b32 v2, 31, v1
  v_lshrrev_b32 v3, 5, v1
  s_lshr_b32 s23, s22, 2
  s_and_b32 s28, s22, 3
  s_mov_b32 s42, 0xfffff
  s_mov_b32 s43, 0xfffff
  s_mov_b32 s44, 0xffff
  s_mov_b32 s45, 0
  v_lshlrev_b32 v4, 4, v1
  v_mov_b32 v5, v4
  v_mul_u32_u24 v14, 320, v3
  v_lshl_add_u32 v6, v2, 4, v14
  s_lshl_b32 s32, s20, 6
  s_lshl_b32 s33, s23, 5
  s_add_u32 s32, s32, s33
  s_add_u32 s32, s32, s28
  s_lshl_b32 s33, s32, 10
  s_add_u32 s48, s33, 0x280000
  s_sub_u32 s33, s32, s28
  s_lshl_b32 s33, s33, 8
  s_add_u32 s49, s33, 0x480000
  s_mul_i32 s33, s32, 1280
  s_add_u32 s50, s33, 0x500000
  s_mul_i32 s39, s23, 39936
  s_waitcnt lgkmcnt(0)
  s_mov_b32 s16, s24
  s_and_b32 s17, s25, 0xffff
  s_mov_b32 s18, 0x1c00000
  s_mov_b32 s19, 0x20000
  s_lshl_b32 s33, s28, 10
  s_add_u32 s54, s39, s33
  s_add_u32 s55, s39, 4096
  s_lshl_b32 s33, s28, 11
  s_add_u32 s56, s39, s33
  s_add_u32 s56, s56, 5120
  s_waitcnt lgkmcnt(0)
  s_cmp_eq_u32 s22, 0
  s_cbranch_scc0 p2_kernel_tag_1
  s_cmp_lg_u32 s101, 0
  s_cbranch_scc1 p2_kernel_tg_2
  s_mov_b32 s99, 0
p2_kernel_tgp_3:
  v_mov_b32 v14, 0
  buffer_load_dword v14, v14, s[88:91], 0 offen sc1
  s_waitcnt vmcnt(0)
  v_readfirstlane_b32 s101, v14
  s_add_u32 s99, s99, 1
  s_cmp_ge_u32 s99, 0x100000
  s_cbranch_scc1 p2_kernel_tg_2
  s_cmp_eq_u32 s101, 0
  s_cbranch_scc1 p2_kernel_tgp_3
p2_kernel_tg_2:
p2_kernel_tag_1:
  s_waitcnt vmcnt(0)
  s_barrier
  s_cmp_eq_u32 s22, 0
  s_cbranch_scc0 p2_kernel_pub_4
  s_cmp_eq_u32 s95, 1
  s_cbranch_scc0 p2_kernel_pub_4
  s_lshl_b32 s33, s94, 7
  s_add_u32 s33, s33, 0x1be0000
  v_mov_b32 v14, 0
  v_mov_b32 v15, s101
  s_mov_b64 exec, 1
  buffer_store_dword v15, v14, s[16:19], s33 offen sc1
  s_mov_b64 exec, -1
p2_kernel_pub_4:
  s_mov_b32 s95, 0
  v_cmp_gt_u32 vcc, 96, v0
  s_and_saveexec_b64 s[52:53], vcc
  s_cbranch_execz p2_kernel_ones_5
  v_lshrrev_b32 v14, 4, v0
  v_mul_u32_u24 v14, 13312, v14
  v_bfe_u32 v15, v0, 1, 3
  v_lshl_add_u32 v14, v15, 10, v14
  v_and_b32 v15, 1, v0
  v_lshl_add_u32 v14, v15, 9, v14
  v_mov_b32 v72, 0x3f803f80
  v_mov_b32 v73, 0x3f803f80
  v_mov_b32 v74, 0x3f803f80
  v_mov_b32 v75, 0x3f803f80
  ds_write_b128 v14, v[72:75] offset:5440
p2_kernel_ones_5:
  s_mov_b64 exec, -1
  v_mov_b32 v72, 0
  v_mov_b32 v73, 0
  v_mov_b32 v74, 0
  v_mov_b32 v75, 0
  v_add_u32 v16, 0, v0
  v_cmp_gt_u32 vcc, 1056, v16
  s_and_saveexec_b64 s[52:53], vcc
  s_cbranch_execz p2_kernel_zv_6
  v_mul_u32_u24 v14, 5958, v16
  v_lshrrev_b32 v14, 16, v14
  v_mul_u32_u24 v15, 11, v14
  v_sub_u32 v15, v16, v15
  v_lshrrev_b32 v17, 4, v14
  v_mul_u32_u24 v17, 13312, v17
  v_bfe_u32 v16, v14, 1, 3
  v_lshl_add_u32 v17, v16, 10, v17
  v_and_b32 v16, 1, v14
  v_lshl_add_u32 v17, v16, 9, v17
  v_lshl_add_u32 v17, v15, 4, v17
  ds_write_b128 v17, v[72:75] offset:5456
p2_kernel_zv_6:
  s_mov_b64 exec, -1
  v_add_u32 v16, 512, v0
  v_cmp_gt_u32 vcc, 1056, v16
  s_and_saveexec_b64 s[52:53], vcc
  s_cbranch_execz p2_kernel_zv_7
  v_mul_u32_u24 v14, 5958, v16
  v_lshrrev_b32 v14, 16, v14
  v_mul_u32_u24 v15, 11, v14
  v_sub_u32 v15, v16, v15
  v_lshrrev_b32 v17, 4, v14
  v_mul_u32_u24 v17, 13312, v17
  v_bfe_u32 v16, v14, 1, 3
  v_lshl_add_u32 v17, v16, 10, v17
  v_and_b32 v16, 1, v14
  v_lshl_add_u32 v17, v16, 9, v17
  v_lshl_add_u32 v17, v15, 4, v17
  ds_write_b128 v17, v[72:75] offset:5456
p2_kernel_zv_7:
  s_mov_b64 exec, -1
  v_add_u32 v16, 1024, v0
  v_cmp_gt_u32 vcc, 1056, v16
  s_and_saveexec_b64 s[52:53], vcc
  s_cbranch_execz p2_kernel_zv_8
  v_mul_u32_u24 v14, 5958, v16
  v_lshrrev_b32 v14, 16, v14
  v_mul_u32_u24 v15, 11, v14
  v_sub_u32 v15, v16, v15
  v_lshrrev_b32 v17, 4, v14
  v_mul_u32_u24 v17, 13312, v17
  v_bfe_u32 v16, v14, 1, 3
  v_lshl_add_u32 v17, v16, 10, v17
  v_and_b32 v16, 1, v14
  v_lshl_add_u32 v17, v16, 9, v17
  v_lshl_add_u32 v17, v15, 4, v17
  ds_write_b128 v17, v[72:75] offset:5456
p2_kernel_zv_8:
  s_mov_b64 exec, -1
  v_mov_b32 v152, 0
  v_mov_b32 v153, 0
  v_mov_b32 v154, 0
  v_mov_b32 v155, 0
  v_mov_b32 v156, 0
  v_mov_b32 v157, 0
  v_mov_b32 v158, 0
  v_mov_b32 v159, 0
  v_mov_b32 v160, 0
  v_mov_b32 v161, 0
  v_mov_b32 v162, 0
  v_mov_b32 v163, 0
  v_mov_b32 v164, 0
  v_mov_b32 v165, 0
  v_mov_b32 v166, 0
  v_mov_b32 v167, 0
  v_mov_b32 v168, 0
  v_mov_b32 v169, 0
  v_mov_b32 v170, 0
  v_mov_b32 v171, 0
  v_mov_b32 v172, 0
  v_mov_b32 v173, 0
  v_mov_b32 v174, 0
  v_mov_b32 v175, 0
  v_mov_b32 v176, 0
  v_mov_b32 v177, 0
  v_mov_b32 v178, 0
  v_mov_b32 v179, 0
  v_mov_b32 v180, 0
  v_mov_b32 v181, 0
  v_mov_b32 v182, 0
  v_mov_b32 v183, 0
  s_mov_b32 s47, 0
  s_lshr_b32 s32, s2, 3
  s_lshl_b32 s32, s32, 3
  s_add_u32 s32, s32, s22
  s_cmp_ge_u32 s32, 50
  s_cbranch_scc1 p2_kernel_t13_9
  s_lshl_b32 s33, s32, 13
  v_lshl_add_u32 v208, v1, 7, s33
  s_and_b32 s83, s2, 1
  s_mul_i32 s83, s83, 409600
  s_add_u32 s83, s83, 0x1a60000
  s_branch p2_kernel_tgo_10
p2_kernel_t13_9:
  s_sub_u32 s33, s32, 50
  s_lshl_b32 s33, s33, 13
  v_lshl_add_u32 v208, v1, 7, s33
  s_and_b32 s33, s2, 3
  s_lshl_b32 s34, s33, 2
  s_cmp_eq_u32 s33, 3
  s_cselect_b32 s33, 11, s34
  s_mul_i32 s83, s33, 327680
  s_add_u32 s83, s83, 0x1400000
  s_cmp_ge_u32 s32, 210
  s_cselect_b32 s83, 0x7ff00000, s83
p2_kernel_tgo_10:
  v_mov_b32 v254, 0
  s_mul_i32 s32, s20, 20
  s_lshr_b32 s33, s32, 7
  s_add_u32 s34, s32, 19
  s_lshr_b32 s34, s34, 7
  v_and_b32 v14, 1, v1
  v_cmp_eq_u32 vcc, 0, v14
  v_mov_b32 v15, s33
  v_mov_b32 v16, s34
  v_cndmask_b32 v15, v16, v15, vcc
  v_bfe_u32 v14, v1, 1, 1
  v_mul_u32_u24 v14, 5, v14
  v_add3_u32 v16, v15, v14, 5
  v_lshrrev_b32 v14, 2, v1
  v_mul_u32_u24 v14, 15, v14
  v_add_u32 v14, v14, v16
  v_lshlrev_b32 v14, 7, v14
  v_add_u32 v14, 0x1be0000, v14
  v_bfe_u32 v17, v1, 1, 1
  s_lshl_b32 s32, s21, 1
  v_add_u32 v17, s32, v17
  v_mul_u32_u24 v17, 15, v17
  v_add_u32 v17, v17, v15
  v_lshlrev_b32 v17, 7, v17
  v_add_u32 v17, 0x1be0000, v17
  v_mov_b32 v18, s101
  s_cmp_eq_u32 s22, 0
  s_cbranch_scc0 p2_kernel_wd_11
  s_mov_b32 s35, 0
  s_mov_b32 exec_lo, -1
  s_mov_b32 exec_hi, -1
p2_kernel_wp_12:
  buffer_load_dword v19, v14, s[16:19], 0 offen sc1
  buffer_load_dword v20, v17, s[16:19], 0 offen sc1
  s_waitcnt vmcnt(0)
  v_cmp_eq_u32 vcc, v19, v18
  v_cmp_eq_u32 s[96:97], v20, v18
  s_and_b64 vcc, vcc, s[96:97]
  s_cmp_eq_u64 vcc, exec
  s_cbranch_scc1 p2_kernel_wd_11_ok
  s_sleep 1
  s_add_u32 s35, s35, 1
  s_cmp_lt_u32 s35, 0x100000
  s_cbranch_scc1 p2_kernel_wp_12
p2_kernel_wd_11_ok:
  s_mov_b64 exec, -1
p2_kernel_wd_11:
  s_barrier
  s_lshl_b32 s32, s20, 6
  s_lshl_b32 s33, s21, 3
  s_add_u32 s32, s32, s33
  s_lshl_b32 s33, s28, 1
  s_add_u32 s32, s32, s33
  s_lshl_b32 s33, s32, 10
  s_add_u32 s33, s33, 0x0
  s_lshl_b32 s34, s32, 8
  s_add_u32 s34, s34, 0x200000
  v_mov_b32 v28, 0
  v_mov_b32 v29, 0
  v_mov_b32 v36, 0
  v_mov_b32 v37, 0
  v_lshlrev_b32 v14, 3, v2
  v_lshlrev_b32 v15, 3, v1
  buffer_load_dwordx2 v[24:25], v15, s[16:19], s33 offen offset:0 sc1
  buffer_load_dwordx2 v[26:27], v15, s[16:19], s33 offen offset:512 sc1
  buffer_load_dwordx2 v[32:33], v15, s[16:19], s33 offen offset:1024 sc1
  buffer_load_dwordx2 v[34:35], v15, s[16:19], s33 offen offset:1536 sc1
  s_mov_b32 exec_hi, 0
  buffer_load_dwordx2 v[28:29], v14, s[16:19], s34 offen sc1
  buffer_load_dwordx2 v[36:37], v14, s[16:19], s34 offen offset:256 sc1
  s_mov_b64 exec, -1
p2_kernel_pass:
  s_mov_b32 s36, s48
  s_mov_b32 s37, s49
  s_mov_b32 s38, s50
  s_mov_b32 s40, 0
  s_add_u32 m0, s54, s40
  s_add_u32 s34, s38, 640
  buffer_load_dwordx4 v4, s[16:19], s36 offen sc1 lds
  s_add_u32 m0, s55, s40
  s_add_u32 s36, s36, 4096
  buffer_load_dwordx4 v4, s[16:19], s37 offen sc1 lds
  s_add_u32 s37, s37, 1024
  s_add_u32 m0, s56, s40
  s_mov_b64 exec, s[42:43]
  buffer_load_dwordx4 v6, s[16:19], s38 offen sc1 lds
  s_add_u32 m0, m0, 1024
  s_nop 0
  buffer_load_dwordx4 v6, s[16:19], s34 offen sc1 lds
  s_mov_b64 exec, -1
  s_add_u32 s38, s38, 5120
  s_add_u32 s40, s40, 13312
  s_cmp_eq_u32 s40, 39936
  s_cselect_b32 s40, 0, s40
  s_add_u32 m0, s54, s40
  s_add_u32 s34, s38, 640
  buffer_load_dwordx4 v4, s[16:19], s36 offen sc1 lds
  s_add_u32 m0, s55, s40
  s_add_u32 s36, s36, 4096
  buffer_load_dwordx4 v4, s[16:19], s37 offen sc1 lds
  s_add_u32 s37, s37, 1024
  s_add_u32 m0, s56, s40
  s_mov_b64 exec, s[42:43]
  buffer_load_dwordx4 v6, s[16:19], s38 offen sc1 lds
  s_add_u32 m0, m0, 1024
  s_nop 0
  buffer_load_dwordx4 v6, s[16:19], s34 offen sc1 lds
  s_mov_b64 exec, -1
  s_add_u32 s38, s38, 5120
  s_add_u32 s40, s40, 13312
  s_cmp_eq_u32 s40, 39936
  s_cselect_b32 s40, 0, s40
  v_mov_b32 v120, 0
  v_mov_b32 v121, 0
  v_mov_b32 v122, 0
  v_mov_b32 v123, 0
  v_mov_b32 v124, 0
  v_mov_b32 v125, 0
  v_mov_b32 v126, 0
  v_mov_b32 v127, 0
  v_mov_b32 v128, 0
  v_mov_b32 v129, 0
  v_mov_b32 v130, 0
  v_mov_b32 v131, 0
  v_mov_b32 v132, 0
  v_mov_b32 v133, 0
  v_mov_b32 v134, 0
  v_mov_b32 v135, 0
  v_mov_b32 v136, 0
  v_mov_b32 v137, 0
  v_mov_b32 v138, 0
  v_mov_b32 v139, 0
  v_mov_b32 v140, 0
  v_mov_b32 v141, 0
  v_mov_b32 v142, 0
  v_mov_b32 v143, 0
  v_mov_b32 v144, 0
  v_mov_b32 v145, 0
  v_mov_b32 v146, 0
  v_mov_b32 v147, 0
  v_mov_b32 v148, 0
  v_mov_b32 v149, 0
  v_mov_b32 v150, 0
  v_mov_b32 v151, 0
  v_mov_b32 v112, 0
  v_mov_b32 v64, 0
  v_mov_b32 v113, 0
  v_mov_b32 v65, 0
  v_mov_b32 v114, 0
  v_mov_b32 v66, 0
  v_mov_b32 v115, 0
  v_mov_b32 v67, 0
  v_mov_b32 v116, 0
  v_mov_b32 v68, 0
  v_mov_b32 v117, 0
  v_mov_b32 v69, 0
  v_mov_b32 v118, 0
  v_mov_b32 v70, 0
  v_mov_b32 v119, 0
  v_mov_b32 v71, 0
  v_lshl_add_u32 v7, v1, 4, s39
  v_lshl_add_u32 v8, v2, 3, s39
  v_lshl_add_u32 v11, v1, 3, s39
  s_mov_b32 s46, 13312
  s_waitcnt vmcnt(4) lgkmcnt(0)
  s_barrier
  ds_read2st64_b64 v[40:43], v11 offset0:0 offset1:1
  ds_read_b64 v[44:45], v8 offset:4096
  s_waitcnt lgkmcnt(0)
  v_mfma_f32_32x32x16_bf16 v[72:87], v[40:43], v[24:27], v[152:167]
  v_mfma_f32_32x32x8_bf16 v[72:87], v[44:45], v[28:29], v[72:87]
  s_mov_b32 s41, 0
  s_nop 7
  s_nop 3
  s_cmp_eq_u32 s47, 0
  s_cbranch_scc0 p2_kernel_loop
  s_mov_b32 s76, 3
  s_cmp_ge_u32 s2, 182
  s_cbranch_scc1 p2_kernel_rp_none_13
  s_mul_i32 s35, s22, 5
  s_cmp_ge_u32 s2, 108
  s_cbranch_scc1 p2_kernel_rp_w2_14
  s_mov_b32 s76, 0
  s_cmp_ge_u32 s2, 54
  s_cselect_b32 s72, s70, s68
  s_cselect_b32 s73, s71, s69
  s_cselect_b32 s32, 54, 0
  s_cselect_b32 s78, 1, 0
  s_and_b32 s73, s73, 0xffff
  s_mov_b32 s74, 0x21c000
  s_mov_b32 s75, 0x20000
  s_sub_u32 s32, s2, s32
  s_lshr_b32 s33, s32, 1
  s_and_b32 s32, s32, 1
  s_mul_i32 s34, s32, 320
  s_lshl_b32 s79, s35, 3
  s_add_u32 s34, s34, s79
  s_mul_i32 s34, s34, 3456
  s_lshl_b32 s79, s33, 7
  s_add_u32 s34, s34, s79
  v_lshrrev_b32 v204, 3, v1
  v_mul_u32_u24 v204, 3456, v204
  v_and_b32 v205, 7, v1
  v_lshl_add_u32 v204, v205, 4, v204
  s_lshl_b32 s77, s33, 1
  s_and_b32 s79, s22, 1
  s_add_u32 s77, s77, s79
  s_mul_i32 s77, s77, 40
  s_mul_i32 s79, s32, 20
  s_add_u32 s77, s77, s79
  s_lshr_b32 s79, s22, 1
  s_mul_i32 s79, s79, 5
  s_add_u32 s77, s77, s79
  s_lshl_b32 s77, s77, 1
  s_add_u32 s77, s77, s78
  s_lshl_b32 s77, s77, 10
  s_add_u32 s77, s77, 0x1400000
  s_lshl_b32 s78, s78, 1
  s_add_u32 s78, s78, s32
  s_mul_i32 s78, s78, 1728
  s_lshl_b32 s79, s33, 6
  s_add_u32 s78, s78, s79
  s_lshl_b32 s78, s78, 2
  s_add_u32 s78, s78, 0x1b30000
  s_lshl_b32 s32, s35, 10
  s_add_u32 m0, s32, 104512
  s_nop 0
  buffer_load_dwordx4 v204, s[72:75], s34 offen lds
  s_add_u32 s34, s34, 27648
  s_lshl_b32 s32, s35, 10
  s_add_u32 m0, s32, 105536
  s_nop 0
  buffer_load_dwordx4 v204, s[72:75], s34 offen lds
  s_add_u32 s34, s34, 27648
  s_lshl_b32 s32, s35, 10
  s_add_u32 m0, s32, 106560
  s_nop 0
  buffer_load_dwordx4 v204, s[72:75], s34 offen lds
  s_add_u32 s34, s34, 27648
  s_lshl_b32 s32, s35, 10
  s_add_u32 m0, s32, 107584
  s_nop 0
  buffer_load_dwordx4 v204, s[72:75], s34 offen lds
  s_add_u32 s34, s34, 27648
  s_lshl_b32 s32, s35, 10
  s_add_u32 m0, s32, 108608
  s_nop 0
  buffer_load_dwordx4 v204, s[72:75], s34 offen lds
  s_add_u32 s34, s34, 27648
  s_branch p2_kernel_rp_none_13
p2_kernel_rp_w2_14:
  s_cmp_ge_u32 s2, 162
  s_cbranch_scc1 p2_kernel_rp_wo_15
  s_mov_b32 s76, 1
  s_mov_b32 s72, s66
  s_and_b32 s73, s67, 0xffff
  s_mov_b32 s74, 0x21c000
  s_mov_b32 s75, 0x20000
  s_sub_u32 s32, s2, 108
  s_mul_i32 s34, s32, 40960
  s_lshl_b32 s33, s35, 10
  s_add_u32 s34, s34, s33
  s_mul_i32 s77, s22, 27
  s_lshr_b32 s33, s32, 1
  s_add_u32 s77, s77, s33
  s_mul_i32 s77, s77, 10
  s_and_b32 s33, s32, 1
  s_mul_i32 s33, s33, 5
  s_add_u32 s77, s77, s33
  s_lshl_b32 s77, s77, 10
  s_add_u32 s77, s77, 0x1840000
  s_lshl_b32 s33, s35, 10
  v_lshlrev_b32 v204, 4, v1
  s_add_u32 m0, s33, 104512
  s_nop 0
  buffer_load_dwordx4 v204, s[72:75], s34 offen lds
  s_add_u32 s34, s34, 1024
  s_add_u32 m0, s33, 105536
  s_nop 0
  buffer_load_dwordx4 v204, s[72:75], s34 offen lds
  s_add_u32 s34, s34, 1024
  s_add_u32 m0, s33, 106560
  s_nop 0
  buffer_load_dwordx4 v204, s[72:75], s34 offen lds
  s_add_u32 s34, s34, 1024
  s_add_u32 m0, s33, 107584
  s_nop 0
  buffer_load_dwordx4 v204, s[72:75], s34 offen lds
  s_add_u32 s34, s34, 1024
  s_add_u32 m0, s33, 108608
  s_nop 0
  buffer_load_dwordx4 v204, s[72:75], s34 offen lds
  s_add_u32 s34, s34, 1024
  s_branch p2_kernel_rp_none_13
p2_kernel_rp_wo_15:
  s_mov_b32 s76, 1
  s_mov_b32 s72, s64
  s_and_b32 s73, s65, 0xffff
  s_mov_b32 s74, 0xc8000
  s_mov_b32 s75, 0x20000
  s_sub_u32 s32, s2, 162
  s_mul_i32 s77, s22, 10
  s_lshr_b32 s33, s32, 1
  s_add_u32 s77, s77, s33
  s_mul_i32 s77, s77, 10
  s_and_b32 s33, s32, 1
  s_mul_i32 s33, s33, 5
  s_add_u32 s77, s77, s33
  s_lshl_b32 s77, s77, 10
  s_add_u32 s77, s77, 0x1a60000
  s_lshl_b32 s33, s35, 10
  s_cmp_ge_u32 s32, 16
  s_cbranch_scc1 p2_kernel_rp_wor_16
  s_mul_i32 s34, s32, 51200
  s_add_u32 s34, s34, s33
  s_cmp_ge_u32 s22, 4
  s_cselect_b32 s79, 5120, 0
  s_add_u32 s34, s34, s79
  v_lshlrev_b32 v204, 4, v1
  s_add_u32 m0, s33, 104512
  s_nop 0
  buffer_load_dwordx4 v204, s[72:75], s34 offen lds
  s_add_u32 s34, s34, 1024
  s_add_u32 m0, s33, 105536
  s_nop 0
  buffer_load_dwordx4 v204, s[72:75], s34 offen lds
  s_add_u32 s34, s34, 1024
  s_add_u32 m0, s33, 106560
  s_nop 0
  buffer_load_dwordx4 v204, s[72:75], s34 offen lds
  s_add_u32 s34, s34, 1024
  s_add_u32 m0, s33, 107584
  s_nop 0
  buffer_load_dwordx4 v204, s[72:75], s34 offen lds
  s_add_u32 s34, s34, 1024
  s_add_u32 m0, s33, 108608
  s_nop 0
  buffer_load_dwordx4 v204, s[72:75], s34 offen lds
  s_add_u32 s34, s34, 1024
  s_branch p2_kernel_rp_none_13
p2_kernel_rp_wor_16:
  s_sub_u32 s32, s32, 16
  s_mul_i32 s34, s32, 204800
  s_add_u32 s79, s35, 0
  s_lshl_b32 s79, s79, 6
  v_add_u32 v205, s79, v1
  v_mul_u32_u24 v14, 3277, v205
  v_lshrrev_b32 v14, 18, v14
  v_mul_u32_u24 v15, 80, v14
  v_sub_u32 v205, v205, v15
  v_lshrrev_b32 v15, 4, v14
  v_bfe_u32 v16, v14, 2, 1
  v_lshl_add_u32 v15, v15, 1, v16
  v_bfe_u32 v16, v14, 3, 1
  v_lshl_add_u32 v15, v15, 1, v16
  v_mul_u32_u24 v15, 20, v15
  v_and_b32 v16, 3, v14
  v_add3_u32 v15, v15, v16, 16
  v_mul_u32_u24 v15, 1280, v15
  v_lshl_add_u32 v204, v205, 4, v15
  s_add_u32 m0, s33, 104512
  s_nop 0
  buffer_load_dwordx4 v204, s[72:75], s34 offen lds
  s_add_u32 s79, s35, 1
  s_lshl_b32 s79, s79, 6
  v_add_u32 v205, s79, v1
  v_mul_u32_u24 v14, 3277, v205
  v_lshrrev_b32 v14, 18, v14
  v_mul_u32_u24 v15, 80, v14
  v_sub_u32 v205, v205, v15
  v_lshrrev_b32 v15, 4, v14
  v_bfe_u32 v16, v14, 2, 1
  v_lshl_add_u32 v15, v15, 1, v16
  v_bfe_u32 v16, v14, 3, 1
  v_lshl_add_u32 v15, v15, 1, v16
  v_mul_u32_u24 v15, 20, v15
  v_and_b32 v16, 3, v14
  v_add3_u32 v15, v15, v16, 16
  v_mul_u32_u24 v15, 1280, v15
  v_lshl_add_u32 v204, v205, 4, v15
  s_add_u32 m0, s33, 105536
  s_nop 0
  buffer_load_dwordx4 v204, s[72:75], s34 offen lds
  s_add_u32 s79, s35, 2
  s_lshl_b32 s79, s79, 6
  v_add_u32 v205, s79, v1
  v_mul_u32_u24 v14, 3277, v205
  v_lshrrev_b32 v14, 18, v14
  v_mul_u32_u24 v15, 80, v14
  v_sub_u32 v205, v205, v15
  v_lshrrev_b32 v15, 4, v14
  v_bfe_u32 v16, v14, 2, 1
  v_lshl_add_u32 v15, v15, 1, v16
  v_bfe_u32 v16, v14, 3, 1
  v_lshl_add_u32 v15, v15, 1, v16
  v_mul_u32_u24 v15, 20, v15
  v_and_b32 v16, 3, v14
  v_add3_u32 v15, v15, v16, 16
  v_mul_u32_u24 v15, 1280, v15
  v_lshl_add_u32 v204, v205, 4, v15
  s_add_u32 m0, s33, 106560
  s_nop 0
  buffer_load_dwordx4 v204, s[72:75], s34 offen lds
  s_add_u32 s79, s35, 3
  s_lshl_b32 s79, s79, 6
  v_add_u32 v205, s79, v1
  v_mul_u32_u24 v14, 3277, v205
  v_lshrrev_b32 v14, 18, v14
  v_mul_u32_u24 v15, 80, v14
  v_sub_u32 v205, v205, v15
  v_lshrrev_b32 v15, 4, v14
  v_bfe_u32 v16, v14, 2, 1
  v_lshl_add_u32 v15, v15, 1, v16
  v_bfe_u32 v16, v14, 3, 1
  v_lshl_add_u32 v15, v15, 1, v16
  v_mul_u32_u24 v15, 20, v15
  v_and_b32 v16, 3, v14
  v_add3_u32 v15, v15, v16, 16
  v_mul_u32_u24 v15, 1280, v15
  v_lshl_add_u32 v204, v205, 4, v15
  s_add_u32 m0, s33, 107584
  s_nop 0
  buffer_load_dwordx4 v204, s[72:75], s34 offen lds
  s_add_u32 s79, s35, 4
  s_lshl_b32 s79, s79, 6
  v_add_u32 v205, s79, v1
  v_mul_u32_u24 v14, 3277, v205
  v_lshrrev_b32 v14, 18, v14
  v_mul_u32_u24 v15, 80, v14
  v_sub_u32 v205, v205, v15
  v_lshrrev_b32 v15, 4, v14
  v_bfe_u32 v16, v14, 2, 1
  v_lshl_add_u32 v15, v15, 1, v16
  v_bfe_u32 v16, v14, 3, 1
  v_lshl_add_u32 v15, v15, 1, v16
  v_mul_u32_u24 v15, 20, v15
  v_and_b32 v16, 3, v14
  v_add3_u32 v15, v15, v16, 16
  v_mul_u32_u24 v15, 1280, v15
  v_lshl_add_u32 v204, v205, 4, v15
  s_add_u32 m0, s33, 108608
  s_nop 0
  buffer_load_dwordx4 v204, s[72:75], s34 offen lds
p2_kernel_rp_none_13:
  v_mfma_f32_32x32x16_bf16 v[88:103], v[40:43], v[32:35], v[168:183]
  v_exp_f32 v72, v72
  ds_read2st64_b64 v[48:51], v11 offset0:2 offset1:3
  v_exp_f32 v73, v73
  ds_read_b64 v[52:53], v8 offset:4352
  v_exp_f32 v74, v74
  ds_read_b128 v[56:59], v7 offset:5120
  v_exp_f32 v75, v75
  ds_read_b128 v[60:63], v7 offset:6144
  v_mfma_f32_32x32x8_bf16 v[88:103], v[44:45], v[36:37], v[88:103]
  v_exp_f32 v76, v76
  v_exp_f32 v77, v77
  v_exp_f32 v78, v78
  v_exp_f32 v79, v79
  v_cvt_pk_bf16_f32 v104, v72, v73
  v_cvt_pk_bf16_f32 v105, v74, v75
  v_mfma_f32_32x32x16_bf16 v[136:151], v[64:67], v[112:115], v[136:151]
  v_exp_f32 v80, v80
  v_exp_f32 v81, v81
  v_exp_f32 v82, v82
  v_exp_f32 v83, v83
  v_cvt_pk_bf16_f32 v106, v76, v77
  v_cvt_pk_bf16_f32 v107, v78, v79
  v_mfma_f32_32x32x16_bf16 v[136:151], v[68:71], v[116:119], v[136:151]
  v_exp_f32 v84, v84
  v_exp_f32 v85, v85
  v_exp_f32 v86, v86
  v_exp_f32 v87, v87
  v_cvt_pk_bf16_f32 v108, v80, v81
  v_cvt_pk_bf16_f32 v109, v82, v83
  v_cvt_pk_bf16_f32 v110, v84, v85
  v_cvt_pk_bf16_f32 v111, v86, v87
  s_waitcnt lgkmcnt(0)
  v_mfma_f32_32x32x16_bf16 v[72:87], v[48:51], v[24:27], v[152:167]
  v_exp_f32 v88, v88
  v_exp_f32 v89, v89
  v_exp_f32 v90, v90
  v_exp_f32 v91, v91
  v_mfma_f32_32x32x8_bf16 v[72:87], v[52:53], v[28:29], v[72:87]
  v_exp_f32 v92, v92
  v_exp_f32 v93, v93
  v_exp_f32 v94, v94
  v_exp_f32 v95, v95
  v_cvt_pk_bf16_f32 v112, v88, v89
  v_cvt_pk_bf16_f32 v113, v90, v91
  v_mfma_f32_32x32x16_bf16 v[120:135], v[56:59], v[104:107], v[120:135]
  v_exp_f32 v96, v96
  v_exp_f32 v97, v97
  v_exp_f32 v98, v98
  v_exp_f32 v99, v99
  v_cvt_pk_bf16_f32 v114, v92, v93
  v_cvt_pk_bf16_f32 v115, v94, v95
  v_mfma_f32_32x32x16_bf16 v[120:135], v[60:63], v[108:111], v[120:135]
  v_exp_f32 v100, v100
  v_exp_f32 v101, v101
  v_exp_f32 v102, v102
  v_exp_f32 v103, v103
  v_cvt_pk_bf16_f32 v116, v96, v97
  v_cvt_pk_bf16_f32 v117, v98, v99
  v_cvt_pk_bf16_f32 v118, v100, v101
  v_cvt_pk_bf16_f32 v119, v102, v103
  v_mfma_f32_32x32x16_bf16 v[88:103], v[48:51], v[32:35], v[168:183]
  v_exp_f32 v72, v72
  ds_read2st64_b64 v[40:43], v11 offset0:4 offset1:5
  v_exp_f32 v73, v73
  ds_read_b64 v[44:45], v8 offset:4608
  v_exp_f32 v74, v74
  ds_read_b128 v[64:67], v7 offset:7168
  v_exp_f32 v75, v75
  ds_read_b128 v[68:71], v7 offset:8192
  v_mfma_f32_32x32x8_bf16 v[88:103], v[52:53], v[36:37], v[88:103]
  v_exp_f32 v76, v76
  v_exp_f32 v77, v77
  v_exp_f32 v78, v78
  v_exp_f32 v79, v79
  v_cvt_pk_bf16_f32 v104, v72, v73
  v_cvt_pk_bf16_f32 v105, v74, v75
  v_mfma_f32_32x32x16_bf16 v[136:151], v[56:59], v[112:115], v[136:151]
  v_exp_f32 v80, v80
  v_exp_f32 v81, v81
  v_exp_f32 v82, v82
  v_exp_f32 v83, v83
  v_cvt_pk_bf16_f32 v106, v76, v77
  v_cvt_pk_bf16_f32 v107, v78, v79
  v_mfma_f32_32x32x16_bf16 v[136:151], v[60:63], v[116:119], v[136:151]
  v_exp_f32 v84, v84
  v_exp_f32 v85, v85
  v_exp_f32 v86, v86
  v_exp_f32 v87, v87
  v_cvt_pk_bf16_f32 v108, v80, v81
  v_cvt_pk_bf16_f32 v109, v82, v83
  v_cvt_pk_bf16_f32 v110, v84, v85
  v_cvt_pk_bf16_f32 v111, v86, v87
  s_waitcnt lgkmcnt(0)
  v_mfma_f32_32x32x16_bf16 v[72:87], v[40:43], v[24:27], v[152:167]
  v_exp_f32 v88, v88
  v_exp_f32 v89, v89
  v_exp_f32 v90, v90
  v_exp_f32 v91, v91
  v_mfma_f32_32x32x8_bf16 v[72:87], v[44:45], v[28:29], v[72:87]
  v_exp_f32 v92, v92
  v_exp_f32 v93, v93
  v_exp_f32 v94, v94
  v_exp_f32 v95, v95
  v_cvt_pk_bf16_f32 v112, v88, v89
  v_cvt_pk_bf16_f32 v113, v90, v91
  v_mfma_f32_32x32x16_bf16 v[120:135], v[64:67], v[104:107], v[120:135]
  v_exp_f32 v96, v96
  v_exp_f32 v97, v97
  v_exp_f32 v98, v98
  v_exp_f32 v99, v99
  v_cvt_pk_bf16_f32 v114, v92, v93
  v_cvt_pk_bf16_f32 v115, v94, v95
  v_mfma_f32_32x32x16_bf16 v[120:135], v[68:71], v[108:111], v[120:135]
  v_exp_f32 v100, v100
  v_exp_f32 v101, v101
  v_exp_f32 v102, v102
  v_exp_f32 v103, v103
  v_cvt_pk_bf16_f32 v116, v96, v97
  v_cvt_pk_bf16_f32 v117, v98, v99
  v_cvt_pk_bf16_f32 v118, v100, v101
  v_cvt_pk_bf16_f32 v119, v102, v103
  v_mfma_f32_32x32x16_bf16 v[88:103], v[40:43], v[32:35], v[168:183]
  v_exp_f32 v72, v72
  ds_read2st64_b64 v[48:51], v11 offset0:6 offset1:7
  v_exp_f32 v73, v73
  ds_read_b64 v[52:53], v8 offset:4864
  v_exp_f32 v74, v74
  ds_read_b128 v[56:59], v7 offset:9216
  v_exp_f32 v75, v75
  ds_read_b128 v[60:63], v7 offset:10240
  v_mfma_f32_32x32x8_bf16 v[88:103], v[44:45], v[36:37], v[88:103]
  v_exp_f32 v76, v76
  v_exp_f32 v77, v77
  v_exp_f32 v78, v78
  v_exp_f32 v79, v79
  v_cvt_pk_bf16_f32 v104, v72, v73
  v_cvt_pk_bf16_f32 v105, v74, v75
  v_mfma_f32_32x32x16_bf16 v[136:151], v[64:67], v[112:115], v[136:151]
  v_exp_f32 v80, v80
  v_exp_f32 v81, v81
  v_exp_f32 v82, v82
  v_exp_f32 v83, v83
  v_cvt_pk_bf16_f32 v106, v76, v77
  v_cvt_pk_bf16_f32 v107, v78, v79
  v_mfma_f32_32x32x16_bf16 v[136:151], v[68:71], v[116:119], v[136:151]
  v_exp_f32 v84, v84
  v_exp_f32 v85, v85
  v_exp_f32 v86, v86
  v_exp_f32 v87, v87
  v_cvt_pk_bf16_f32 v108, v80, v81
  v_cvt_pk_bf16_f32 v109, v82, v83
  v_cvt_pk_bf16_f32 v110, v84, v85
  v_cvt_pk_bf16_f32 v111, v86, v87
  s_waitcnt lgkmcnt(0)
  v_mfma_f32_32x32x16_bf16 v[72:87], v[48:51], v[24:27], v[152:167]
  v_exp_f32 v88, v88
  s_add_u32 s32, s39, s46
  v_exp_f32 v89, v89
  s_nop 0
  v_exp_f32 v90, v90
  v_lshl_add_u32 v9, v1, 4, s32
  v_exp_f32 v91, v91
  v_lshl_add_u32 v10, v2, 3, s32
  v_mfma_f32_32x32x8_bf16 v[72:87], v[52:53], v[28:29], v[72:87]
  v_exp_f32 v92, v92
  v_lshl_add_u32 v12, v1, 3, s32
  v_exp_f32 v93, v93
  s_add_u32 s46, s46, 13312
  v_exp_f32 v94, v94
  s_cmp_eq_u32 s46, 39936
  s_cselect_b32 s46, 0, s46
  v_exp_f32 v95, v95
  v_cvt_pk_bf16_f32 v112, v88, v89
  v_cvt_pk_bf16_f32 v113, v90, v91
  v_mfma_f32_32x32x16_bf16 v[120:135], v[56:59], v[104:107], v[120:135]
  v_exp_f32 v96, v96
  v_exp_f32 v97, v97
  v_exp_f32 v98, v98
  v_exp_f32 v99, v99
  v_cvt_pk_bf16_f32 v114, v92, v93
  v_cvt_pk_bf16_f32 v115, v94, v95
  v_mfma_f32_32x32x16_bf16 v[120:135], v[60:63], v[108:111], v[120:135]
  v_exp_f32 v100, v100
  v_exp_f32 v101, v101
  v_exp_f32 v102, v102
  v_exp_f32 v103, v103
  v_cvt_pk_bf16_f32 v116, v96, v97
  v_cvt_pk_bf16_f32 v117, v98, v99
  v_cvt_pk_bf16_f32 v118, v100, v101
  v_cvt_pk_bf16_f32 v119, v102, v103
  s_cmp_eq_u32 s76, 3
  s_cbranch_scc1 p2_kernel_fw1_18
  s_waitcnt vmcnt(5)
  s_branch p2_kernel_fw2_19
p2_kernel_fw1_18:
  s_waitcnt vmcnt(0)
p2_kernel_fw2_19:
  s_barrier
  v_mfma_f32_32x32x16_bf16 v[88:103], v[48:51], v[32:35], v[168:183]
  v_exp_f32 v72, v72
  ds_read2st64_b64 v[40:43], v12 offset0:0 offset1:1
  v_exp_f32 v73, v73
  ds_read_b64 v[44:45], v10 offset:4096
  v_exp_f32 v74, v74
  ds_read_b128 v[64:67], v7 offset:11264
  v_exp_f32 v75, v75
  ds_read_b128 v[68:71], v7 offset:12288
  v_mfma_f32_32x32x8_bf16 v[88:103], v[52:53], v[36:37], v[88:103]
  v_exp_f32 v76, v76
  s_add_u32 m0, s54, s40
  v_exp_f32 v77, v77
  s_add_u32 s34, s38, 640
  v_exp_f32 v78, v78
  buffer_load_dwordx4 v4, s[16:19], s36 offen sc1 lds
  v_exp_f32 v79, v79
  s_add_u32 m0, s55, s40
  v_cvt_pk_bf16_f32 v104, v72, v73
  v_cvt_pk_bf16_f32 v105, v74, v75
  v_mfma_f32_32x32x16_bf16 v[136:151], v[56:59], v[112:115], v[136:151]
  v_exp_f32 v80, v80
  s_add_u32 s36, s36, 4096
  v_exp_f32 v81, v81
  buffer_load_dwordx4 v4, s[16:19], s37 offen sc1 lds
  v_exp_f32 v82, v82
  s_add_u32 s37, s37, 1024
  v_exp_f32 v83, v83
  v_cvt_pk_bf16_f32 v106, v76, v77
  v_cvt_pk_bf16_f32 v107, v78, v79
  v_mfma_f32_32x32x16_bf16 v[136:151], v[60:63], v[116:119], v[136:151]
  v_exp_f32 v84, v84
  v_exp_f32 v85, v85
  v_exp_f32 v86, v86
  v_exp_f32 v87, v87
  v_cvt_pk_bf16_f32 v108, v80, v81
  v_cvt_pk_bf16_f32 v109, v82, v83
  v_cvt_pk_bf16_f32 v110, v84, v85
  v_cvt_pk_bf16_f32 v111, v86, v87
  s_waitcnt lgkmcnt(0)
  v_mfma_f32_32x32x16_bf16 v[72:87], v[40:43], v[24:27], v[152:167]
  v_exp_f32 v88, v88
  s_add_u32 m0, s56, s40
  s_mov_b64 exec, s[42:43]
  buffer_load_dwordx4 v6, s[16:19], s38 offen sc1 lds
  s_add_u32 m0, m0, 1024
  s_nop 0
  buffer_load_dwordx4 v6, s[16:19], s34 offen sc1 lds
  s_mov_b64 exec, -1
  v_exp_f32 v89, v89
  s_add_u32 s38, s38, 5120
  v_exp_f32 v90, v90
  s_add_u32 s40, s40, 13312
  v_exp_f32 v91, v91
  s_cmp_eq_u32 s40, 39936
  s_cselect_b32 s40, 0, s40
  v_mfma_f32_32x32x8_bf16 v[72:87], v[44:45], v[28:29], v[72:87]
  v_exp_f32 v92, v92
  v_mov_b32 v7, v9
  v_exp_f32 v93, v93
  v_mov_b32 v8, v10
  v_exp_f32 v94, v94
  v_mov_b32 v11, v12
  v_exp_f32 v95, v95
  s_add_u32 s41, s41, 1
  v_cvt_pk_bf16_f32 v112, v88, v89
  v_cvt_pk_bf16_f32 v113, v90, v91
  v_mfma_f32_32x32x16_bf16 v[120:135], v[64:67], v[104:107], v[120:135]
  v_exp_f32 v96, v96
  v_exp_f32 v97, v97
  v_exp_f32 v98, v98
  v_exp_f32 v99, v99
  v_cvt_pk_bf16_f32 v114, v92, v93
  v_cvt_pk_bf16_f32 v115, v94, v95
  v_mfma_f32_32x32x16_bf16 v[120:135], v[68:71], v[108:111], v[120:135]
  v_exp_f32 v100, v100
  v_exp_f32 v101, v101
  v_exp_f32 v102, v102
  v_exp_f32 v103, v103
  v_cvt_pk_bf16_f32 v116, v96, v97
  v_cvt_pk_bf16_f32 v117, v98, v99
  v_cvt_pk_bf16_f32 v118, v100, v101
  v_cvt_pk_bf16_f32 v119, v102, v103
  v_mfma_f32_32x32x16_bf16 v[88:103], v[40:43], v[32:35], v[168:183]
  v_exp_f32 v72, v72
  ds_read2st64_b64 v[48:51], v11 offset0:2 offset1:3
  v_exp_f32 v73, v73
  ds_read_b64 v[52:53], v8 offset:4352
  v_exp_f32 v74, v74
  ds_read_b128 v[56:59], v7 offset:5120
  v_exp_f32 v75, v75
  ds_read_b128 v[60:63], v7 offset:6144
  v_mfma_f32_32x32x8_bf16 v[88:103], v[44:45], v[36:37], v[88:103]
  v_exp_f32 v76, v76
  v_exp_f32 v77, v77
  v_exp_f32 v78, v78
  v_exp_f32 v79, v79
  v_cvt_pk_bf16_f32 v104, v72, v73
  v_cvt_pk_bf16_f32 v105, v74, v75
  v_mfma_f32_32x32x16_bf16 v[136:151], v[64:67], v[112:115], v[136:151]
  v_exp_f32 v80, v80
  v_exp_f32 v81, v81
  v_exp_f32 v82, v82
  v_exp_f32 v83, v83
  v_cvt_pk_bf16_f32 v106, v76, v77
  v_cvt_pk_bf16_f32 v107, v78, v79
  v_mfma_f32_32x32x16_bf16 v[136:151], v[68:71], v[116:119], v[136:151]
  v_exp_f32 v84, v84
  v_exp_f32 v85, v85
  v_exp_f32 v86, v86
  v_exp_f32 v87, v87
  v_cvt_pk_bf16_f32 v108, v80, v81
  v_cvt_pk_bf16_f32 v109, v82, v83
  v_cvt_pk_bf16_f32 v110, v84, v85
  v_cvt_pk_bf16_f32 v111, v86, v87
  s_waitcnt lgkmcnt(0)
  v_mfma_f32_32x32x16_bf16 v[72:87], v[48:51], v[24:27], v[152:167]
  v_exp_f32 v88, v88
  v_exp_f32 v89, v89
  v_exp_f32 v90, v90
  v_exp_f32 v91, v91
  v_mfma_f32_32x32x8_bf16 v[72:87], v[52:53], v[28:29], v[72:87]
  v_exp_f32 v92, v92
  v_exp_f32 v93, v93
  v_exp_f32 v94, v94
  v_exp_f32 v95, v95
  v_cvt_pk_bf16_f32 v112, v88, v89
  v_cvt_pk_bf16_f32 v113, v90, v91
  v_mfma_f32_32x32x16_bf16 v[120:135], v[56:59], v[104:107], v[120:135]
  v_exp_f32 v96, v96
  v_exp_f32 v97, v97
  v_exp_f32 v98, v98
  v_exp_f32 v99, v99
  v_cvt_pk_bf16_f32 v114, v92, v93
  v_cvt_pk_bf16_f32 v115, v94, v95
  v_mfma_f32_32x32x16_bf16 v[120:135], v[60:63], v[108:111], v[120:135]
  v_exp_f32 v100, v100
  v_exp_f32 v101, v101
  v_exp_f32 v102, v102
  v_exp_f32 v103, v103
  v_cvt_pk_bf16_f32 v116, v96, v97
  v_cvt_pk_bf16_f32 v117, v98, v99
  v_cvt_pk_bf16_f32 v118, v100, v101
  v_cvt_pk_bf16_f32 v119, v102, v103
  v_mfma_f32_32x32x16_bf16 v[88:103], v[48:51], v[32:35], v[168:183]
  v_exp_f32 v72, v72
  ds_read2st64_b64 v[40:43], v11 offset0:4 offset1:5
  v_exp_f32 v73, v73
  ds_read_b64 v[44:45], v8 offset:4608
  v_exp_f32 v74, v74
  ds_read_b128 v[64:67], v7 offset:7168
  v_exp_f32 v75, v75
  ds_read_b128 v[68:71], v7 offset:8192
  v_mfma_f32_32x32x8_bf16 v[88:103], v[52:53], v[36:37], v[88:103]
  v_exp_f32 v76, v76
  v_exp_f32 v77, v77
  v_exp_f32 v78, v78
  v_exp_f32 v79, v79
  v_cvt_pk_bf16_f32 v104, v72, v73
  v_cvt_pk_bf16_f32 v105, v74, v75
  v_mfma_f32_32x32x16_bf16 v[136:151], v[56:59], v[112:115], v[136:151]
  v_exp_f32 v80, v80
  v_exp_f32 v81, v81
  v_exp_f32 v82, v82
  v_exp_f32 v83, v83
  v_cvt_pk_bf16_f32 v106, v76, v77
  v_cvt_pk_bf16_f32 v107, v78, v79
  v_mfma_f32_32x32x16_bf16 v[136:151], v[60:63], v[116:119], v[136:151]
  v_exp_f32 v84, v84
  v_exp_f32 v85, v85
  v_exp_f32 v86, v86
  v_exp_f32 v87, v87
  v_cvt_pk_bf16_f32 v108, v80, v81
  v_cvt_pk_bf16_f32 v109, v82, v83
  v_cvt_pk_bf16_f32 v110, v84, v85
  v_cvt_pk_bf16_f32 v111, v86, v87
  s_waitcnt lgkmcnt(0)
  v_mfma_f32_32x32x16_bf16 v[72:87], v[40:43], v[24:27], v[152:167]
  v_exp_f32 v88, v88
  v_exp_f32 v89, v89
  v_exp_f32 v90, v90
  v_exp_f32 v91, v91
  v_mfma_f32_32x32x8_bf16 v[72:87], v[44:45], v[28:29], v[72:87]
  v_exp_f32 v92, v92
  v_exp_f32 v93, v93
  v_exp_f32 v94, v94
  v_exp_f32 v95, v95
  v_cvt_pk_bf16_f32 v112, v88, v89
  v_cvt_pk_bf16_f32 v113, v90, v91
  v_mfma_f32_32x32x16_bf16 v[120:135], v[64:67], v[104:107], v[120:135]
  v_exp_f32 v96, v96
  v_exp_f32 v97, v97
  v_exp_f32 v98, v98
  v_exp_f32 v99, v99
  v_cvt_pk_bf16_f32 v114, v92, v93
  v_cvt_pk_bf16_f32 v115, v94, v95
  v_mfma_f32_32x32x16_bf16 v[120:135], v[68:71], v[108:111], v[120:135]
  v_exp_f32 v100, v100
  v_exp_f32 v101, v101
  v_exp_f32 v102, v102
  v_exp_f32 v103, v103
  v_cvt_pk_bf16_f32 v116, v96, v97
  v_cvt_pk_bf16_f32 v117, v98, v99
  v_cvt_pk_bf16_f32 v118, v100, v101
  v_cvt_pk_bf16_f32 v119, v102, v103
  v_mfma_f32_32x32x16_bf16 v[88:103], v[40:43], v[32:35], v[168:183]
  v_exp_f32 v72, v72
  ds_read2st64_b64 v[48:51], v11 offset0:6 offset1:7
  v_exp_f32 v73, v73
  ds_read_b64 v[52:53], v8 offset:4864
  v_exp_f32 v74, v74
  ds_read_b128 v[56:59], v7 offset:9216
  v_exp_f32 v75, v75
  ds_read_b128 v[60:63], v7 offset:10240
  v_mfma_f32_32x32x8_bf16 v[88:103], v[44:45], v[36:37], v[88:103]
  v_exp_f32 v76, v76
  v_exp_f32 v77, v77
  v_exp_f32 v78, v78
  v_exp_f32 v79, v79
  v_cvt_pk_bf16_f32 v104, v72, v73
  v_cvt_pk_bf16_f32 v105, v74, v75
  v_mfma_f32_32x32x16_bf16 v[136:151], v[64:67], v[112:115], v[136:151]
  v_exp_f32 v80, v80
  v_exp_f32 v81, v81
  v_exp_f32 v82, v82
  v_exp_f32 v83, v83
  v_cvt_pk_bf16_f32 v106, v76, v77
  v_cvt_pk_bf16_f32 v107, v78, v79
  v_mfma_f32_32x32x16_bf16 v[136:151], v[68:71], v[116:119], v[136:151]
  v_exp_f32 v84, v84
  v_exp_f32 v85, v85
  v_exp_f32 v86, v86
  v_exp_f32 v87, v87
  v_cvt_pk_bf16_f32 v108, v80, v81
  v_cvt_pk_bf16_f32 v109, v82, v83
  v_cvt_pk_bf16_f32 v110, v84, v85
  v_cvt_pk_bf16_f32 v111, v86, v87
  s_waitcnt lgkmcnt(0)
  v_mfma_f32_32x32x16_bf16 v[72:87], v[48:51], v[24:27], v[152:167]
  v_exp_f32 v88, v88
  s_add_u32 s32, s39, s46
  v_exp_f32 v89, v89
  s_nop 0
  v_exp_f32 v90, v90
  v_lshl_add_u32 v9, v1, 4, s32
  v_exp_f32 v91, v91
  v_lshl_add_u32 v10, v2, 3, s32
  v_mfma_f32_32x32x8_bf16 v[72:87], v[52:53], v[28:29], v[72:87]
  v_exp_f32 v92, v92
  v_lshl_add_u32 v12, v1, 3, s32
  v_exp_f32 v93, v93
  s_add_u32 s46, s46, 13312
  v_exp_f32 v94, v94
  s_cmp_eq_u32 s46, 39936
  s_cselect_b32 s46, 0, s46
  v_exp_f32 v95, v95
  v_cvt_pk_bf16_f32 v112, v88, v89
  v_cvt_pk_bf16_f32 v113, v90, v91
  v_mfma_f32_32x32x16_bf16 v[120:135], v[56:59], v[104:107], v[120:135]
  v_exp_f32 v96, v96
  v_exp_f32 v97, v97
  v_exp_f32 v98, v98
  v_exp_f32 v99, v99
  v_cvt_pk_bf16_f32 v114, v92, v93
  v_cvt_pk_bf16_f32 v115, v94, v95
  v_mfma_f32_32x32x16_bf16 v[120:135], v[60:63], v[108:111], v[120:135]
  v_exp_f32 v100, v100
  v_exp_f32 v101, v101
  v_exp_f32 v102, v102
  v_exp_f32 v103, v103
  v_cvt_pk_bf16_f32 v116, v96, v97
  v_cvt_pk_bf16_f32 v117, v98, v99
  v_cvt_pk_bf16_f32 v118, v100, v101
  v_cvt_pk_bf16_f32 v119, v102, v103
  s_waitcnt vmcnt(0)
  s_barrier
  v_mfma_f32_32x32x16_bf16 v[88:103], v[48:51], v[32:35], v[168:183]
  v_exp_f32 v72, v72
  ds_read2st64_b64 v[40:43], v12 offset0:0 offset1:1
  v_exp_f32 v73, v73
  ds_read_b64 v[44:45], v10 offset:4096
  v_exp_f32 v74, v74
  ds_read_b128 v[64:67], v7 offset:11264
  v_exp_f32 v75, v75
  ds_read_b128 v[68:71], v7 offset:12288
  v_mfma_f32_32x32x8_bf16 v[88:103], v[52:53], v[36:37], v[88:103]
  v_exp_f32 v76, v76
  s_add_u32 m0, s54, s40
  v_exp_f32 v77, v77
  s_add_u32 s34, s38, 640
  v_exp_f32 v78, v78
  buffer_load_dwordx4 v4, s[16:19], s36 offen sc1 lds
  v_exp_f32 v79, v79
  s_add_u32 m0, s55, s40
  v_cvt_pk_bf16_f32 v104, v72, v73
  v_cvt_pk_bf16_f32 v105, v74, v75
  v_mfma_f32_32x32x16_bf16 v[136:151], v[56:59], v[112:115], v[136:151]
  v_exp_f32 v80, v80
  s_add_u32 s36, s36, 4096
  v_exp_f32 v81, v81
  buffer_load_dwordx4 v4, s[16:19], s37 offen sc1 lds
  v_exp_f32 v82, v82
  s_add_u32 s37, s37, 1024
  v_exp_f32 v83, v83
  v_cvt_pk_bf16_f32 v106, v76, v77
  v_cvt_pk_bf16_f32 v107, v78, v79
  v_mfma_f32_32x32x16_bf16 v[136:151], v[60:63], v[116:119], v[136:151]
  v_exp_f32 v84, v84
  v_exp_f32 v85, v85
  v_exp_f32 v86, v86
  v_exp_f32 v87, v87
  v_cvt_pk_bf16_f32 v108, v80, v81
  v_cvt_pk_bf16_f32 v109, v82, v83
  v_cvt_pk_bf16_f32 v110, v84, v85
  v_cvt_pk_bf16_f32 v111, v86, v87
  s_waitcnt lgkmcnt(0)
  v_mfma_f32_32x32x16_bf16 v[72:87], v[40:43], v[24:27], v[152:167]
  v_exp_f32 v88, v88
  s_add_u32 m0, s56, s40
  s_mov_b64 exec, s[42:43]
  buffer_load_dwordx4 v6, s[16:19], s38 offen sc1 lds
  s_add_u32 m0, m0, 1024
  s_nop 0
  buffer_load_dwordx4 v6, s[16:19], s34 offen sc1 lds
  s_mov_b64 exec, -1
  v_exp_f32 v89, v89
  s_add_u32 s38, s38, 5120
  v_exp_f32 v90, v90
  s_add_u32 s40, s40, 13312
  v_exp_f32 v91, v91
  s_cmp_eq_u32 s40, 39936
  s_cselect_b32 s40, 0, s40
  v_mfma_f32_32x32x8_bf16 v[72:87], v[44:45], v[28:29], v[72:87]
  v_exp_f32 v92, v92
  v_mov_b32 v7, v9
  v_exp_f32 v93, v93
  v_mov_b32 v8, v10
  v_exp_f32 v94, v94
  v_mov_b32 v11, v12
  v_exp_f32 v95, v95
  s_add_u32 s41, s41, 1
  v_cvt_pk_bf16_f32 v112, v88, v89
  v_cvt_pk_bf16_f32 v113, v90, v91
  v_mfma_f32_32x32x16_bf16 v[120:135], v[64:67], v[104:107], v[120:135]
  v_exp_f32 v96, v96
  v_exp_f32 v97, v97
  v_exp_f32 v98, v98
  v_exp_f32 v99, v99
  v_cvt_pk_bf16_f32 v114, v92, v93
  v_cvt_pk_bf16_f32 v115, v94, v95
  v_mfma_f32_32x32x16_bf16 v[120:135], v[68:71], v[108:111], v[120:135]
  v_exp_f32 v100, v100
  v_exp_f32 v101, v101
  v_exp_f32 v102, v102
  v_exp_f32 v103, v103
  v_cvt_pk_bf16_f32 v116, v96, v97
  v_cvt_pk_bf16_f32 v117, v98, v99
  v_cvt_pk_bf16_f32 v118, v100, v101
  v_cvt_pk_bf16_f32 v119, v102, v103
  s_cmp_eq_u32 s76, 3
  s_cbranch_scc1 p2_kernel_rf_none_20
  v_lshlrev_b32 v205, 4, v1
  s_cmp_eq_u32 s76, 1
  s_cbranch_scc1 p2_kernel_rf_16_21
  v_bfe_u32 v14, v1, 2, 2
  v_lshl_add_u32 v14, v3, 3, v14
  v_lshlrev_b32 v14, 7, v14
  v_bfe_u32 v15, v1, 4, 1
  v_lshl_add_u32 v14, v15, 5, v14
  v_and_b32 v15, 3, v1
  v_lshl_add_u32 v14, v15, 3, v14
  s_lshr_b32 s32, s22, 1
  s_mul_i32 s32, s32, 10240
  s_and_b32 s33, s22, 1
  s_lshl_b32 s33, s33, 6
  s_add_u32 s32, s32, s33
  s_add_u32 s32, s32, 104512
  v_add_u32 v204, s32, v14
  v_mov_b32 v207, 0x3f803f80
  v_mov_b32 v206, 0
  s_mov_b32 s32, s77
  ds_read_b64_tr_b16 v[184:185], v204 offset:0
  ds_read_b64_tr_b16 v[186:187], v204 offset:512
  ds_read_b64_tr_b16 v[188:189], v204 offset:2048
  ds_read_b64_tr_b16 v[190:191], v204 offset:2560
  ds_read_b64_tr_b16 v[192:193], v204 offset:4096
  ds_read_b64_tr_b16 v[194:195], v204 offset:4608
  ds_read_b64_tr_b16 v[196:197], v204 offset:6144
  ds_read_b64_tr_b16 v[198:199], v204 offset:6656
  ds_read_b64_tr_b16 v[200:201], v204 offset:8192
  ds_read_b64_tr_b16 v[202:203], v204 offset:8704
  s_waitcnt lgkmcnt(0)
  buffer_store_dwordx4 v[184:187], v205, s[16:19], s32 offen sc1
  v_dot2c_f32_bf16 v206, v184, v207
  v_dot2c_f32_bf16 v206, v185, v207
  v_dot2c_f32_bf16 v206, v186, v207
  v_dot2c_f32_bf16 v206, v187, v207
  s_add_u32 s32, s32, 2048
  buffer_store_dwordx4 v[188:191], v205, s[16:19], s32 offen sc1
  v_dot2c_f32_bf16 v206, v188, v207
  v_dot2c_f32_bf16 v206, v189, v207
  v_dot2c_f32_bf16 v206, v190, v207
  v_dot2c_f32_bf16 v206, v191, v207
  s_add_u32 s32, s32, 2048
  buffer_store_dwordx4 v[192:195], v205, s[16:19], s32 offen sc1
  v_dot2c_f32_bf16 v206, v192, v207
  v_dot2c_f32_bf16 v206, v193, v207
  v_dot2c_f32_bf16 v206, v194, v207
  v_dot2c_f32_bf16 v206, v195, v207
  s_add_u32 s32, s32, 2048
  buffer_store_dwordx4 v[196:199], v205, s[16:19], s32 offen sc1
  v_dot2c_f32_bf16 v206, v196, v207
  v_dot2c_f32_bf16 v206, v197, v207
  v_dot2c_f32_bf16 v206, v198, v207
  v_dot2c_f32_bf16 v206, v199, v207
  s_add_u32 s32, s32, 2048
  buffer_store_dwordx4 v[200:203], v205, s[16:19], s32 offen sc1
  v_dot2c_f32_bf16 v206, v200, v207
  v_dot2c_f32_bf16 v206, v201, v207
  v_dot2c_f32_bf16 v206, v202, v207
  v_dot2c_f32_bf16 v206, v203, v207
  s_add_u32 s32, s32, 2048
  s_nop 2
  s_lshr_b32 s32, s22, 1
  s_lshl_b32 s32, s32, 1
  v_add_u32 v14, s32, v3
  v_lshlrev_b32 v14, 6, v14
  s_and_b32 s33, s22, 1
  s_lshl_b32 s33, s33, 5
  v_add3_u32 v14, v14, s33, v2
  v_lshlrev_b32 v14, 2, v14
  v_add_u32 v14, 79872, v14
  ds_write_b32 v14, v206
  s_branch p2_kernel_rf_none_20
p2_kernel_rf_16_21:
  v_lshrrev_b32 v14, 5, v1
  v_lshlrev_b32 v14, 4, v14
  v_bfe_u32 v15, v1, 4, 1
  v_lshl_add_u32 v14, v15, 2, v14
  v_bfe_u32 v15, v1, 2, 2
  v_add_u32 v14, v14, v15
  v_mul_u32_u24 v14, 1280, v14
  v_and_b32 v15, 3, v1
  v_lshl_add_u32 v14, v15, 3, v14
  s_mul_i32 s32, s22, 160
  s_add_u32 s32, s32, 104512
  v_add_u32 v204, s32, v14
  s_mov_b32 s32, s77
  ds_read_b64_tr_b16 v[184:185], v204 offset:0
  ds_read_b64_tr_b16 v[186:187], v204 offset:10240
  ds_read_b64_tr_b16 v[188:189], v204 offset:32
  ds_read_b64_tr_b16 v[190:191], v204 offset:10272
  ds_read_b64_tr_b16 v[192:193], v204 offset:64
  ds_read_b64_tr_b16 v[194:195], v204 offset:10304
  ds_read_b64_tr_b16 v[196:197], v204 offset:96
  ds_read_b64_tr_b16 v[198:199], v204 offset:10336
  ds_read_b64_tr_b16 v[200:201], v204 offset:128
  ds_read_b64_tr_b16 v[202:203], v204 offset:10368
  s_waitcnt lgkmcnt(0)
  buffer_store_dwordx4 v[184:187], v205, s[16:19], s32 offen sc1
  s_add_u32 s32, s32, 1024
  buffer_store_dwordx4 v[188:191], v205, s[16:19], s32 offen sc1
  s_add_u32 s32, s32, 1024
  buffer_store_dwordx4 v[192:195], v205, s[16:19], s32 offen sc1
  s_add_u32 s32, s32, 1024
  buffer_store_dwordx4 v[196:199], v205, s[16:19], s32 offen sc1
  s_add_u32 s32, s32, 1024
  buffer_store_dwordx4 v[200:203], v205, s[16:19], s32 offen sc1
  s_add_u32 s32, s32, 1024
p2_kernel_rf_none_20:
  v_mfma_f32_32x32x16_bf16 v[88:103], v[40:43], v[32:35], v[168:183]
  v_exp_f32 v72, v72
  ds_read2st64_b64 v[48:51], v11 offset0:2 offset1:3
  v_exp_f32 v73, v73
  ds_read_b64 v[52:53], v8 offset:4352
  v_exp_f32 v74, v74
  ds_read_b128 v[56:59], v7 offset:5120
  v_exp_f32 v75, v75
  ds_read_b128 v[60:63], v7 offset:6144
  v_mfma_f32_32x32x8_bf16 v[88:103], v[44:45], v[36:37], v[88:103]
  v_exp_f32 v76, v76
  v_exp_f32 v77, v77
  v_exp_f32 v78, v78
  v_exp_f32 v79, v79
  v_cvt_pk_bf16_f32 v104, v72, v73
  v_cvt_pk_bf16_f32 v105, v74, v75
  v_mfma_f32_32x32x16_bf16 v[136:151], v[64:67], v[112:115], v[136:151]
  v_exp_f32 v80, v80
  v_exp_f32 v81, v81
  v_exp_f32 v82, v82
  v_exp_f32 v83, v83
  v_cvt_pk_bf16_f32 v106, v76, v77
  v_cvt_pk_bf16_f32 v107, v78, v79
  v_mfma_f32_32x32x16_bf16 v[136:151], v[68:71], v[116:119], v[136:151]
  v_exp_f32 v84, v84
  v_exp_f32 v85, v85
  v_exp_f32 v86, v86
  v_exp_f32 v87, v87
  v_cvt_pk_bf16_f32 v108, v80, v81
  v_cvt_pk_bf16_f32 v109, v82, v83
  v_cvt_pk_bf16_f32 v110, v84, v85
  v_cvt_pk_bf16_f32 v111, v86, v87
  s_waitcnt lgkmcnt(0)
  v_mfma_f32_32x32x16_bf16 v[72:87], v[48:51], v[24:27], v[152:167]
  v_exp_f32 v88, v88
  v_exp_f32 v89, v89
  v_exp_f32 v90, v90
  v_exp_f32 v91, v91
  v_mfma_f32_32x32x8_bf16 v[72:87], v[52:53], v[28:29], v[72:87]
  v_exp_f32 v92, v92
  v_exp_f32 v93, v93
  v_exp_f32 v94, v94
  v_exp_f32 v95, v95
  v_cvt_pk_bf16_f32 v112, v88, v89
  v_cvt_pk_bf16_f32 v113, v90, v91
  v_mfma_f32_32x32x16_bf16 v[120:135], v[56:59], v[104:107], v[120:135]
  v_exp_f32 v96, v96
  v_exp_f32 v97, v97
  v_exp_f32 v98, v98
  v_exp_f32 v99, v99
  v_cvt_pk_bf16_f32 v114, v92, v93
  v_cvt_pk_bf16_f32 v115, v94, v95
  v_mfma_f32_32x32x16_bf16 v[120:135], v[60:63], v[108:111], v[120:135]
  v_exp_f32 v100, v100
  v_exp_f32 v101, v101
  v_exp_f32 v102, v102
  v_exp_f32 v103, v103
  v_cvt_pk_bf16_f32 v116, v96, v97
  v_cvt_pk_bf16_f32 v117, v98, v99
  v_cvt_pk_bf16_f32 v118, v100, v101
  v_cvt_pk_bf16_f32 v119, v102, v103
  v_mfma_f32_32x32x16_bf16 v[88:103], v[48:51], v[32:35], v[168:183]
  v_exp_f32 v72, v72
  ds_read2st64_b64 v[40:43], v11 offset0:4 offset1:5
  v_exp_f32 v73, v73
  ds_read_b64 v[44:45], v8 offset:4608
  v_exp_f32 v74, v74
  ds_read_b128 v[64:67], v7 offset:7168
  v_exp_f32 v75, v75
  ds_read_b128 v[68:71], v7 offset:8192
  v_mfma_f32_32x32x8_bf16 v[88:103], v[52:53], v[36:37], v[88:103]
  v_exp_f32 v76, v76
  v_exp_f32 v77, v77
  v_exp_f32 v78, v78
  v_exp_f32 v79, v79
  v_cvt_pk_bf16_f32 v104, v72, v73
  v_cvt_pk_bf16_f32 v105, v74, v75
  v_mfma_f32_32x32x16_bf16 v[136:151], v[56:59], v[112:115], v[136:151]
  v_exp_f32 v80, v80
  v_exp_f32 v81, v81
  v_exp_f32 v82, v82
  v_exp_f32 v83, v83
  v_cvt_pk_bf16_f32 v106, v76, v77
  v_cvt_pk_bf16_f32 v107, v78, v79
  v_mfma_f32_32x32x16_bf16 v[136:151], v[60:63], v[116:119], v[136:151]
  v_exp_f32 v84, v84
  v_exp_f32 v85, v85
  v_exp_f32 v86, v86
  v_exp_f32 v87, v87
  v_cvt_pk_bf16_f32 v108, v80, v81
  v_cvt_pk_bf16_f32 v109, v82, v83
  v_cvt_pk_bf16_f32 v110, v84, v85
  v_cvt_pk_bf16_f32 v111, v86, v87
  s_waitcnt lgkmcnt(0)
  v_mfma_f32_32x32x16_bf16 v[72:87], v[40:43], v[24:27], v[152:167]
  v_exp_f32 v88, v88
  v_exp_f32 v89, v89
  v_exp_f32 v90, v90
  v_exp_f32 v91, v91
  v_mfma_f32_32x32x8_bf16 v[72:87], v[44:45], v[28:29], v[72:87]
  v_exp_f32 v92, v92
  v_exp_f32 v93, v93
  v_exp_f32 v94, v94
  v_exp_f32 v95, v95
  v_cvt_pk_bf16_f32 v112, v88, v89
  v_cvt_pk_bf16_f32 v113, v90, v91
  v_mfma_f32_32x32x16_bf16 v[120:135], v[64:67], v[104:107], v[120:135]
  v_exp_f32 v96, v96
  v_exp_f32 v97, v97
  v_exp_f32 v98, v98
  v_exp_f32 v99, v99
  v_cvt_pk_bf16_f32 v114, v92, v93
  v_cvt_pk_bf16_f32 v115, v94, v95
  v_mfma_f32_32x32x16_bf16 v[120:135], v[68:71], v[108:111], v[120:135]
  v_exp_f32 v100, v100
  v_exp_f32 v101, v101
  v_exp_f32 v102, v102
  v_exp_f32 v103, v103
  v_cvt_pk_bf16_f32 v116, v96, v97
  v_cvt_pk_bf16_f32 v117, v98, v99
  v_cvt_pk_bf16_f32 v118, v100, v101
  v_cvt_pk_bf16_f32 v119, v102, v103
  v_mfma_f32_32x32x16_bf16 v[88:103], v[40:43], v[32:35], v[168:183]
  v_exp_f32 v72, v72
  ds_read2st64_b64 v[48:51], v11 offset0:6 offset1:7
  v_exp_f32 v73, v73
  ds_read_b64 v[52:53], v8 offset:4864
  v_exp_f32 v74, v74
  ds_read_b128 v[56:59], v7 offset:9216
  v_exp_f32 v75, v75
  ds_read_b128 v[60:63], v7 offset:10240
  v_mfma_f32_32x32x8_bf16 v[88:103], v[44:45], v[36:37], v[88:103]
  v_exp_f32 v76, v76
  v_exp_f32 v77, v77
  v_exp_f32 v78, v78
  v_exp_f32 v79, v79
  v_cvt_pk_bf16_f32 v104, v72, v73
  v_cvt_pk_bf16_f32 v105, v74, v75
  v_mfma_f32_32x32x16_bf16 v[136:151], v[64:67], v[112:115], v[136:151]
  v_exp_f32 v80, v80
  v_exp_f32 v81, v81
  v_exp_f32 v82, v82
  v_exp_f32 v83, v83
  v_cvt_pk_bf16_f32 v106, v76, v77
  v_cvt_pk_bf16_f32 v107, v78, v79
  v_mfma_f32_32x32x16_bf16 v[136:151], v[68:71], v[116:119], v[136:151]
  v_exp_f32 v84, v84
  v_exp_f32 v85, v85
  v_exp_f32 v86, v86
  v_exp_f32 v87, v87
  v_cvt_pk_bf16_f32 v108, v80, v81
  v_cvt_pk_bf16_f32 v109, v82, v83
  v_cvt_pk_bf16_f32 v110, v84, v85
  v_cvt_pk_bf16_f32 v111, v86, v87
  s_waitcnt lgkmcnt(0)
  v_mfma_f32_32x32x16_bf16 v[72:87], v[48:51], v[24:27], v[152:167]
  v_exp_f32 v88, v88
  s_add_u32 s32, s39, s46
  v_exp_f32 v89, v89
  s_nop 0
  v_exp_f32 v90, v90
  v_lshl_add_u32 v9, v1, 4, s32
  v_exp_f32 v91, v91
  v_lshl_add_u32 v10, v2, 3, s32
  v_mfma_f32_32x32x8_bf16 v[72:87], v[52:53], v[28:29], v[72:87]
  v_exp_f32 v92, v92
  v_lshl_add_u32 v12, v1, 3, s32
  v_exp_f32 v93, v93
  s_add_u32 s46, s46, 13312
  v_exp_f32 v94, v94
  s_cmp_eq_u32 s46, 39936
  s_cselect_b32 s46, 0, s46
  v_exp_f32 v95, v95
  v_cvt_pk_bf16_f32 v112, v88, v89
  v_cvt_pk_bf16_f32 v113, v90, v91
  v_mfma_f32_32x32x16_bf16 v[120:135], v[56:59], v[104:107], v[120:135]
  v_exp_f32 v96, v96
  v_exp_f32 v97, v97
  v_exp_f32 v98, v98
  v_exp_f32 v99, v99
  v_cvt_pk_bf16_f32 v114, v92, v93
  v_cvt_pk_bf16_f32 v115, v94, v95
  v_mfma_f32_32x32x16_bf16 v[120:135], v[60:63], v[108:111], v[120:135]
  v_exp_f32 v100, v100
  v_exp_f32 v101, v101
  v_exp_f32 v102, v102
  v_exp_f32 v103, v103
  v_cvt_pk_bf16_f32 v116, v96, v97
  v_cvt_pk_bf16_f32 v117, v98, v99
  v_cvt_pk_bf16_f32 v118, v100, v101
  v_cvt_pk_bf16_f32 v119, v102, v103
  s_waitcnt vmcnt(0)
  s_barrier
  v_mfma_f32_32x32x16_bf16 v[88:103], v[48:51], v[32:35], v[168:183]
  v_exp_f32 v72, v72
  ds_read2st64_b64 v[40:43], v12 offset0:0 offset1:1
  v_exp_f32 v73, v73
  ds_read_b64 v[44:45], v10 offset:4096
  v_exp_f32 v74, v74
  ds_read_b128 v[64:67], v7 offset:11264
  v_exp_f32 v75, v75
  ds_read_b128 v[68:71], v7 offset:12288
  v_mfma_f32_32x32x8_bf16 v[88:103], v[52:53], v[36:37], v[88:103]
  v_exp_f32 v76, v76
  s_add_u32 m0, s54, s40
  v_exp_f32 v77, v77
  s_add_u32 s34, s38, 640
  v_exp_f32 v78, v78
  buffer_load_dwordx4 v4, s[16:19], s36 offen sc1 lds
  v_exp_f32 v79, v79
  s_add_u32 m0, s55, s40
  v_cvt_pk_bf16_f32 v104, v72, v73
  v_cvt_pk_bf16_f32 v105, v74, v75
  v_mfma_f32_32x32x16_bf16 v[136:151], v[56:59], v[112:115], v[136:151]
  v_exp_f32 v80, v80
  s_add_u32 s36, s36, 4096
  v_exp_f32 v81, v81
  buffer_load_dwordx4 v4, s[16:19], s37 offen sc1 lds
  v_exp_f32 v82, v82
  s_add_u32 s37, s37, 1024
  v_exp_f32 v83, v83
  v_cvt_pk_bf16_f32 v106, v76, v77
  v_cvt_pk_bf16_f32 v107, v78, v79
  v_mfma_f32_32x32x16_bf16 v[136:151], v[60:63], v[116:119], v[136:151]
  v_exp_f32 v84, v84
  v_exp_f32 v85, v85
  v_exp_f32 v86, v86
  v_exp_f32 v87, v87
  v_cvt_pk_bf16_f32 v108, v80, v81
  v_cvt_pk_bf16_f32 v109, v82, v83
  v_cvt_pk_bf16_f32 v110, v84, v85
  v_cvt_pk_bf16_f32 v111, v86, v87
  s_waitcnt lgkmcnt(0)
  v_mfma_f32_32x32x16_bf16 v[72:87], v[40:43], v[24:27], v[152:167]
  v_exp_f32 v88, v88
  s_add_u32 m0, s56, s40
  s_mov_b64 exec, s[42:43]
  buffer_load_dwordx4 v6, s[16:19], s38 offen sc1 lds
  s_add_u32 m0, m0, 1024
  s_nop 0
  buffer_load_dwordx4 v6, s[16:19], s34 offen sc1 lds
  s_mov_b64 exec, -1
  v_exp_f32 v89, v89
  s_add_u32 s38, s38, 5120
  v_exp_f32 v90, v90
  s_add_u32 s40, s40, 13312
  v_exp_f32 v91, v91
  s_cmp_eq_u32 s40, 39936
  s_cselect_b32 s40, 0, s40
  v_mfma_f32_32x32x8_bf16 v[72:87], v[44:45], v[28:29], v[72:87]
  v_exp_f32 v92, v92
  v_mov_b32 v7, v9
  v_exp_f32 v93, v93
  v_mov_b32 v8, v10
  v_exp_f32 v94, v94
  v_mov_b32 v11, v12
  v_exp_f32 v95, v95
  s_add_u32 s41, s41, 1
  v_cvt_pk_bf16_f32 v112, v88, v89
  v_cvt_pk_bf16_f32 v113, v90, v91
  v_mfma_f32_32x32x16_bf16 v[120:135], v[64:67], v[104:107], v[120:135]
  v_exp_f32 v96, v96
  v_exp_f32 v97, v97
  v_exp_f32 v98, v98
  v_exp_f32 v99, v99
  v_cvt_pk_bf16_f32 v114, v92, v93
  v_cvt_pk_bf16_f32 v115, v94, v95
  v_mfma_f32_32x32x16_bf16 v[120:135], v[68:71], v[108:111], v[120:135]
  v_exp_f32 v100, v100
  v_exp_f32 v101, v101
  v_exp_f32 v102, v102
  v_exp_f32 v103, v103
  v_cvt_pk_bf16_f32 v116, v96, v97
  v_cvt_pk_bf16_f32 v117, v98, v99
  v_cvt_pk_bf16_f32 v118, v100, v101
  v_cvt_pk_bf16_f32 v119, v102, v103
  s_cmp_eq_u32 s76, 0
  s_cbranch_scc0 p2_kernel_rc_none_22
  s_cmp_eq_u32 s22, 0
  s_cbranch_scc0 p2_kernel_rc_none_22
  v_lshlrev_b32 v205, 2, v1
  v_add_u32 v204, 79872, v205
  ds_read_b32 v184, v204 offset:0
  ds_read_b32 v185, v204 offset:256
  ds_read_b32 v186, v204 offset:512
  ds_read_b32 v187, v204 offset:768
  s_waitcnt lgkmcnt(0)
  v_add_f32 v206, v184, v185
  v_add_f32 v206, v206, v186
  v_add_f32 v206, v206, v187
  ds_read_b32 v184, v204 offset:1024
  ds_read_b32 v185, v204 offset:1280
  ds_read_b32 v186, v204 offset:1536
  ds_read_b32 v187, v204 offset:1792
  s_waitcnt lgkmcnt(0)
  v_add_f32 v206, v206, v184
  v_add_f32 v206, v206, v185
  v_add_f32 v206, v206, v186
  v_add_f32 v206, v206, v187
  buffer_store_dword v206, v205, s[16:19], s78 offen sc1
p2_kernel_rc_none_22:
  v_mfma_f32_32x32x16_bf16 v[88:103], v[40:43], v[32:35], v[168:183]
  v_exp_f32 v72, v72
  ds_read2st64_b64 v[48:51], v11 offset0:2 offset1:3
  v_exp_f32 v73, v73
  ds_read_b64 v[52:53], v8 offset:4352
  v_exp_f32 v74, v74
  ds_read_b128 v[56:59], v7 offset:5120
  v_exp_f32 v75, v75
  ds_read_b128 v[60:63], v7 offset:6144
  v_mfma_f32_32x32x8_bf16 v[88:103], v[44:45], v[36:37], v[88:103]
  v_exp_f32 v76, v76
  v_exp_f32 v77, v77
  v_exp_f32 v78, v78
  v_exp_f32 v79, v79
  v_cvt_pk_bf16_f32 v104, v72, v73
  v_cvt_pk_bf16_f32 v105, v74, v75
  v_mfma_f32_32x32x16_bf16 v[136:151], v[64:67], v[112:115], v[136:151]
  v_exp_f32 v80, v80
  v_exp_f32 v81, v81
  v_exp_f32 v82, v82
  v_exp_f32 v83, v83
  v_cvt_pk_bf16_f32 v106, v76, v77
  v_cvt_pk_bf16_f32 v107, v78, v79
  v_mfma_f32_32x32x16_bf16 v[136:151], v[68:71], v[116:119], v[136:151]
  v_exp_f32 v84, v84
  v_exp_f32 v85, v85
  v_exp_f32 v86, v86
  v_exp_f32 v87, v87
  v_cvt_pk_bf16_f32 v108, v80, v81
  v_cvt_pk_bf16_f32 v109, v82, v83
  v_cvt_pk_bf16_f32 v110, v84, v85
  v_cvt_pk_bf16_f32 v111, v86, v87
  s_waitcnt lgkmcnt(0)
  v_mfma_f32_32x32x16_bf16 v[72:87], v[48:51], v[24:27], v[152:167]
  v_exp_f32 v88, v88
  v_exp_f32 v89, v89
  v_exp_f32 v90, v90
  v_exp_f32 v91, v91
  v_mfma_f32_32x32x8_bf16 v[72:87], v[52:53], v[28:29], v[72:87]
  v_exp_f32 v92, v92
  v_exp_f32 v93, v93
  v_exp_f32 v94, v94
  v_exp_f32 v95, v95
  v_cvt_pk_bf16_f32 v112, v88, v89
  v_cvt_pk_bf16_f32 v113, v90, v91
  v_mfma_f32_32x32x16_bf16 v[120:135], v[56:59], v[104:107], v[120:135]
  v_exp_f32 v96, v96
  v_exp_f32 v97, v97
  v_exp_f32 v98, v98
  v_exp_f32 v99, v99
  v_cvt_pk_bf16_f32 v114, v92, v93
  v_cvt_pk_bf16_f32 v115, v94, v95
  v_mfma_f32_32x32x16_bf16 v[120:135], v[60:63], v[108:111], v[120:135]
  v_exp_f32 v100, v100
  v_exp_f32 v101, v101
  v_exp_f32 v102, v102
  v_exp_f32 v103, v103
  v_cvt_pk_bf16_f32 v116, v96, v97
  v_cvt_pk_bf16_f32 v117, v98, v99
  v_cvt_pk_bf16_f32 v118, v100, v101
  v_cvt_pk_bf16_f32 v119, v102, v103
  v_mfma_f32_32x32x16_bf16 v[88:103], v[48:51], v[32:35], v[168:183]
  v_exp_f32 v72, v72
  ds_read2st64_b64 v[40:43], v11 offset0:4 offset1:5
  v_exp_f32 v73, v73
  ds_read_b64 v[44:45], v8 offset:4608
  v_exp_f32 v74, v74
  ds_read_b128 v[64:67], v7 offset:7168
  v_exp_f32 v75, v75
  ds_read_b128 v[68:71], v7 offset:8192
  v_mfma_f32_32x32x8_bf16 v[88:103], v[52:53], v[36:37], v[88:103]
  v_exp_f32 v76, v76
  v_exp_f32 v77, v77
  v_exp_f32 v78, v78
  v_exp_f32 v79, v79
  v_cvt_pk_bf16_f32 v104, v72, v73
  v_cvt_pk_bf16_f32 v105, v74, v75
  v_mfma_f32_32x32x16_bf16 v[136:151], v[56:59], v[112:115], v[136:151]
  v_exp_f32 v80, v80
  v_exp_f32 v81, v81
  v_exp_f32 v82, v82
  v_exp_f32 v83, v83
  v_cvt_pk_bf16_f32 v106, v76, v77
  v_cvt_pk_bf16_f32 v107, v78, v79
  v_mfma_f32_32x32x16_bf16 v[136:151], v[60:63], v[116:119], v[136:151]
  v_exp_f32 v84, v84
  v_exp_f32 v85, v85
  v_exp_f32 v86, v86
  v_exp_f32 v87, v87
  v_cvt_pk_bf16_f32 v108, v80, v81
  v_cvt_pk_bf16_f32 v109, v82, v83
  v_cvt_pk_bf16_f32 v110, v84, v85
  v_cvt_pk_bf16_f32 v111, v86, v87
  s_waitcnt lgkmcnt(0)
  v_mfma_f32_32x32x16_bf16 v[72:87], v[40:43], v[24:27], v[152:167]
  v_exp_f32 v88, v88
  v_exp_f32 v89, v89
  v_exp_f32 v90, v90
  v_exp_f32 v91, v91
  v_mfma_f32_32x32x8_bf16 v[72:87], v[44:45], v[28:29], v[72:87]
  v_exp_f32 v92, v92
  v_exp_f32 v93, v93
  v_exp_f32 v94, v94
  v_exp_f32 v95, v95
  v_cvt_pk_bf16_f32 v112, v88, v89
  v_cvt_pk_bf16_f32 v113, v90, v91
  v_mfma_f32_32x32x16_bf16 v[120:135], v[64:67], v[104:107], v[120:135]
  v_exp_f32 v96, v96
  v_exp_f32 v97, v97
  v_exp_f32 v98, v98
  v_exp_f32 v99, v99
  v_cvt_pk_bf16_f32 v114, v92, v93
  v_cvt_pk_bf16_f32 v115, v94, v95
  v_mfma_f32_32x32x16_bf16 v[120:135], v[68:71], v[108:111], v[120:135]
  v_exp_f32 v100, v100
  v_exp_f32 v101, v101
  v_exp_f32 v102, v102
  v_exp_f32 v103, v103
  v_cvt_pk_bf16_f32 v116, v96, v97
  v_cvt_pk_bf16_f32 v117, v98, v99
  v_cvt_pk_bf16_f32 v118, v100, v101
  v_cvt_pk_bf16_f32 v119, v102, v103
  v_mfma_f32_32x32x16_bf16 v[88:103], v[40:43], v[32:35], v[168:183]
  v_exp_f32 v72, v72
  ds_read2st64_b64 v[48:51], v11 offset0:6 offset1:7
  v_exp_f32 v73, v73
  ds_read_b64 v[52:53], v8 offset:4864
  v_exp_f32 v74, v74
  ds_read_b128 v[56:59], v7 offset:9216
  v_exp_f32 v75, v75
  ds_read_b128 v[60:63], v7 offset:10240
  v_mfma_f32_32x32x8_bf16 v[88:103], v[44:45], v[36:37], v[88:103]
  v_exp_f32 v76, v76
  v_exp_f32 v77, v77
  v_exp_f32 v78, v78
  v_exp_f32 v79, v79
  v_cvt_pk_bf16_f32 v104, v72, v73
  v_cvt_pk_bf16_f32 v105, v74, v75
  v_mfma_f32_32x32x16_bf16 v[136:151], v[64:67], v[112:115], v[136:151]
  v_exp_f32 v80, v80
  v_exp_f32 v81, v81
  v_exp_f32 v82, v82
  v_exp_f32 v83, v83
  v_cvt_pk_bf16_f32 v106, v76, v77
  v_cvt_pk_bf16_f32 v107, v78, v79
  v_mfma_f32_32x32x16_bf16 v[136:151], v[68:71], v[116:119], v[136:151]
  v_exp_f32 v84, v84
  v_exp_f32 v85, v85
  v_exp_f32 v86, v86
  v_exp_f32 v87, v87
  v_cvt_pk_bf16_f32 v108, v80, v81
  v_cvt_pk_bf16_f32 v109, v82, v83
  v_cvt_pk_bf16_f32 v110, v84, v85
  v_cvt_pk_bf16_f32 v111, v86, v87
  s_waitcnt lgkmcnt(0)
  v_mfma_f32_32x32x16_bf16 v[72:87], v[48:51], v[24:27], v[152:167]
  v_exp_f32 v88, v88
  s_add_u32 s32, s39, s46
  v_exp_f32 v89, v89
  s_nop 0
  v_exp_f32 v90, v90
  v_lshl_add_u32 v9, v1, 4, s32
  v_exp_f32 v91, v91
  v_lshl_add_u32 v10, v2, 3, s32
  v_mfma_f32_32x32x8_bf16 v[72:87], v[52:53], v[28:29], v[72:87]
  v_exp_f32 v92, v92
  v_lshl_add_u32 v12, v1, 3, s32
  v_exp_f32 v93, v93
  s_add_u32 s46, s46, 13312
  v_exp_f32 v94, v94
  s_cmp_eq_u32 s46, 39936
  s_cselect_b32 s46, 0, s46
  v_exp_f32 v95, v95
  v_cvt_pk_bf16_f32 v112, v88, v89
  v_cvt_pk_bf16_f32 v113, v90, v91
  v_mfma_f32_32x32x16_bf16 v[120:135], v[56:59], v[104:107], v[120:135]
  v_exp_f32 v96, v96
  v_exp_f32 v97, v97
  v_exp_f32 v98, v98
  v_exp_f32 v99, v99
  v_cvt_pk_bf16_f32 v114, v92, v93
  v_cvt_pk_bf16_f32 v115, v94, v95
  v_mfma_f32_32x32x16_bf16 v[120:135], v[60:63], v[108:111], v[120:135]
  v_exp_f32 v100, v100
  v_exp_f32 v101, v101
  v_exp_f32 v102, v102
  v_exp_f32 v103, v103
  v_cvt_pk_bf16_f32 v116, v96, v97
  v_cvt_pk_bf16_f32 v117, v98, v99
  v_cvt_pk_bf16_f32 v118, v100, v101
  v_cvt_pk_bf16_f32 v119, v102, v103
  s_waitcnt vmcnt(0)
  s_barrier
  s_cmp_eq_u32 s22, 0
  s_cbranch_scc0 p2_kernel_rpd_23
  s_cmp_eq_u32 s76, 3
  s_cbranch_scc1 p2_kernel_rpd_23
  v_mov_b32 v205, 8
  v_mov_b32 v206, 1
  s_mov_b64 exec, 1
  buffer_atomic_add v206, v205, s[88:91], 0 offen sc1
  s_mov_b64 exec, -1
p2_kernel_rpd_23:
  v_mfma_f32_32x32x16_bf16 v[88:103], v[48:51], v[32:35], v[168:183]
  v_exp_f32 v72, v72
  ds_read2st64_b64 v[40:43], v12 offset0:0 offset1:1
  v_exp_f32 v73, v73
  ds_read_b64 v[44:45], v10 offset:4096
  v_exp_f32 v74, v74
  ds_read_b128 v[64:67], v7 offset:11264
  v_exp_f32 v75, v75
  ds_read_b128 v[68:71], v7 offset:12288
  v_mfma_f32_32x32x8_bf16 v[88:103], v[52:53], v[36:37], v[88:103]
  v_exp_f32 v76, v76
  s_add_u32 m0, s54, s40
  v_exp_f32 v77, v77
  s_add_u32 s34, s38, 640
  v_exp_f32 v78, v78
  buffer_load_dwordx4 v4, s[16:19], s36 offen sc1 lds
  v_exp_f32 v79, v79
  s_add_u32 m0, s55, s40
  v_cvt_pk_bf16_f32 v104, v72, v73
  v_cvt_pk_bf16_f32 v105, v74, v75
  v_mfma_f32_32x32x16_bf16 v[136:151], v[56:59], v[112:115], v[136:151]
  v_exp_f32 v80, v80
  s_add_u32 s36, s36, 4096
  v_exp_f32 v81, v81
  buffer_load_dwordx4 v4, s[16:19], s37 offen sc1 lds
  v_exp_f32 v82, v82
  s_add_u32 s37, s37, 1024
  v_exp_f32 v83, v83
  v_cvt_pk_bf16_f32 v106, v76, v77
  v_cvt_pk_bf16_f32 v107, v78, v79
  v_mfma_f32_32x32x16_bf16 v[136:151], v[60:63], v[116:119], v[136:151]
  v_exp_f32 v84, v84
  v_exp_f32 v85, v85
  v_exp_f32 v86, v86
  v_exp_f32 v87, v87
  v_cvt_pk_bf16_f32 v108, v80, v81
  v_cvt_pk_bf16_f32 v109, v82, v83
  v_cvt_pk_bf16_f32 v110, v84, v85
  v_cvt_pk_bf16_f32 v111, v86, v87
  s_waitcnt lgkmcnt(0)
  v_mfma_f32_32x32x16_bf16 v[72:87], v[40:43], v[24:27], v[152:167]
  v_exp_f32 v88, v88
  s_add_u32 m0, s56, s40
  s_mov_b64 exec, s[42:43]
  buffer_load_dwordx4 v6, s[16:19], s38 offen sc1 lds
  s_add_u32 m0, m0, 1024
  s_nop 0
  buffer_load_dwordx4 v6, s[16:19], s34 offen sc1 lds
  s_mov_b64 exec, -1
  v_exp_f32 v89, v89
  s_add_u32 s38, s38, 5120
  v_exp_f32 v90, v90
  s_add_u32 s40, s40, 13312
  v_exp_f32 v91, v91
  s_cmp_eq_u32 s40, 39936
  s_cselect_b32 s40, 0, s40
  v_mfma_f32_32x32x8_bf16 v[72:87], v[44:45], v[28:29], v[72:87]
  v_exp_f32 v92, v92
  v_mov_b32 v7, v9
  v_exp_f32 v93, v93
  v_mov_b32 v8, v10
  v_exp_f32 v94, v94
  v_mov_b32 v11, v12
  v_exp_f32 v95, v95
  s_add_u32 s41, s41, 1
  v_cvt_pk_bf16_f32 v112, v88, v89
  v_cvt_pk_bf16_f32 v113, v90, v91
  v_mfma_f32_32x32x16_bf16 v[120:135], v[64:67], v[104:107], v[120:135]
  v_exp_f32 v96, v96
  v_exp_f32 v97, v97
  v_exp_f32 v98, v98
  v_exp_f32 v99, v99
  v_cvt_pk_bf16_f32 v114, v92, v93
  v_cvt_pk_bf16_f32 v115, v94, v95
  v_mfma_f32_32x32x16_bf16 v[120:135], v[68:71], v[108:111], v[120:135]
  v_exp_f32 v100, v100
  v_exp_f32 v101, v101
  v_exp_f32 v102, v102
  v_exp_f32 v103, v103
  v_cvt_pk_bf16_f32 v116, v96, v97
  v_cvt_pk_bf16_f32 v117, v98, v99
  v_cvt_pk_bf16_f32 v118, v100, v101
  v_cvt_pk_bf16_f32 v119, v102, v103
p2_kernel_loop:
  v_mfma_f32_32x32x16_bf16 v[88:103], v[40:43], v[32:35], v[168:183]
  v_exp_f32 v72, v72
  ds_read2st64_b64 v[48:51], v11 offset0:2 offset1:3
  v_exp_f32 v73, v73
  ds_read_b64 v[52:53], v8 offset:4352
  v_exp_f32 v74, v74
  ds_read_b128 v[56:59], v7 offset:5120
  v_exp_f32 v75, v75
  ds_read_b128 v[60:63], v7 offset:6144
  v_mfma_f32_32x32x8_bf16 v[88:103], v[44:45], v[36:37], v[88:103]
  v_exp_f32 v76, v76
  v_exp_f32 v77, v77
  v_exp_f32 v78, v78
  v_exp_f32 v79, v79
  v_cvt_pk_bf16_f32 v104, v72, v73
  v_cvt_pk_bf16_f32 v105, v74, v75
  v_mfma_f32_32x32x16_bf16 v[136:151], v[64:67], v[112:115], v[136:151]
  v_exp_f32 v80, v80
  v_exp_f32 v81, v81
  v_exp_f32 v82, v82
  v_exp_f32 v83, v83
  v_cvt_pk_bf16_f32 v106, v76, v77
  v_cvt_pk_bf16_f32 v107, v78, v79
  v_mfma_f32_32x32x16_bf16 v[136:151], v[68:71], v[116:119], v[136:151]
  v_exp_f32 v84, v84
  v_exp_f32 v85, v85
  v_exp_f32 v86, v86
  v_exp_f32 v87, v87
  v_cvt_pk_bf16_f32 v108, v80, v81
  v_cvt_pk_bf16_f32 v109, v82, v83
  v_cvt_pk_bf16_f32 v110, v84, v85
  v_cvt_pk_bf16_f32 v111, v86, v87
  s_waitcnt lgkmcnt(0)
  v_mfma_f32_32x32x16_bf16 v[72:87], v[48:51], v[24:27], v[152:167]
  v_exp_f32 v88, v88
  v_exp_f32 v89, v89
  v_exp_f32 v90, v90
  v_exp_f32 v91, v91
  v_mfma_f32_32x32x8_bf16 v[72:87], v[52:53], v[28:29], v[72:87]
  v_exp_f32 v92, v92
  v_exp_f32 v93, v93
  v_exp_f32 v94, v94
  v_exp_f32 v95, v95
  v_cvt_pk_bf16_f32 v112, v88, v89
  v_cvt_pk_bf16_f32 v113, v90, v91
  v_mfma_f32_32x32x16_bf16 v[120:135], v[56:59], v[104:107], v[120:135]
  v_exp_f32 v96, v96
  v_exp_f32 v97, v97
  v_exp_f32 v98, v98
  v_exp_f32 v99, v99
  v_cvt_pk_bf16_f32 v114, v92, v93
  v_cvt_pk_bf16_f32 v115, v94, v95
  v_mfma_f32_32x32x16_bf16 v[120:135], v[60:63], v[108:111], v[120:135]
  v_exp_f32 v100, v100
  v_exp_f32 v101, v101
  v_exp_f32 v102, v102
  v_exp_f32 v103, v103
  v_cvt_pk_bf16_f32 v116, v96, v97
  v_cvt_pk_bf16_f32 v117, v98, v99
  v_cvt_pk_bf16_f32 v118, v100, v101
  v_cvt_pk_bf16_f32 v119, v102, v103
  v_mfma_f32_32x32x16_bf16 v[88:103], v[48:51], v[32:35], v[168:183]
  v_exp_f32 v72, v72
  ds_read2st64_b64 v[40:43], v11 offset0:4 offset1:5
  v_exp_f32 v73, v73
  ds_read_b64 v[44:45], v8 offset:4608
  v_exp_f32 v74, v74
  ds_read_b128 v[64:67], v7 offset:7168
  v_exp_f32 v75, v75
  ds_read_b128 v[68:71], v7 offset:8192
  v_mfma_f32_32x32x8_bf16 v[88:103], v[52:53], v[36:37], v[88:103]
  v_exp_f32 v76, v76
  v_exp_f32 v77, v77
  v_exp_f32 v78, v78
  v_exp_f32 v79, v79
  v_cvt_pk_bf16_f32 v104, v72, v73
  v_cvt_pk_bf16_f32 v105, v74, v75
  v_mfma_f32_32x32x16_bf16 v[136:151], v[56:59], v[112:115], v[136:151]
  v_exp_f32 v80, v80
  v_exp_f32 v81, v81
  v_exp_f32 v82, v82
  v_exp_f32 v83, v83
  v_cvt_pk_bf16_f32 v106, v76, v77
  v_cvt_pk_bf16_f32 v107, v78, v79
  v_mfma_f32_32x32x16_bf16 v[136:151], v[60:63], v[116:119], v[136:151]
  v_exp_f32 v84, v84
  v_exp_f32 v85, v85
  v_exp_f32 v86, v86
  v_exp_f32 v87, v87
  v_cvt_pk_bf16_f32 v108, v80, v81
  v_cvt_pk_bf16_f32 v109, v82, v83
  v_cvt_pk_bf16_f32 v110, v84, v85
  v_cvt_pk_bf16_f32 v111, v86, v87
  s_waitcnt lgkmcnt(0)
  v_mfma_f32_32x32x16_bf16 v[72:87], v[40:43], v[24:27], v[152:167]
  v_exp_f32 v88, v88
  v_exp_f32 v89, v89
  v_exp_f32 v90, v90
  v_exp_f32 v91, v91
  v_mfma_f32_32x32x8_bf16 v[72:87], v[44:45], v[28:29], v[72:87]
  v_exp_f32 v92, v92
  v_exp_f32 v93, v93
  v_exp_f32 v94, v94
  v_exp_f32 v95, v95
  v_cvt_pk_bf16_f32 v112, v88, v89
  v_cvt_pk_bf16_f32 v113, v90, v91
  v_mfma_f32_32x32x16_bf16 v[120:135], v[64:67], v[104:107], v[120:135]
  v_exp_f32 v96, v96
  v_exp_f32 v97, v97
  v_exp_f32 v98, v98
  v_exp_f32 v99, v99
  v_cvt_pk_bf16_f32 v114, v92, v93
  v_cvt_pk_bf16_f32 v115, v94, v95
  v_mfma_f32_32x32x16_bf16 v[120:135], v[68:71], v[108:111], v[120:135]
  v_exp_f32 v100, v100
  v_exp_f32 v101, v101
  v_exp_f32 v102, v102
  v_exp_f32 v103, v103
  v_cvt_pk_bf16_f32 v116, v96, v97
  v_cvt_pk_bf16_f32 v117, v98, v99
  v_cvt_pk_bf16_f32 v118, v100, v101
  v_cvt_pk_bf16_f32 v119, v102, v103
  v_mfma_f32_32x32x16_bf16 v[88:103], v[40:43], v[32:35], v[168:183]
  v_exp_f32 v72, v72
  ds_read2st64_b64 v[48:51], v11 offset0:6 offset1:7
  v_exp_f32 v73, v73
  ds_read_b64 v[52:53], v8 offset:4864
  v_exp_f32 v74, v74
  ds_read_b128 v[56:59], v7 offset:9216
  v_exp_f32 v75, v75
  ds_read_b128 v[60:63], v7 offset:10240
  v_mfma_f32_32x32x8_bf16 v[88:103], v[44:45], v[36:37], v[88:103]
  v_exp_f32 v76, v76
  v_exp_f32 v77, v77
  v_exp_f32 v78, v78
  v_exp_f32 v79, v79
  v_cvt_pk_bf16_f32 v104, v72, v73
  v_cvt_pk_bf16_f32 v105, v74, v75
  v_mfma_f32_32x32x16_bf16 v[136:151], v[64:67], v[112:115], v[136:151]
  v_exp_f32 v80, v80
  v_exp_f32 v81, v81
  v_exp_f32 v82, v82
  v_exp_f32 v83, v83
  v_cvt_pk_bf16_f32 v106, v76, v77
  v_cvt_pk_bf16_f32 v107, v78, v79
  v_mfma_f32_32x32x16_bf16 v[136:151], v[68:71], v[116:119], v[136:151]
  v_exp_f32 v84, v84
  v_exp_f32 v85, v85
  v_exp_f32 v86, v86
  v_exp_f32 v87, v87
  v_cvt_pk_bf16_f32 v108, v80, v81
  v_cvt_pk_bf16_f32 v109, v82, v83
  v_cvt_pk_bf16_f32 v110, v84, v85
  v_cvt_pk_bf16_f32 v111, v86, v87
  s_waitcnt lgkmcnt(0)
  v_mfma_f32_32x32x16_bf16 v[72:87], v[48:51], v[24:27], v[152:167]
  v_exp_f32 v88, v88
  s_add_u32 s32, s39, s46
  v_exp_f32 v89, v89
  s_nop 0
  v_exp_f32 v90, v90
  v_lshl_add_u32 v9, v1, 4, s32
  v_exp_f32 v91, v91
  v_lshl_add_u32 v10, v2, 3, s32
  v_mfma_f32_32x32x8_bf16 v[72:87], v[52:53], v[28:29], v[72:87]
  v_exp_f32 v92, v92
  v_lshl_add_u32 v12, v1, 3, s32
  v_exp_f32 v93, v93
  s_add_u32 s46, s46, 13312
  v_exp_f32 v94, v94
  s_cmp_eq_u32 s46, 39936
  s_cselect_b32 s46, 0, s46
  v_exp_f32 v95, v95
  v_cvt_pk_bf16_f32 v112, v88, v89
  v_cvt_pk_bf16_f32 v113, v90, v91
  v_mfma_f32_32x32x16_bf16 v[120:135], v[56:59], v[104:107], v[120:135]
  v_exp_f32 v96, v96
  v_exp_f32 v97, v97
  v_exp_f32 v98, v98
  v_exp_f32 v99, v99
  v_cvt_pk_bf16_f32 v114, v92, v93
  v_cvt_pk_bf16_f32 v115, v94, v95
  v_mfma_f32_32x32x16_bf16 v[120:135], v[60:63], v[108:111], v[120:135]
  v_exp_f32 v100, v100
  v_exp_f32 v101, v101
  v_exp_f32 v102, v102
  v_exp_f32 v103, v103
  v_cvt_pk_bf16_f32 v116, v96, v97
  v_cvt_pk_bf16_f32 v117, v98, v99
  v_cvt_pk_bf16_f32 v118, v100, v101
  v_cvt_pk_bf16_f32 v119, v102, v103
  s_waitcnt vmcnt(0)
  s_barrier
  v_mfma_f32_32x32x16_bf16 v[88:103], v[48:51], v[32:35], v[168:183]
  v_exp_f32 v72, v72
  ds_read2st64_b64 v[40:43], v12 offset0:0 offset1:1
  v_exp_f32 v73, v73
  ds_read_b64 v[44:45], v10 offset:4096
  v_exp_f32 v74, v74
  ds_read_b128 v[64:67], v7 offset:11264
  v_exp_f32 v75, v75
  ds_read_b128 v[68:71], v7 offset:12288
  v_mfma_f32_32x32x8_bf16 v[88:103], v[52:53], v[36:37], v[88:103]
  v_exp_f32 v76, v76
  v_readfirstlane_b32 s32, v254
  v_exp_f32 v77, v77
  s_cmp_eq_u32 s32, 182
  s_cselect_b32 s84, s83, 0x7ff00000
  s_cselect_b32 s85, 1, 0
  v_exp_f32 v78, v78
  s_cmp_eq_u32 s41, 99
  s_cselect_b32 s84, s84, 0x7ff00000
  v_exp_f32 v79, v79
  s_add_u32 m0, s54, s40
  v_cvt_pk_bf16_f32 v104, v72, v73
  v_cvt_pk_bf16_f32 v105, v74, v75
  v_mfma_f32_32x32x16_bf16 v[136:151], v[56:59], v[112:115], v[136:151]
  v_exp_f32 v80, v80
  s_add_u32 s34, s38, 640
  v_exp_f32 v81, v81
  buffer_load_dwordx4 v4, s[16:19], s36 offen sc1 lds
  v_exp_f32 v82, v82
  s_add_u32 m0, s55, s40
  v_exp_f32 v83, v83
  s_add_u32 s36, s36, 4096
  v_cvt_pk_bf16_f32 v106, v76, v77
  v_cvt_pk_bf16_f32 v107, v78, v79
  v_mfma_f32_32x32x16_bf16 v[136:151], v[60:63], v[116:119], v[136:151]
  v_exp_f32 v84, v84
  buffer_load_dwordx4 v4, s[16:19], s37 offen sc1 lds
  v_exp_f32 v85, v85
  s_add_u32 s37, s37, 1024
  v_exp_f32 v86, v86
  v_exp_f32 v87, v87
  v_cvt_pk_bf16_f32 v108, v80, v81
  v_cvt_pk_bf16_f32 v109, v82, v83
  v_cvt_pk_bf16_f32 v110, v84, v85
  v_cvt_pk_bf16_f32 v111, v86, v87
  s_waitcnt lgkmcnt(0)
  v_mfma_f32_32x32x16_bf16 v[72:87], v[40:43], v[24:27], v[152:167]
  v_exp_f32 v88, v88
  s_add_u32 m0, s56, s40
  s_mov_b64 exec, s[42:43]
  buffer_load_dwordx4 v6, s[16:19], s38 offen sc1 lds
  s_add_u32 m0, m0, 1024
  s_nop 0
  buffer_load_dwordx4 v6, s[16:19], s34 offen sc1 lds
  s_mov_b64 exec, -1
  v_exp_f32 v89, v89
  s_add_u32 s38, s38, 5120
  v_exp_f32 v90, v90
  s_add_u32 s40, s40, 13312
  v_exp_f32 v91, v91
  s_cmp_eq_u32 s40, 39936
  s_cselect_b32 s40, 0, s40
  v_mfma_f32_32x32x8_bf16 v[72:87], v[44:45], v[28:29], v[72:87]
  v_exp_f32 v92, v92
  buffer_load_dword v206, v208, s[16:19], s84 offen
  v_exp_f32 v93, v93
  v_mov_b32 v205, 8
  v_exp_f32 v94, v94
  s_nop 0
  v_exp_f32 v95, v95
  buffer_load_dword v254, v205, s[88:91], 0 offen sc1
  v_cvt_pk_bf16_f32 v112, v88, v89
  v_cvt_pk_bf16_f32 v113, v90, v91
  v_mfma_f32_32x32x16_bf16 v[120:135], v[64:67], v[104:107], v[120:135]
  v_exp_f32 v96, v96
  v_mov_b32 v7, v9
  v_exp_f32 v97, v97
  v_mov_b32 v8, v10
  v_exp_f32 v98, v98
  v_mov_b32 v11, v12
  v_exp_f32 v99, v99
  s_add_u32 s41, s41, 1
  v_cvt_pk_bf16_f32 v114, v92, v93
  v_cvt_pk_bf16_f32 v115, v94, v95
  v_mfma_f32_32x32x16_bf16 v[120:135], v[68:71], v[108:111], v[120:135]
  v_exp_f32 v100, v100
  v_exp_f32 v101, v101
  v_exp_f32 v102, v102
  v_exp_f32 v103, v103
  v_cvt_pk_bf16_f32 v116, v96, v97
  v_cvt_pk_bf16_f32 v117, v98, v99
  v_cvt_pk_bf16_f32 v118, v100, v101
  v_cvt_pk_bf16_f32 v119, v102, v103
  s_cmp_lt_u32 s41, 8
  s_cbranch_scc1 p2_kernel_loop
  s_nop 1
  v_mfma_f32_32x32x16_bf16 v[136:151], v[64:67], v[112:115], v[136:151]
  v_mfma_f32_32x32x16_bf16 v[136:151], v[68:71], v[116:119], v[136:151]
  s_nop 7
  s_nop 7
  s_lshl_b32 s32, s28, 1
  s_add_u32 s32, s32, s23
  s_mul_i32 s33, s32, 3072
  s_add_u32 s33, s33, 108608
  v_lshl_add_u32 v14, v1, 4, s33
  s_xor_b32 s32, s32, 1
  s_mul_i32 s33, s32, 3072
  s_add_u32 s33, s33, 108608
  v_lshl_add_u32 v15, v1, 4, s33
  s_cmp_eq_u32 s23, 0
  s_cbranch_scc0 p2_kernel_k1_24
  ds_write_b128 v14, v[136:139] offset:0
  ds_write_b128 v14, v[140:143] offset:1024
  ds_write_b128 v14, v[144:147] offset:2048
  s_branch p2_kernel_k2_25
p2_kernel_k1_24:
  ds_write_b128 v14, v[120:123] offset:0
  ds_write_b128 v14, v[124:127] offset:1024
  ds_write_b128 v14, v[128:131] offset:2048
  v_mov_b32 v120, v136
  v_mov_b32 v121, v137
  v_mov_b32 v122, v138
  v_mov_b32 v123, v139
  v_mov_b32 v124, v140
  v_mov_b32 v125, v141
  v_mov_b32 v126, v142
  v_mov_b32 v127, v143
  v_mov_b32 v128, v144
  v_mov_b32 v129, v145
  v_mov_b32 v130, v146
  v_mov_b32 v131, v147
p2_kernel_k2_25:
  s_waitcnt lgkmcnt(0)
  s_barrier
  s_cmp_eq_u32 s47, 0
  s_cbranch_scc0 p2_kernel_noep_26
  s_cmp_eq_u32 s85, 1
  s_cbranch_scc1 p2_kernel_cok_28
  s_mov_b32 s99, 0
p2_kernel_cspin_27:
  s_waitcnt vmcnt(0)
  v_mov_b32 v254, 8
  buffer_load_dword v254, v254, s[88:91], 0 offen sc1
  s_waitcnt vmcnt(0)
  v_readfirstlane_b32 s98, v254
  s_add_u32 s99, s99, 1
  s_cmp_ge_u32 s99, 0x100000
  s_cbranch_scc1 p2_kernel_cok_28
  s_cmp_eq_u32 s98, 182
  s_cbranch_scc0 p2_kernel_cspin_27
p2_kernel_cok_28:
  s_mov_b32 s85, 1
p2_kernel_noep_26:
  ds_read_b128 v[72:75], v15 offset:0
  ds_read_b128 v[76:79], v15 offset:1024
  ds_read_b128 v[80:83], v15 offset:2048
  s_waitcnt lgkmcnt(0)
  v_add_f32 v120, v120, v72
  v_add_f32 v121, v121, v73
  v_add_f32 v122, v122, v74
  v_add_f32 v123, v123, v75
  v_add_f32 v124, v124, v76
  v_add_f32 v125, v125, v77
  v_add_f32 v126, v126, v78
  v_add_f32 v127, v127, v79
  v_add_f32 v128, v128, v80
  v_add_f32 v129, v129, v81
  v_add_f32 v130, v130, v82
  v_add_f32 v131, v131, v83
  v_mov_b32 v16, v128
  v_mov_b32 v17, v128
  s_nop 1
  v_permlane32_swap_b32 v16, v17
  s_cmp_eq_u32 s47, 0
  s_cbranch_scc0 p2_kernel_fin
  s_mov_b32 s32, 0x1f800000
  s_mov_b32 s33, 0x5f800000
  v_cmp_le_f32 vcc, s32, v17
  v_cmp_ge_f32 s[52:53], s33, v17
  s_and_b64 vcc, vcc, s[52:53]
  v_mov_b32 v18, 0x207
  v_cmp_class_f32 s[52:53], v120, v18
  s_andn2_b64 vcc, vcc, s[52:53]
  v_cmp_class_f32 s[52:53], v121, v18
  s_andn2_b64 vcc, vcc, s[52:53]
  v_cmp_class_f32 s[52:53], v122, v18
  s_andn2_b64 vcc, vcc, s[52:53]
  v_cmp_class_f32 s[52:53], v123, v18
  s_andn2_b64 vcc, vcc, s[52:53]
  v_cmp_class_f32 s[52:53], v124, v18
  s_andn2_b64 vcc, vcc, s[52:53]
  v_cmp_class_f32 s[52:53], v125, v18
  s_andn2_b64 vcc, vcc, s[52:53]
  v_cmp_class_f32 s[52:53], v126, v18
  s_andn2_b64 vcc, vcc, s[52:53]
  v_cmp_class_f32 s[52:53], v127, v18
  s_andn2_b64 vcc, vcc, s[52:53]
  v_cmp_class_f32 s[52:53], v128, v18
  s_mov_b32 s53, 0
  s_andn2_b64 vcc, vcc, s[52:53]
  v_cmp_class_f32 s[52:53], v129, v18
  s_mov_b32 s53, 0
  s_andn2_b64 vcc, vcc, s[52:53]
  v_cmp_class_f32 s[52:53], v130, v18
  s_mov_b32 s53, 0
  s_andn2_b64 vcc, vcc, s[52:53]
  v_cmp_class_f32 s[52:53], v131, v18
  s_mov_b32 s53, 0
  s_andn2_b64 vcc, vcc, s[52:53]
  s_not_b64 s[52:53], vcc
  s_cmp_lg_u64 s[52:53], 0
  s_cselect_b32 s32, 1, 0
  v_mov_b32 v18, s32
  s_lshl_b32 s33, s22, 2
  s_add_u32 s33, s33, 141376
  v_mov_b32 v19, s33
  ds_write_b32 v19, v18
  s_waitcnt lgkmcnt(0)
  s_barrier
  v_and_b32 v19, 7, v1
  v_lshlrev_b32 v19, 2, v19
  v_add_u32 v19, 141376, v19
  ds_read_b32 v18, v19
  s_waitcnt lgkmcnt(0)
  v_cmp_ne_u32 vcc, 0, v18
  s_cmp_eq_u64 vcc, 0
  s_cbranch_scc1 p2_kernel_fin
  s_mov_b32 s47, 1
  s_waitcnt vmcnt(0)
  s_mov_b32 s36, s48
  s_mov_b32 s37, s49
  s_mov_b32 s38, s50
  v_mov_b32 v20, 0xff800000
  v_mov_b32 v21, 0xff800000
  s_mov_b32 s41, 0
  v_lshl_add_u32 v7, v1, 4, s39
  v_lshl_add_u32 v8, v2, 3, s39
  v_lshl_add_u32 v11, v1, 3, s39
p2_kernel_maxloop:
  s_barrier
  s_mov_b32 s40, 0
  s_add_u32 m0, s54, s40
  s_add_u32 s34, s38, 640
  buffer_load_dwordx4 v4, s[16:19], s36 offen sc1 lds
  s_add_u32 m0, s55, s40
  s_add_u32 s36, s36, 4096
  buffer_load_dwordx4 v4, s[16:19], s37 offen sc1 lds
  s_add_u32 s37, s37, 1024
  s_add_u32 m0, s56, s40
  s_mov_b64 exec, s[42:43]
  buffer_load_dwordx4 v6, s[16:19], s38 offen sc1 lds
  s_add_u32 m0, m0, 1024
  s_nop 0
  buffer_load_dwordx4 v6, s[16:19], s34 offen sc1 lds
  s_mov_b64 exec, -1
  s_add_u32 s38, s38, 5120
  s_add_u32 s40, s40, 13312
  s_cmp_eq_u32 s40, 39936
  s_cselect_b32 s40, 0, s40
  s_waitcnt vmcnt(0)
  s_barrier
  ds_read2st64_b64 v[40:43], v11 offset0:0 offset1:1
  ds_read_b64 v[44:45], v8 offset:4096
  s_waitcnt lgkmcnt(0)
  v_mfma_f32_32x32x16_bf16 v[72:87], v[40:43], v[24:27], 0
  v_mfma_f32_32x32x8_bf16 v[72:87], v[44:45], v[28:29], v[72:87]
  v_mfma_f32_32x32x16_bf16 v[88:103], v[40:43], v[32:35], 0
  v_mfma_f32_32x32x8_bf16 v[88:103], v[44:45], v[36:37], v[88:103]
  s_nop 15
  v_max_f32 v20, v20, v72
  v_max_f32 v20, v20, v73
  v_max_f32 v20, v20, v74
  v_max_f32 v20, v20, v75
  v_max_f32 v20, v20, v76
  v_max_f32 v20, v20, v77
  v_max_f32 v20, v20, v78
  v_max_f32 v20, v20, v79
  v_max_f32 v20, v20, v80
  v_max_f32 v20, v20, v81
  v_max_f32 v20, v20, v82
  v_max_f32 v20, v20, v83
  v_max_f32 v20, v20, v84
  v_max_f32 v20, v20, v85
  v_max_f32 v20, v20, v86
  v_max_f32 v20, v20, v87
  v_max_f32 v21, v21, v88
  v_max_f32 v21, v21, v89
  v_max_f32 v21, v21, v90
  v_max_f32 v21, v21, v91
  v_max_f32 v21, v21, v92
  v_max_f32 v21, v21, v93
  v_max_f32 v21, v21, v94
  v_max_f32 v21, v21, v95
  v_max_f32 v21, v21, v96
  v_max_f32 v21, v21, v97
  v_max_f32 v21, v21, v98
  v_max_f32 v21, v21, v99
  v_max_f32 v21, v21, v100
  v_max_f32 v21, v21, v101
  v_max_f32 v21, v21, v102
  v_max_f32 v21, v21, v103
  ds_read2st64_b64 v[40:43], v11 offset0:2 offset1:3
  ds_read_b64 v[44:45], v8 offset:4352
  s_waitcnt lgkmcnt(0)
  v_mfma_f32_32x32x16_bf16 v[72:87], v[40:43], v[24:27], 0
  v_mfma_f32_32x32x8_bf16 v[72:87], v[44:45], v[28:29], v[72:87]
  v_mfma_f32_32x32x16_bf16 v[88:103], v[40:43], v[32:35], 0
  v_mfma_f32_32x32x8_bf16 v[88:103], v[44:45], v[36:37], v[88:103]
  s_nop 15
  v_max_f32 v20, v20, v72
  v_max_f32 v20, v20, v73
  v_max_f32 v20, v20, v74
  v_max_f32 v20, v20, v75
  v_max_f32 v20, v20, v76
  v_max_f32 v20, v20, v77
  v_max_f32 v20, v20, v78
  v_max_f32 v20, v20, v79
  v_max_f32 v20, v20, v80
  v_max_f32 v20, v20, v81
  v_max_f32 v20, v20, v82
  v_max_f32 v20, v20, v83
  v_max_f32 v20, v20, v84
  v_max_f32 v20, v20, v85
  v_max_f32 v20, v20, v86
  v_max_f32 v20, v20, v87
  v_max_f32 v21, v21, v88
  v_max_f32 v21, v21, v89
  v_max_f32 v21, v21, v90
  v_max_f32 v21, v21, v91
  v_max_f32 v21, v21, v92
  v_max_f32 v21, v21, v93
  v_max_f32 v21, v21, v94
  v_max_f32 v21, v21, v95
  v_max_f32 v21, v21, v96
  v_max_f32 v21, v21, v97
  v_max_f32 v21, v21, v98
  v_max_f32 v21, v21, v99
  v_max_f32 v21, v21, v100
  v_max_f32 v21, v21, v101
  v_max_f32 v21, v21, v102
  v_max_f32 v21, v21, v103
  ds_read2st64_b64 v[40:43], v11 offset0:4 offset1:5
  ds_read_b64 v[44:45], v8 offset:4608
  s_waitcnt lgkmcnt(0)
  v_mfma_f32_32x32x16_bf16 v[72:87], v[40:43], v[24:27], 0
  v_mfma_f32_32x32x8_bf16 v[72:87], v[44:45], v[28:29], v[72:87]
  v_mfma_f32_32x32x16_bf16 v[88:103], v[40:43], v[32:35], 0
  v_mfma_f32_32x32x8_bf16 v[88:103], v[44:45], v[36:37], v[88:103]
  s_nop 15
  v_max_f32 v20, v20, v72
  v_max_f32 v20, v20, v73
  v_max_f32 v20, v20, v74
  v_max_f32 v20, v20, v75
  v_max_f32 v20, v20, v76
  v_max_f32 v20, v20, v77
  v_max_f32 v20, v20, v78
  v_max_f32 v20, v20, v79
  v_max_f32 v20, v20, v80
  v_max_f32 v20, v20, v81
  v_max_f32 v20, v20, v82
  v_max_f32 v20, v20, v83
  v_max_f32 v20, v20, v84
  v_max_f32 v20, v20, v85
  v_max_f32 v20, v20, v86
  v_max_f32 v20, v20, v87
  v_max_f32 v21, v21, v88
  v_max_f32 v21, v21, v89
  v_max_f32 v21, v21, v90
  v_max_f32 v21, v21, v91
  v_max_f32 v21, v21, v92
  v_max_f32 v21, v21, v93
  v_max_f32 v21, v21, v94
  v_max_f32 v21, v21, v95
  v_max_f32 v21, v21, v96
  v_max_f32 v21, v21, v97
  v_max_f32 v21, v21, v98
  v_max_f32 v21, v21, v99
  v_max_f32 v21, v21, v100
  v_max_f32 v21, v21, v101
  v_max_f32 v21, v21, v102
  v_max_f32 v21, v21, v103
  ds_read2st64_b64 v[40:43], v11 offset0:6 offset1:7
  ds_read_b64 v[44:45], v8 offset:4864
  s_waitcnt lgkmcnt(0)
  v_mfma_f32_32x32x16_bf16 v[72:87], v[40:43], v[24:27], 0
  v_mfma_f32_32x32x8_bf16 v[72:87], v[44:45], v[28:29], v[72:87]
  v_mfma_f32_32x32x16_bf16 v[88:103], v[40:43], v[32:35], 0
  v_mfma_f32_32x32x8_bf16 v[88:103], v[44:45], v[36:37], v[88:103]
  s_nop 15
  v_max_f32 v20, v20, v72
  v_max_f32 v20, v20, v73
  v_max_f32 v20, v20, v74
  v_max_f32 v20, v20, v75
  v_max_f32 v20, v20, v76
  v_max_f32 v20, v20, v77
  v_max_f32 v20, v20, v78
  v_max_f32 v20, v20, v79
  v_max_f32 v20, v20, v80
  v_max_f32 v20, v20, v81
  v_max_f32 v20, v20, v82
  v_max_f32 v20, v20, v83
  v_max_f32 v20, v20, v84
  v_max_f32 v20, v20, v85
  v_max_f32 v20, v20, v86
  v_max_f32 v20, v20, v87
  v_max_f32 v21, v21, v88
  v_max_f32 v21, v21, v89
  v_max_f32 v21, v21, v90
  v_max_f32 v21, v21, v91
  v_max_f32 v21, v21, v92
  v_max_f32 v21, v21, v93
  v_max_f32 v21, v21, v94
  v_max_f32 v21, v21, v95
  v_max_f32 v21, v21, v96
  v_max_f32 v21, v21, v97
  v_max_f32 v21, v21, v98
  v_max_f32 v21, v21, v99
  v_max_f32 v21, v21, v100
  v_max_f32 v21, v21, v101
  v_max_f32 v21, v21, v102
  v_max_f32 v21, v21, v103
  s_add_u32 s41, s41, 1
  s_cmp_lt_u32 s41, 8
  s_cbranch_scc1 p2_kernel_maxloop
  v_mov_b32 v16, v20
  v_mov_b32 v17, v20
  s_nop 1
  v_permlane32_swap_b32 v16, v17
  v_max_f32 v20, v16, v17
  v_mov_b32 v16, v21
  v_mov_b32 v17, v21
  s_nop 1
  v_permlane32_swap_b32 v16, v17
  v_max_f32 v21, v16, v17
  s_barrier
  ds_write_b64 v14, v[20:21]
  s_waitcnt lgkmcnt(0)
  s_barrier
  ds_read_b64 v[16:17], v15
  s_waitcnt lgkmcnt(0)
  v_max_f32 v20, v20, v16
  v_sub_f32 v152, 0, v20
  v_sub_f32 v153, 0, v20
  v_sub_f32 v154, 0, v20
  v_sub_f32 v155, 0, v20
  v_sub_f32 v156, 0, v20
  v_sub_f32 v157, 0, v20
  v_sub_f32 v158, 0, v20
  v_sub_f32 v159, 0, v20
  v_sub_f32 v160, 0, v20
  v_sub_f32 v161, 0, v20
  v_sub_f32 v162, 0, v20
  v_sub_f32 v163, 0, v20
  v_sub_f32 v164, 0, v20
  v_sub_f32 v165, 0, v20
  v_sub_f32 v166, 0, v20
  v_sub_f32 v167, 0, v20
  v_max_f32 v21, v21, v17
  v_sub_f32 v168, 0, v21
  v_sub_f32 v169, 0, v21
  v_sub_f32 v170, 0, v21
  v_sub_f32 v171, 0, v21
  v_sub_f32 v172, 0, v21
  v_sub_f32 v173, 0, v21
  v_sub_f32 v174, 0, v21
  v_sub_f32 v175, 0, v21
  v_sub_f32 v176, 0, v21
  v_sub_f32 v177, 0, v21
  v_sub_f32 v178, 0, v21
  v_sub_f32 v179, 0, v21
  v_sub_f32 v180, 0, v21
  v_sub_f32 v181, 0, v21
  v_sub_f32 v182, 0, v21
  v_sub_f32 v183, 0, v21
  s_barrier
  s_branch p2_kernel_pass
p2_kernel_fin:
  s_cmp_eq_u32 s47, 0
  s_cbranch_scc1 p2_kernel_fe_29
  s_barrier
p2_kernel_fe_29:
  v_rcp_f32 v17, v17
  s_nop 0
  v_mul_f32 v120, v17, v120
  v_mul_f32 v121, v17, v121
  v_mul_f32 v122, v17, v122
  v_mul_f32 v123, v17, v123
  v_mul_f32 v124, v17, v124
  v_mul_f32 v125, v17, v125
  v_mul_f32 v126, v17, v126
  v_mul_f32 v127, v17, v127
  v_mul_f32 v128, v17, v128
  v_mul_f32 v129, v17, v129
  v_mul_f32 v130, v17, v130
  v_mul_f32 v131, v17, v131
  v_cvt_pk_bf16_f32 v120, v120, v121
  v_cvt_pk_bf16_f32 v121, v122, v123
  v_cvt_pk_bf16_f32 v122, v124, v125
  v_cvt_pk_bf16_f32 v123, v126, v127
  v_cvt_pk_bf16_f32 v124, v128, v129
  v_cvt_pk_bf16_f32 v125, v130, v131
  s_lshl_b32 s32, s21, 3
  s_lshl_b32 s33, s28, 1
  s_add_u32 s32, s32, s33
  s_add_u32 s32, s32, s23
  s_lshl_b32 s32, s32, 11
  s_lshr_b32 s33, s20, 1
  s_lshl_b32 s33, s33, 17
  s_add_u32 s33, s33, s32
  s_and_b32 s34, s20, 1
  s_lshl_b32 s34, s34, 9
  s_add_u32 s33, s33, s34
  s_add_u32 s33, s33, 0x780000
  v_lshrrev_b32 v14, 4, v2
  v_lshlrev_b32 v14, 10, v14
  v_and_b32 v15, 15, v2
  v_lshl_add_u32 v14, v15, 4, v14
  v_lshl_add_u32 v15, v3, 8, v14
  buffer_store_dwordx4 v[120:123], v15, s[16:19], s33 offen sc1
  s_lshr_b32 s33, s20, 3
  s_lshl_b32 s33, s33, 17
  s_add_u32 s33, s33, s32
  s_bfe_u32 s34, s20, 0x20001
  s_lshl_b32 s34, s34, 7
  s_add_u32 s33, s33, s34
  s_and_b32 s34, s20, 1
  s_lshl_b32 s34, s34, 9
  s_add_u32 s33, s33, s34
  s_add_u32 s33, s33, 0x980000
  v_lshrrev_b32 v14, 4, v2
  v_lshlrev_b32 v14, 10, v14
  v_and_b32 v15, 15, v2
  v_lshl_add_u32 v14, v15, 3, v14
  s_mov_b32 exec_hi, 0
  buffer_store_dwordx2 v[124:125], v14, s[16:19], s33 offen sc1
  s_mov_b64 exec, -1
  s_lshl_b32 s32, s20, 3
  s_add_u32 s32, s32, s21
  s_mov_b32 s94, s32
  s_mov_b32 s95, 1
p2_kernel_CODE_END:
p3_kernel:
  s_load_dwordx2 s[6:7], s[0:1], 0
  s_load_dwordx2 s[24:25], s[0:1], 72
  s_and_b32 s32, s2, 7
  s_lshr_b32 s33, s2, 3
  s_lshr_b32 s34, s32, 1
  s_lshl_b32 s34, s34, 3
  s_and_b32 s35, s33, 7
  s_add_u32 s20, s34, s35
  s_and_b32 s34, s32, 1
  s_lshl_b32 s34, s34, 2
  s_lshr_b32 s35, s33, 3
  s_add_u32 s21, s34, s35
  v_lshrrev_b32 v14, 6, v0
  v_and_b32 v1, 63, v0
  v_readfirstlane_b32 s22, v14
  v_and_b32 v2, 15, v1
  v_lshrrev_b32 v3, 4, v1
  s_lshr_b32 s23, s22, 2
  s_and_b32 s28, s22, 3
  s_lshl_b32 s32, s20, 2
  s_add_u32 s28, s28, s32
  s_mov_b32 s38, -1
  s_mov_b32 s39, 0xff
  s_mul_i32 s36, s22, 640
  v_lshlrev_b32 v4, 4, v1
  v_add_u32 v4, s36, v4
  s_mul_i32 s42, s21, 102400
  s_add_u32 s42, s42, 0x1a60000
  v_lshlrev_b32 v6, 4, v1
  s_lshl_b32 s32, s28, 4
  v_add_u32 v14, s32, v2
  s_mul_i32 s33, s21, 80
  s_mul_i32 s34, s23, 48
  s_add_u32 s33, s33, s34
  v_lshl_add_u32 v15, v3, 2, s33
  v_mul_u32_u24 v12, 1280, v14
  v_lshl_add_u32 v12, v15, 1, v12
  v_lshrrev_b32 v16, 5, v14
  v_mul_u32_u24 v16, 40, v16
  s_lshr_b32 s33, s33, 4
  v_add_u32 v16, s33, v16
  v_lshlrev_b32 v16, 10, v16
  v_and_b32 v17, 31, v14
  v_lshl_add_u32 v16, v17, 4, v16
  v_lshrrev_b32 v17, 1, v3
  v_lshl_add_u32 v16, v17, 9, v16
  v_and_b32 v17, 1, v3
  v_lshl_add_u32 v16, v17, 3, v16
  v_add_u32 v11, 0xa00000, v16
  v_lshlrev_b32 v13, 2, v14
  v_add_u32 v13, 0x1340000, v13
  s_waitcnt lgkmcnt(0)
  s_mov_b32 s12, s6
  s_and_b32 s13, s7, 0xffff
  s_mov_b32 s14, 0x280000
  s_mov_b32 s15, 0x20000
  s_mov_b32 s16, s24
  s_and_b32 s17, s25, 0xffff
  s_mov_b32 s18, 0x1c00000
  s_mov_b32 s19, 0x20000
  s_lshl_b32 s40, s28, 10
  s_lshl_b32 s32, s23, 17
  s_add_u32 s40, s40, s32
  s_add_u32 s40, s40, 0x780000
  s_lshr_b32 s32, s2, 3
  s_and_b32 s33, s32, 7
  s_lshr_b32 s32, s32, 3
  s_add_u32 s32, s32, s33
  s_and_b32 s48, s32, 1
  s_waitcnt lgkmcnt(0)
  s_waitcnt vmcnt(0)
  s_barrier
  s_cmp_eq_u32 s22, 0
  s_cbranch_scc0 p3_kernel_pub_1
  s_cmp_eq_u32 s95, 1
  s_cbranch_scc0 p3_kernel_pub_1
  s_lshl_b32 s33, s94, 7
  s_add_u32 s33, s33, 0x1bc0000
  v_mov_b32 v14, 0
  v_mov_b32 v15, s101
  s_mov_b64 exec, 1
  buffer_store_dword v15, v14, s[16:19], s33 offen sc1
  s_mov_b64 exec, -1
p3_kernel_pub_1:
  s_mov_b32 s95, 0
  s_add_u32 s32, s22, 0
  s_mul_i32 s50, s32, 205
  s_lshr_b32 s50, s50, 11
  s_mul_i32 s33, s50, 10
  s_sub_u32 s32, s32, s33
  s_mul_i32 s60, s50, 10240
  s_lshl_b32 s33, s32, 10
  s_add_u32 s60, s60, s33
  s_add_u32 s55, s33, s42
  s_add_u32 s32, s22, 8
  s_mul_i32 s51, s32, 205
  s_lshr_b32 s51, s51, 11
  s_mul_i32 s33, s51, 10
  s_sub_u32 s32, s32, s33
  s_mul_i32 s61, s51, 10240
  s_lshl_b32 s33, s32, 10
  s_add_u32 s61, s61, s33
  s_add_u32 s56, s33, s42
  s_add_u32 s32, s22, 16
  s_mul_i32 s52, s32, 205
  s_lshr_b32 s52, s52, 11
  s_mul_i32 s33, s52, 10
  s_sub_u32 s32, s32, s33
  s_mul_i32 s62, s52, 10240
  s_lshl_b32 s33, s32, 10
  s_add_u32 s62, s62, s33
  s_add_u32 s57, s33, s42
  s_add_u32 s32, s22, 24
  s_mul_i32 s53, s32, 205
  s_lshr_b32 s53, s53, 11
  s_mul_i32 s33, s53, 10
  s_sub_u32 s32, s32, s33
  s_mul_i32 s63, s53, 10240
  s_lshl_b32 s33, s32, 10
  s_add_u32 s63, s63, s33
  s_add_u32 s58, s33, s42
  s_add_u32 s32, s22, 32
  s_mul_i32 s54, s32, 205
  s_lshr_b32 s54, s54, 11
  s_mul_i32 s33, s54, 10
  s_sub_u32 s32, s32, s33
  s_mul_i32 s64, s54, 10240
  s_lshl_b32 s33, s32, 10
  s_add_u32 s64, s64, s33
  s_add_u32 s59, s33, s42
  s_mov_b32 s66, 0
  s_mul_i32 s66, s66, 10240
  s_mov_b32 s67, 1
  s_mul_i32 s67, s67, 10240
  s_mov_b32 s68, 2
  s_mul_i32 s68, s68, 10240
  s_mov_b32 s69, 3
  s_mul_i32 s69, s69, 10240
  s_add_u32 s41, s66, s55
  s_add_u32 m0, s60, 0
  s_nop 0
  buffer_load_dwordx4 v6, s[16:19], s41 offen sc1 lds
  s_cmp_eq_u32 s51, 0
  s_cselect_b32 s41, s66, s67
  s_add_u32 s41, s41, s56
  s_add_u32 m0, s61, 0
  s_nop 0
  buffer_load_dwordx4 v6, s[16:19], s41 offen sc1 lds
  s_cmp_eq_u32 s52, 1
  s_cselect_b32 s41, s67, s68
  s_add_u32 s41, s41, s57
  s_add_u32 m0, s62, 0
  s_nop 0
  buffer_load_dwordx4 v6, s[16:19], s41 offen sc1 lds
  s_cmp_eq_u32 s53, 2
  s_cselect_b32 s41, s68, s69
  s_add_u32 s41, s41, s58
  s_add_u32 m0, s63, 0
  s_nop 0
  buffer_load_dwordx4 v6, s[16:19], s41 offen sc1 lds
  s_add_u32 s41, s69, s59
  s_add_u32 m0, s64, 0
  s_nop 0
  buffer_load_dwordx4 v6, s[16:19], s41 offen sc1 lds
  s_mov_b32 s66, 4
  s_mul_i32 s66, s66, 10240
  s_mov_b32 s67, 5
  s_mul_i32 s67, s67, 10240
  s_mov_b32 s68, 6
  s_mul_i32 s68, s68, 10240
  s_mov_b32 s69, 7
  s_mul_i32 s69, s69, 10240
  s_add_u32 s41, s66, s55
  s_add_u32 m0, s60, 40960
  s_nop 0
  buffer_load_dwordx4 v6, s[16:19], s41 offen sc1 lds
  s_cmp_eq_u32 s51, 0
  s_cselect_b32 s41, s66, s67
  s_add_u32 s41, s41, s56
  s_add_u32 m0, s61, 40960
  s_nop 0
  buffer_load_dwordx4 v6, s[16:19], s41 offen sc1 lds
  s_cmp_eq_u32 s52, 1
  s_cselect_b32 s41, s67, s68
  s_add_u32 s41, s41, s57
  s_add_u32 m0, s62, 40960
  s_nop 0
  buffer_load_dwordx4 v6, s[16:19], s41 offen sc1 lds
  s_cmp_eq_u32 s53, 2
  s_cselect_b32 s41, s68, s69
  s_add_u32 s41, s41, s58
  s_add_u32 m0, s63, 40960
  s_nop 0
  buffer_load_dwordx4 v6, s[16:19], s41 offen sc1 lds
  s_add_u32 s41, s69, s59
  s_add_u32 m0, s64, 40960
  s_nop 0
  buffer_load_dwordx4 v6, s[16:19], s41 offen sc1 lds
  s_mov_b32 s66, 8
  s_mul_i32 s66, s66, 10240
  s_mov_b32 s67, 9
  s_mul_i32 s67, s67, 10240
  s_add_u32 s41, s66, s55
  s_add_u32 m0, s60, 81920
  s_nop 0
  buffer_load_dwordx4 v6, s[16:19], s41 offen sc1 lds
  s_cmp_eq_u32 s51, 0
  s_cselect_b32 s41, s66, s67
  s_add_u32 s41, s41, s56
  s_add_u32 m0, s61, 81920
  s_nop 0
  buffer_load_dwordx4 v6, s[16:19], s41 offen sc1 lds
  s_cmp_ge_u32 s52, 2
  s_cbranch_scc1 p3_kernel_wgs_2
  s_cmp_eq_u32 s52, 1
  s_cselect_b32 s41, s67, s67
  s_add_u32 s41, s41, s57
  s_add_u32 m0, s62, 81920
  s_nop 0
  buffer_load_dwordx4 v6, s[16:19], s41 offen sc1 lds
p3_kernel_wgs_2:
  s_lshr_b32 s32, s20, 2
  v_lshl_add_u32 v14, v1, 3, s32
  v_lshlrev_b32 v14, 7, v14
  v_add_u32 v14, 0x1bc0000, v14
  v_mov_b32 v15, s101
  s_cmp_eq_u32 s22, 0
  s_cbranch_scc0 p3_kernel_wd_3
  s_mov_b32 s35, 0
  s_mov_b32 exec_lo, 0xffffffff
  s_mov_b32 exec_hi, 0
p3_kernel_wp_4:
  buffer_load_dword v16, v14, s[16:19], 0 offen sc1
  s_waitcnt vmcnt(0)
  v_cmp_eq_u32 vcc, v16, v15
  s_cmp_eq_u64 vcc, exec
  s_cbranch_scc1 p3_kernel_wd_3_ok
  s_sleep 1
  s_add_u32 s35, s35, 1
  s_cmp_lt_u32 s35, 0x100000
  s_cbranch_scc1 p3_kernel_wp_4
p3_kernel_wd_3_ok:
  s_mov_b64 exec, -1
p3_kernel_wd_3:
  s_barrier
  s_mov_b32 s43, 0
  s_mul_i32 s32, s43, 262144
  s_add_u32 s32, s32, s40
  buffer_load_dwordx4 v[92:95], v6, s[16:19], s32 offen sc1
  s_mov_b32 s43, 1
  s_mul_i32 s32, s43, 262144
  s_add_u32 s32, s32, s40
  buffer_load_dwordx4 v[96:99], v6, s[16:19], s32 offen sc1
  s_mov_b32 s43, 2
  s_mul_i32 s32, s43, 262144
  s_add_u32 s32, s32, s40
  buffer_load_dwordx4 v[100:103], v6, s[16:19], s32 offen sc1
  s_mov_b32 s43, 3
  s_mul_i32 s32, s43, 262144
  s_add_u32 s32, s32, s40
  buffer_load_dwordx4 v[104:107], v6, s[16:19], s32 offen sc1
  s_mov_b32 s43, 4
  s_mul_i32 s32, s43, 262144
  s_add_u32 s32, s32, s40
  buffer_load_dwordx4 v[108:111], v6, s[16:19], s32 offen sc1
  s_mov_b32 s43, 5
  s_mul_i32 s32, s43, 262144
  s_add_u32 s32, s32, s40
  buffer_load_dwordx4 v[112:115], v6, s[16:19], s32 offen sc1
  s_mov_b32 s43, 6
  s_mul_i32 s32, s43, 262144
  s_add_u32 s32, s32, s40
  buffer_load_dwordx4 v[116:119], v6, s[16:19], s32 offen sc1
  s_mov_b32 s43, 7
  s_mul_i32 s32, s43, 262144
  s_add_u32 s32, s32, s40
  buffer_load_dwordx4 v[120:123], v6, s[16:19], s32 offen sc1
  s_mov_b32 s43, 8
  s_mul_i32 s32, s43, 262144
  s_add_u32 s32, s32, s40
  v_lshrrev_b32 v21, 1, v6
  buffer_load_dwordx2 v[124:125], v21, s[16:19], s32 offen sc1
  buffer_load_dwordx2 v[126:127], v21, s[16:19], s32 offen offset:512 sc1
  s_mov_b32 s43, 9
  s_mul_i32 s32, s43, 262144
  s_add_u32 s32, s32, s40
  v_lshrrev_b32 v21, 1, v6
  buffer_load_dwordx2 v[128:129], v21, s[16:19], s32 offen sc1
  buffer_load_dwordx2 v[130:131], v21, s[16:19], s32 offen offset:512 sc1
  s_mul_i32 s32, s23, 5120
  v_lshl_add_u32 v8, v1, 4, s32
  v_add_u32 v9, 61440, v8
  v_add_u32 v10, 122880, v8
  s_waitcnt vmcnt(8)
  s_barrier
  buffer_load_dwordx2 v[22:23], v12, s[12:15], 0 offen offset:0
  buffer_load_dwordx2 v[24:25], v12, s[12:15], 0 offen offset:32
  buffer_load_dwordx2 v[26:27], v12, s[12:15], 0 offen offset:64
  ds_read_b128 v[52:55], v8 offset:0
  ds_read_b128 v[56:59], v8 offset:1024
  ds_read_b128 v[60:63], v8 offset:2048
  ds_read_b128 v[64:67], v8 offset:3072
  ds_read_b128 v[68:71], v8 offset:4096
  ds_read_b128 v[72:75], v8 offset:10240
  ds_read_b128 v[76:79], v8 offset:11264
  ds_read_b128 v[80:83], v8 offset:12288
  ds_read_b128 v[84:87], v8 offset:13312
  ds_read_b128 v[88:91], v8 offset:14336
  s_waitcnt lgkmcnt(9)
  v_mfma_f32_16x16x32_bf16 v[32:35], v[52:55], v[92:95], 0
  s_waitcnt lgkmcnt(8)
  v_mfma_f32_16x16x32_bf16 v[36:39], v[56:59], v[92:95], 0
  s_waitcnt lgkmcnt(7)
  v_mfma_f32_16x16x32_bf16 v[40:43], v[60:63], v[92:95], 0
  s_waitcnt lgkmcnt(6)
  v_mfma_f32_16x16x32_bf16 v[44:47], v[64:67], v[92:95], 0
  s_waitcnt lgkmcnt(5)
  v_mfma_f32_16x16x32_bf16 v[48:51], v[68:71], v[92:95], 0
  s_waitcnt lgkmcnt(4)
  v_mfma_f32_16x16x32_bf16 v[32:35], v[72:75], v[96:99], v[32:35]
  s_waitcnt lgkmcnt(3)
  v_mfma_f32_16x16x32_bf16 v[36:39], v[76:79], v[96:99], v[36:39]
  s_waitcnt lgkmcnt(2)
  v_mfma_f32_16x16x32_bf16 v[40:43], v[80:83], v[96:99], v[40:43]
  s_waitcnt lgkmcnt(1)
  v_mfma_f32_16x16x32_bf16 v[44:47], v[84:87], v[96:99], v[44:47]
  s_waitcnt lgkmcnt(0)
  v_mfma_f32_16x16x32_bf16 v[48:51], v[88:91], v[96:99], v[48:51]
  ds_read_b128 v[52:55], v8 offset:20480
  ds_read_b128 v[56:59], v8 offset:21504
  ds_read_b128 v[60:63], v8 offset:22528
  ds_read_b128 v[64:67], v8 offset:23552
  ds_read_b128 v[68:71], v8 offset:24576
  ds_read_b128 v[72:75], v8 offset:30720
  ds_read_b128 v[76:79], v8 offset:31744
  ds_read_b128 v[80:83], v8 offset:32768
  ds_read_b128 v[84:87], v8 offset:33792
  ds_read_b128 v[88:91], v8 offset:34816
  s_waitcnt lgkmcnt(9)
  v_mfma_f32_16x16x32_bf16 v[32:35], v[52:55], v[100:103], v[32:35]
  s_waitcnt lgkmcnt(8)
  v_mfma_f32_16x16x32_bf16 v[36:39], v[56:59], v[100:103], v[36:39]
  s_waitcnt lgkmcnt(7)
  v_mfma_f32_16x16x32_bf16 v[40:43], v[60:63], v[100:103], v[40:43]
  s_waitcnt lgkmcnt(6)
  v_mfma_f32_16x16x32_bf16 v[44:47], v[64:67], v[100:103], v[44:47]
  s_waitcnt lgkmcnt(5)
  v_mfma_f32_16x16x32_bf16 v[48:51], v[68:71], v[100:103], v[48:51]
  s_waitcnt lgkmcnt(4)
  v_mfma_f32_16x16x32_bf16 v[32:35], v[72:75], v[104:107], v[32:35]
  s_waitcnt lgkmcnt(3)
  v_mfma_f32_16x16x32_bf16 v[36:39], v[76:79], v[104:107], v[36:39]
  s_waitcnt lgkmcnt(2)
  v_mfma_f32_16x16x32_bf16 v[40:43], v[80:83], v[104:107], v[40:43]
  s_waitcnt lgkmcnt(1)
  v_mfma_f32_16x16x32_bf16 v[44:47], v[84:87], v[104:107], v[44:47]
  s_waitcnt lgkmcnt(0)
  v_mfma_f32_16x16x32_bf16 v[48:51], v[88:91], v[104:107], v[48:51]
  s_waitcnt vmcnt(7)
  s_barrier
  ds_read_b128 v[52:55], v8 offset:40960
  ds_read_b128 v[56:59], v8 offset:41984
  ds_read_b128 v[60:63], v8 offset:43008
  ds_read_b128 v[64:67], v8 offset:44032
  ds_read_b128 v[68:71], v8 offset:45056
  ds_read_b128 v[72:75], v8 offset:51200
  ds_read_b128 v[76:79], v8 offset:52224
  ds_read_b128 v[80:83], v8 offset:53248
  ds_read_b128 v[84:87], v8 offset:54272
  ds_read_b128 v[88:91], v8 offset:55296
  s_waitcnt lgkmcnt(9)
  v_mfma_f32_16x16x32_bf16 v[32:35], v[52:55], v[108:111], v[32:35]
  s_waitcnt lgkmcnt(8)
  v_mfma_f32_16x16x32_bf16 v[36:39], v[56:59], v[108:111], v[36:39]
  s_waitcnt lgkmcnt(7)
  v_mfma_f32_16x16x32_bf16 v[40:43], v[60:63], v[108:111], v[40:43]
  s_waitcnt lgkmcnt(6)
  v_mfma_f32_16x16x32_bf16 v[44:47], v[64:67], v[108:111], v[44:47]
  s_waitcnt lgkmcnt(5)
  v_mfma_f32_16x16x32_bf16 v[48:51], v[68:71], v[108:111], v[48:51]
  s_waitcnt lgkmcnt(4)
  v_mfma_f32_16x16x32_bf16 v[32:35], v[72:75], v[112:115], v[32:35]
  s_waitcnt lgkmcnt(3)
  v_mfma_f32_16x16x32_bf16 v[36:39], v[76:79], v[112:115], v[36:39]
  s_waitcnt lgkmcnt(2)
  v_mfma_f32_16x16x32_bf16 v[40:43], v[80:83], v[112:115], v[40:43]
  s_waitcnt lgkmcnt(1)
  v_mfma_f32_16x16x32_bf16 v[44:47], v[84:87], v[112:115], v[44:47]
  s_waitcnt lgkmcnt(0)
  v_mfma_f32_16x16x32_bf16 v[48:51], v[88:91], v[112:115], v[48:51]
  ds_read_b128 v[52:55], v9 offset:0
  ds_read_b128 v[56:59], v9 offset:1024
  ds_read_b128 v[60:63], v9 offset:2048
  ds_read_b128 v[64:67], v9 offset:3072
  ds_read_b128 v[68:71], v9 offset:4096
  ds_read_b128 v[72:75], v9 offset:10240
  ds_read_b128 v[76:79], v9 offset:11264
  ds_read_b128 v[80:83], v9 offset:12288
  ds_read_b128 v[84:87], v9 offset:13312
  ds_read_b128 v[88:91], v9 offset:14336
  s_waitcnt lgkmcnt(9)
  v_mfma_f32_16x16x32_bf16 v[32:35], v[52:55], v[116:119], v[32:35]
  s_waitcnt lgkmcnt(8)
  v_mfma_f32_16x16x32_bf16 v[36:39], v[56:59], v[116:119], v[36:39]
  s_waitcnt lgkmcnt(7)
  v_mfma_f32_16x16x32_bf16 v[40:43], v[60:63], v[116:119], v[40:43]
  s_waitcnt lgkmcnt(6)
  v_mfma_f32_16x16x32_bf16 v[44:47], v[64:67], v[116:119], v[44:47]
  s_waitcnt lgkmcnt(5)
  v_mfma_f32_16x16x32_bf16 v[48:51], v[68:71], v[116:119], v[48:51]
  s_waitcnt lgkmcnt(4)
  v_mfma_f32_16x16x32_bf16 v[32:35], v[72:75], v[120:123], v[32:35]
  s_waitcnt lgkmcnt(3)
  v_mfma_f32_16x16x32_bf16 v[36:39], v[76:79], v[120:123], v[36:39]
  s_waitcnt lgkmcnt(2)
  v_mfma_f32_16x16x32_bf16 v[40:43], v[80:83], v[120:123], v[40:43]
  s_waitcnt lgkmcnt(1)
  v_mfma_f32_16x16x32_bf16 v[44:47], v[84:87], v[120:123], v[44:47]
  s_waitcnt lgkmcnt(0)
  v_mfma_f32_16x16x32_bf16 v[48:51], v[88:91], v[120:123], v[48:51]
  s_waitcnt vmcnt(3)
  s_barrier
  ds_read_b128 v[52:55], v9 offset:20480
  ds_read_b128 v[56:59], v9 offset:21504
  ds_read_b128 v[60:63], v9 offset:22528
  ds_read_b128 v[64:67], v9 offset:23552
  ds_read_b128 v[68:71], v9 offset:24576
  ds_read_b128 v[72:75], v9 offset:30720
  ds_read_b128 v[76:79], v9 offset:31744
  ds_read_b128 v[80:83], v9 offset:32768
  ds_read_b128 v[84:87], v9 offset:33792
  ds_read_b128 v[88:91], v9 offset:34816
  s_waitcnt lgkmcnt(9)
  v_mfma_f32_16x16x32_bf16 v[32:35], v[52:55], v[124:127], v[32:35]
  s_waitcnt lgkmcnt(8)
  v_mfma_f32_16x16x32_bf16 v[36:39], v[56:59], v[124:127], v[36:39]
  s_waitcnt lgkmcnt(7)
  v_mfma_f32_16x16x32_bf16 v[40:43], v[60:63], v[124:127], v[40:43]
  s_waitcnt lgkmcnt(6)
  v_mfma_f32_16x16x32_bf16 v[44:47], v[64:67], v[124:127], v[44:47]
  s_waitcnt lgkmcnt(5)
  v_mfma_f32_16x16x32_bf16 v[48:51], v[68:71], v[124:127], v[48:51]
  s_waitcnt lgkmcnt(4)
  v_mfma_f32_16x16x32_bf16 v[32:35], v[72:75], v[128:131], v[32:35]
  s_waitcnt lgkmcnt(3)
  v_mfma_f32_16x16x32_bf16 v[36:39], v[76:79], v[128:131], v[36:39]
  s_waitcnt lgkmcnt(2)
  v_mfma_f32_16x16x32_bf16 v[40:43], v[80:83], v[128:131], v[40:43]
  s_waitcnt lgkmcnt(1)
  v_mfma_f32_16x16x32_bf16 v[44:47], v[84:87], v[128:131], v[44:47]
  s_waitcnt lgkmcnt(0)
  v_mfma_f32_16x16x32_bf16 v[48:51], v[88:91], v[128:131], v[48:51]
  s_barrier
  s_waitcnt vmcnt(0)
  s_and_b32 s32, s22, 3
  s_mul_i32 s32, s32, 5120
  s_add_u32 s32, s32, 122880
  v_lshl_add_u32 v14, v1, 4, s32
  s_nop 4
  s_cmp_eq_u32 s23, 0
  s_cbranch_scc0 p3_kernel_k1_5
  ds_write_b128 v14, v[44:47] offset:3072
  ds_write_b128 v14, v[48:51] offset:4096
  s_branch p3_kernel_k2_6
p3_kernel_k1_5:
  ds_write_b128 v14, v[32:35] offset:0
  ds_write_b128 v14, v[36:39] offset:1024
  ds_write_b128 v14, v[40:43] offset:2048
  v_mov_b32 v32, v44
  v_mov_b32 v36, v48
  v_mov_b32 v33, v45
  v_mov_b32 v37, v49
  v_mov_b32 v34, v46
  v_mov_b32 v38, v50
  v_mov_b32 v35, v47
  v_mov_b32 v39, v51
  v_add_u32 v14, 3072, v14
p3_kernel_k2_6:
  s_waitcnt lgkmcnt(0)
  s_barrier
  ds_read_b128 v[52:55], v14 offset:0
  ds_read_b128 v[56:59], v14 offset:1024
  ds_read_b128 v[60:63], v14 offset:2048
  s_waitcnt lgkmcnt(0)
  v_add_f32 v32, v32, v52
  v_add_f32 v33, v33, v53
  v_add_f32 v34, v34, v54
  v_add_f32 v35, v35, v55
  v_lshlrev_b32 v16, 16, v22
  v_and_b32 v17, 0xffff0000, v22
  v_lshlrev_b32 v18, 16, v23
  v_and_b32 v19, 0xffff0000, v23
  v_add_f32 v32, v32, v16
  v_add_f32 v33, v33, v17
  v_add_f32 v34, v34, v18
  v_add_f32 v35, v35, v19
  v_mov_b32 v28, v32
  v_mul_f32 v29, v32, v32
  v_add_f32 v28, v28, v33
  v_fma_f32 v29, v33, v33, v29
  v_add_f32 v28, v28, v34
  v_fma_f32 v29, v34, v34, v29
  v_add_f32 v28, v28, v35
  v_fma_f32 v29, v35, v35, v29
  v_cvt_pk_bf16_f32 v32, v32, v33
  v_cvt_pk_bf16_f32 v33, v34, v35
  buffer_store_dwordx2 v[32:33], v11, s[16:19], 0 offen offset:0 sc1
  v_add_f32 v36, v36, v56
  v_add_f32 v37, v37, v57
  v_add_f32 v38, v38, v58
  v_add_f32 v39, v39, v59
  v_lshlrev_b32 v16, 16, v24
  v_and_b32 v17, 0xffff0000, v24
  v_lshlrev_b32 v18, 16, v25
  v_and_b32 v19, 0xffff0000, v25
  v_add_f32 v36, v36, v16
  v_add_f32 v37, v37, v17
  v_add_f32 v38, v38, v18
  v_add_f32 v39, v39, v19
  v_add_f32 v28, v28, v36
  v_fma_f32 v29, v36, v36, v29
  v_add_f32 v28, v28, v37
  v_fma_f32 v29, v37, v37, v29
  v_add_f32 v28, v28, v38
  v_fma_f32 v29, v38, v38, v29
  v_add_f32 v28, v28, v39
  v_fma_f32 v29, v39, v39, v29
  v_cvt_pk_bf16_f32 v36, v36, v37
  v_cvt_pk_bf16_f32 v37, v38, v39
  buffer_store_dwordx2 v[36:37], v11, s[16:19], 0 offen offset:1024 sc1
  s_cmp_eq_u32 s23, 0
  s_cbranch_scc0 p3_kernel_k3_7
  v_add_f32 v40, v40, v60
  v_add_f32 v41, v41, v61
  v_add_f32 v42, v42, v62
  v_add_f32 v43, v43, v63
  v_lshlrev_b32 v16, 16, v26
  v_and_b32 v17, 0xffff0000, v26
  v_lshlrev_b32 v18, 16, v27
  v_and_b32 v19, 0xffff0000, v27
  v_add_f32 v40, v40, v16
  v_add_f32 v41, v41, v17
  v_add_f32 v42, v42, v18
  v_add_f32 v43, v43, v19
  v_add_f32 v28, v28, v40
  v_fma_f32 v29, v40, v40, v29
  v_add_f32 v28, v28, v41
  v_fma_f32 v29, v41, v41, v29
  v_add_f32 v28, v28, v42
  v_fma_f32 v29, v42, v42, v29
  v_add_f32 v28, v28, v43
  v_fma_f32 v29, v43, v43, v29
  v_cvt_pk_bf16_f32 v40, v40, v41
  v_cvt_pk_bf16_f32 v41, v42, v43
  buffer_store_dwordx2 v[40:41], v11, s[16:19], 0 offen offset:2048 sc1
p3_kernel_k3_7:
  v_mov_b32 v16, v28
  v_mov_b32 v17, v28
  s_nop 1
  v_permlane16_swap_b32 v16, v17
  v_add_f32 v16, v16, v17
  v_mov_b32 v17, v16
  s_nop 1
  v_permlane32_swap_b32 v16, v17
  v_add_f32 v28, v16, v17
  v_mov_b32 v16, v29
  v_mov_b32 v17, v29
  s_nop 1
  v_permlane16_swap_b32 v16, v17
  v_add_f32 v16, v16, v17
  v_mov_b32 v17, v16
  s_nop 1
  v_permlane32_swap_b32 v16, v17
  v_add_f32 v29, v16, v17
  v_lshlrev_b32 v14, 3, v2
  s_lshl_b32 s32, s28, 4
  s_lshl_b32 s33, s21, 1
  s_add_u32 s32, s32, s33
  s_add_u32 s32, s32, s23
  s_lshl_b32 s32, s32, 7
  s_add_u32 s32, s32, 0x1b40000
  s_mov_b32 exec_lo, 0xffff
  s_mov_b32 exec_hi, 0
  buffer_store_dwordx2 v[28:29], v14, s[16:19], s32 offen sc1
  s_mov_b64 exec, -1
  s_lshl_b32 s32, s20, 3
  s_add_u32 s32, s32, s21
  s_mov_b32 s94, s32
  s_mov_b32 s95, 1
p3_kernel_CODE_END:
p4_kernel:
  s_load_dwordx2 s[24:25], s[0:1], 72
  s_and_b32 s32, s2, 7
  s_lshr_b32 s33, s2, 3
  s_lshr_b32 s34, s32, 2
  s_lshl_b32 s34, s34, 3
  s_and_b32 s35, s33, 7
  s_add_u32 s20, s34, s35
  s_and_b32 s32, s32, 3
  s_lshr_b32 s33, s33, 3
  s_cmp_lt_u32 s32, 2
  s_cselect_b32 s34, 4, 3
  s_cmp_ge_u32 s33, s34
  s_cbranch_scc1 p4_kernel_idle
  s_lshl_b32 s34, s32, 2
  s_cmp_eq_u32 s32, 3
  s_cselect_b32 s34, 11, s34
  s_add_u32 s21, s34, s33
  v_lshrrev_b32 v20, 6, v0
  v_and_b32 v1, 63, v0
  v_readfirstlane_b32 s22, v20
  v_and_b32 v2, 31, v1
  v_lshrrev_b32 v3, 5, v1
  s_lshr_b32 s23, s22, 2
  s_and_b32 s28, s22, 3
  s_lshl_b32 s29, s22, 10
  v_lshlrev_b32 v4, 4, v1
  s_lshl_b32 s32, s20, 2
  s_lshr_b32 s33, s22, 1
  s_add_u32 s32, s32, s33
  s_mul_i32 s32, s32, 40
  s_and_b32 s33, s22, 1
  s_add_u32 s32, s32, s33
  s_lshl_b32 s32, s32, 10
  s_add_u32 s38, s32, 0xa00000
  s_lshl_b32 s32, s21, 2
  s_lshr_b32 s33, s22, 1
  s_add_u32 s32, s32, s33
  s_mul_i32 s32, s32, 40
  s_and_b32 s33, s22, 1
  s_add_u32 s32, s32, s33
  s_lshl_b32 s32, s32, 11
  s_add_u32 s39, s32, 0x1400000
  s_lshr_b32 s32, s2, 3
  s_and_b32 s33, s32, 7
  s_lshr_b32 s32, s32, 3
  s_add_u32 s32, s32, s33
  s_and_b32 s42, s32, 3
  s_lshl_b32 s36, s22, 11
  s_waitcnt lgkmcnt(0)
  s_mov_b32 s16, s24
  s_and_b32 s17, s25, 0xffff
  s_mov_b32 s18, 0x1c00000
  s_mov_b32 s19, 0x20000
  v_lshrrev_b32 v20, 2, v0
  s_lshl_b32 s32, s20, 7
  v_add_u32 v21, s32, v20
  v_and_b32 v23, 3, v0
  v_lshrrev_b32 v22, 4, v21
  v_lshlrev_b32 v22, 11, v22
  v_lshl_add_u32 v22, v23, 9, v22
  v_and_b32 v24, 15, v21
  v_lshl_add_u32 v22, v24, 3, v22
  v_add_u32 v22, 0x1b40000, v22
  s_waitcnt lgkmcnt(0)
  s_waitcnt vmcnt(0)
  s_barrier
  s_cmp_eq_u32 s22, 0
  s_cbranch_scc0 p4_kernel_pub_1
  s_cmp_eq_u32 s95, 1
  s_cbranch_scc0 p4_kernel_pub_1
  s_lshl_b32 s33, s94, 7
  s_add_u32 s33, s33, 0x1bc8000
  v_mov_b32 v26, 0
  v_mov_b32 v27, s101
  s_mov_b64 exec, 1
  buffer_store_dword v27, v26, s[16:19], s33 offen sc1
  s_mov_b64 exec, -1
p4_kernel_pub_1:
  s_mov_b32 s95, 0
  v_bfe_u32 v24, v0, 7, 1
  v_mul_u32_u24 v24, 3456, v24
  v_and_b32 v25, 127, v0
  s_lshl_b32 s32, s21, 7
  v_add3_u32 v24, v24, v25, s32
  v_lshlrev_b32 v24, 2, v24
  v_add_u32 v24, 0x1b30000, v24
  buffer_load_dword v132, v24, s[16:19], 0 offen sc1
  v_add_u32 v25, 6912, v24
  buffer_load_dword v133, v25, s[16:19], 0 offen sc1
  s_mov_b32 s37, 0
  s_lshl_b32 s31, s37, 12
  s_add_u32 m0, s36, 8192
  s_add_u32 s31, s31, s39
  buffer_load_dwordx4 v4, s[16:19], s31 offen sc1 lds
  s_add_u32 m0, s36, 9216
  s_add_u32 s35, s31, 1024
  buffer_load_dwordx4 v4, s[16:19], s35 offen sc1 lds
  s_mov_b32 s37, 1
  s_lshl_b32 s31, s37, 12
  s_add_u32 m0, s36, 32768
  s_add_u32 s31, s31, s39
  buffer_load_dwordx4 v4, s[16:19], s31 offen sc1 lds
  s_add_u32 m0, s36, 33792
  s_add_u32 s35, s31, 1024
  buffer_load_dwordx4 v4, s[16:19], s35 offen sc1 lds
  s_mov_b32 s37, 2
  s_lshl_b32 s31, s37, 12
  s_add_u32 m0, s36, 57344
  s_add_u32 s31, s31, s39
  buffer_load_dwordx4 v4, s[16:19], s31 offen sc1 lds
  s_add_u32 m0, s36, 58368
  s_add_u32 s35, s31, 1024
  buffer_load_dwordx4 v4, s[16:19], s35 offen sc1 lds
  s_mov_b32 s37, 3
  s_lshl_b32 s31, s37, 12
  s_add_u32 m0, s36, 81920
  s_add_u32 s31, s31, s39
  buffer_load_dwordx4 v4, s[16:19], s31 offen sc1 lds
  s_add_u32 m0, s36, 82944
  s_add_u32 s35, s31, 1024
  buffer_load_dwordx4 v4, s[16:19], s35 offen sc1 lds
  s_lshl_b32 s32, s20, 4
  v_add_u32 v24, s32, v1
  v_lshlrev_b32 v24, 7, v24
  v_add_u32 v24, 0x1bc8000, v24
  v_mov_b32 v25, s101
  s_cmp_eq_u32 s22, 0
  s_cbranch_scc0 p4_kernel_wd_2
  s_mov_b32 s35, 0
  s_mov_b32 exec_lo, 0xffff
  s_mov_b32 exec_hi, 0
p4_kernel_wp_3:
  buffer_load_dword v26, v24, s[16:19], 0 offen sc1
  s_waitcnt vmcnt(0)
  v_cmp_eq_u32 vcc, v26, v25
  s_cmp_eq_u64 vcc, exec
  s_cbranch_scc1 p4_kernel_wd_2_ok
  s_sleep 1
  s_add_u32 s35, s35, 1
  s_cmp_lt_u32 s35, 0x100000
  s_cbranch_scc1 p4_kernel_wp_3
p4_kernel_wd_2_ok:
  s_mov_b64 exec, -1
p4_kernel_wd_2:
  s_barrier
  s_mov_b32 s37, 0
  s_lshl_b32 s30, s37, 11
  s_add_u32 m0, s29, 0
  s_add_u32 s30, s30, s38
  buffer_load_dwordx4 v4, s[16:19], s30 offen sc1 lds
  buffer_load_dwordx2 v[124:125], v22, s[16:19], 0 offen offset:0 sc1
  buffer_load_dwordx2 v[126:127], v22, s[16:19], 0 offen offset:128 sc1
  buffer_load_dwordx2 v[128:129], v22, s[16:19], 0 offen offset:256 sc1
  buffer_load_dwordx2 v[130:131], v22, s[16:19], 0 offen offset:384 sc1
  s_mov_b32 s37, 1
  s_lshl_b32 s30, s37, 11
  s_add_u32 m0, s29, 24576
  s_add_u32 s30, s30, s38
  buffer_load_dwordx4 v4, s[16:19], s30 offen sc1 lds
  s_mov_b32 s37, 2
  s_lshl_b32 s30, s37, 11
  s_add_u32 m0, s29, 49152
  s_add_u32 s30, s30, s38
  buffer_load_dwordx4 v4, s[16:19], s30 offen sc1 lds
  s_mov_b32 s37, 3
  s_lshl_b32 s30, s37, 11
  s_add_u32 m0, s29, 73728
  s_add_u32 s30, s30, s38
  buffer_load_dwordx4 v4, s[16:19], s30 offen sc1 lds
  s_waitcnt vmcnt(3)
  v_add_f32 v124, v124, v126
  v_add_f32 v125, v125, v127
  v_add_f32 v124, v124, v128
  v_add_f32 v125, v125, v129
  v_add_f32 v124, v124, v130
  v_add_f32 v125, v125, v131
  s_nop 1
  v_add_f32_dpp v124, v124, v124 quad_perm:[1,0,3,2] row_mask:0xf bank_mask:0xf
  v_add_f32_dpp v125, v125, v125 quad_perm:[1,0,3,2] row_mask:0xf bank_mask:0xf
  s_nop 1
  v_add_f32_dpp v124, v124, v124 quad_perm:[2,3,0,1] row_mask:0xf bank_mask:0xf
  v_add_f32_dpp v125, v125, v125 quad_perm:[2,3,0,1] row_mask:0xf bank_mask:0xf
  v_mul_f32 v124, 0x3acccccd, v124
  v_mul_f32 v125, 0x3acccccd, v125
  v_fma_f32 v125, -v124, v124, v125
  v_max_f32 v125, 0, v125
  v_add_f32 v125, 0x3727c5ac, v125
  v_rcp_f32 v126, v125
  v_rsq_f32 v125, v125
  v_add_f32 v132, v132, v133
  v_lshlrev_b32 v20, 3, v20
  v_add_u32 v20, 147456, v20
  v_and_b32 v25, 255, v0
  v_lshlrev_b32 v25, 2, v25
  v_add_u32 v25, 148480, v25
  v_cmp_eq_u32 vcc, 0, v23
  s_and_saveexec_b64 s[40:41], vcc
  ds_write_b64 v20, v[124:125]
  s_cmp_eq_u32 s21, 0
  s_cbranch_scc0 p4_kernel_a2_4
  v_lshlrev_b32 v21, 2, v21
  v_add_u32 v21, 0x1340000, v21
  buffer_store_dword v126, v21, s[16:19], 0 offen sc1
p4_kernel_a2_4:
  s_mov_b64 exec, -1
  s_cmp_ge_u32 s22, 4
  s_cbranch_scc1 p4_kernel_cs_5
  ds_write_b32 v25, v132
p4_kernel_cs_5:
  s_lshl_b32 s32, s23, 12
  v_lshl_add_u32 v6, v1, 4, s32
  v_add_u32 v7, 49152, v6
  v_add_u32 v8, 98304, v6
  s_lshl_b32 s32, s28, 12
  s_add_u32 s32, s32, 8192
  v_lshl_add_u32 v10, v1, 4, s32
  v_add_u32 v11, 49152, v10
  v_add_u32 v12, 98304, v10
  s_lshr_b32 s32, s2, 3
  s_lshl_b32 s32, s32, 3
  s_add_u32 s32, s32, s22
  s_lshl_b32 s33, s32, 13
  v_lshl_add_u32 v140, v1, 7, s33
  s_and_b32 s44, s2, 1
  s_mul_i32 s44, s44, 1105920
  s_add_u32 s44, s44, 0x1840000
  s_cmp_ge_u32 s32, 135
  s_cselect_b32 s44, 0x7ff00000, s44
  s_waitcnt vmcnt(7)
  s_barrier
  s_add_u32 s37, s42, 4
  s_lshl_b32 s30, s37, 11
  s_add_u32 m0, s29, 98304
  s_add_u32 s30, s30, s38
  buffer_load_dwordx4 v4, s[16:19], s30 offen sc1 lds
  s_lshl_b32 s31, s37, 12
  s_add_u32 m0, s36, 106496
  s_add_u32 s31, s31, s39
  buffer_load_dwordx4 v4, s[16:19], s31 offen sc1 lds
  s_add_u32 m0, s36, 107520
  s_add_u32 s35, s31, 1024
  buffer_load_dwordx4 v4, s[16:19], s35 offen sc1 lds
  ds_read_b128 v[92:95], v6 offset:0
  ds_read_b128 v[96:99], v6 offset:2048
  ds_read_b128 v[108:111], v10 offset:0
  ds_read_b128 v[112:115], v10 offset:1024
  s_waitcnt lgkmcnt(0)
  v_mfma_f32_32x32x16_bf16 v[28:43], v[108:111], v[92:95], 0
  ds_read_b128 v[100:103], v6 offset:1024
  ds_read_b128 v[104:107], v6 offset:3072
  v_mfma_f32_32x32x16_bf16 v[60:75], v[112:115], v[92:95], 0
  ds_read_b128 v[116:119], v10 offset:2048
  ds_read_b128 v[120:123], v10 offset:3072
  v_mfma_f32_32x32x16_bf16 v[44:59], v[108:111], v[96:99], 0
  v_mfma_f32_32x32x16_bf16 v[76:91], v[112:115], v[96:99], 0
  s_waitcnt lgkmcnt(0)
  s_waitcnt vmcnt(5)
  s_barrier
  v_mfma_f32_32x32x16_bf16 v[28:43], v[116:119], v[100:103], v[28:43]
  ds_read_b128 v[92:95], v6 offset:24576
  ds_read_b128 v[96:99], v6 offset:26624
  ds_read_b128 v[108:111], v10 offset:24576
  ds_read_b128 v[112:115], v10 offset:25600
  s_add_u32 s37, s42, 1
  v_mfma_f32_32x32x16_bf16 v[60:75], v[120:123], v[100:103], v[60:75]
  s_cmp_ge_u32 s37, 4
  s_cselect_b32 s100, 4, 0
  s_sub_u32 s37, s37, s100
  s_add_u32 s37, s37, 4
  s_lshl_b32 s30, s37, 11
  v_mfma_f32_32x32x16_bf16 v[44:59], v[116:119], v[104:107], v[44:59]
  s_add_u32 m0, s29, 122880
  s_add_u32 s30, s30, s38
  buffer_load_dwordx4 v4, s[16:19], s30 offen sc1 lds
  s_lshl_b32 s31, s37, 12
  s_add_u32 m0, s36, 131072
  v_mfma_f32_32x32x16_bf16 v[76:91], v[120:123], v[104:107], v[76:91]
  s_add_u32 s31, s31, s39
  buffer_load_dwordx4 v4, s[16:19], s31 offen sc1 lds
  s_add_u32 m0, s36, 132096
  s_add_u32 s35, s31, 1024
  buffer_load_dwordx4 v4, s[16:19], s35 offen sc1 lds
  s_waitcnt lgkmcnt(0)
  v_mfma_f32_32x32x16_bf16 v[28:43], v[108:111], v[92:95], v[28:43]
  ds_read_b128 v[100:103], v6 offset:25600
  ds_read_b128 v[104:107], v6 offset:27648
  v_mfma_f32_32x32x16_bf16 v[60:75], v[112:115], v[92:95], v[60:75]
  ds_read_b128 v[116:119], v10 offset:26624
  ds_read_b128 v[120:123], v10 offset:27648
  v_mfma_f32_32x32x16_bf16 v[44:59], v[108:111], v[96:99], v[44:59]
  v_mfma_f32_32x32x16_bf16 v[76:91], v[112:115], v[96:99], v[76:91]
  s_waitcnt lgkmcnt(0)
  s_waitcnt vmcnt(7)
  s_barrier
  v_mfma_f32_32x32x16_bf16 v[28:43], v[116:119], v[100:103], v[28:43]
  ds_read_b128 v[92:95], v7 offset:0
  ds_read_b128 v[96:99], v7 offset:2048
  ds_read_b128 v[108:111], v11 offset:0
  ds_read_b128 v[112:115], v11 offset:1024
  s_add_u32 s37, s42, 2
  v_mfma_f32_32x32x16_bf16 v[60:75], v[120:123], v[100:103], v[60:75]
  s_cmp_ge_u32 s37, 4
  s_cselect_b32 s100, 4, 0
  s_sub_u32 s37, s37, s100
  s_add_u32 s37, s37, 4
  s_lshl_b32 s30, s37, 11
  v_mfma_f32_32x32x16_bf16 v[44:59], v[116:119], v[104:107], v[44:59]
  s_add_u32 m0, s29, 0
  s_add_u32 s30, s30, s38
  buffer_load_dwordx4 v4, s[16:19], s30 offen sc1 lds
  s_lshl_b32 s31, s37, 12
  s_add_u32 m0, s36, 8192
  v_mfma_f32_32x32x16_bf16 v[76:91], v[120:123], v[104:107], v[76:91]
  s_add_u32 s31, s31, s39
  buffer_load_dwordx4 v4, s[16:19], s31 offen sc1 lds
  s_add_u32 m0, s36, 9216
  s_add_u32 s35, s31, 1024
  buffer_load_dwordx4 v4, s[16:19], s35 offen sc1 lds
  s_waitcnt lgkmcnt(0)
  v_mfma_f32_32x32x16_bf16 v[28:43], v[108:111], v[92:95], v[28:43]
  ds_read_b128 v[100:103], v7 offset:1024
  ds_read_b128 v[104:107], v7 offset:3072
  v_mfma_f32_32x32x16_bf16 v[60:75], v[112:115], v[92:95], v[60:75]
  ds_read_b128 v[116:119], v11 offset:2048
  ds_read_b128 v[120:123], v11 offset:3072
  v_mfma_f32_32x32x16_bf16 v[44:59], v[108:111], v[96:99], v[44:59]
  v_mfma_f32_32x32x16_bf16 v[76:91], v[112:115], v[96:99], v[76:91]
  s_waitcnt lgkmcnt(0)
  s_waitcnt vmcnt(9)
  s_barrier
  v_mfma_f32_32x32x16_bf16 v[28:43], v[116:119], v[100:103], v[28:43]
  ds_read_b128 v[92:95], v7 offset:24576
  ds_read_b128 v[96:99], v7 offset:26624
  ds_read_b128 v[108:111], v11 offset:24576
  ds_read_b128 v[112:115], v11 offset:25600
  s_add_u32 s37, s42, 3
  v_mfma_f32_32x32x16_bf16 v[60:75], v[120:123], v[100:103], v[60:75]
  s_cmp_ge_u32 s37, 4
  s_cselect_b32 s100, 4, 0
  s_sub_u32 s37, s37, s100
  s_add_u32 s37, s37, 4
  s_lshl_b32 s30, s37, 11
  v_mfma_f32_32x32x16_bf16 v[44:59], v[116:119], v[104:107], v[44:59]
  s_add_u32 m0, s29, 24576
  s_add_u32 s30, s30, s38
  buffer_load_dwordx4 v4, s[16:19], s30 offen sc1 lds
  s_lshl_b32 s31, s37, 12
  s_add_u32 m0, s36, 32768
  v_mfma_f32_32x32x16_bf16 v[76:91], v[120:123], v[104:107], v[76:91]
  s_add_u32 s31, s31, s39
  buffer_load_dwordx4 v4, s[16:19], s31 offen sc1 lds
  s_add_u32 m0, s36, 33792
  s_add_u32 s35, s31, 1024
  buffer_load_dwordx4 v4, s[16:19], s35 offen sc1 lds
  s_waitcnt lgkmcnt(0)
  v_mfma_f32_32x32x16_bf16 v[28:43], v[108:111], v[92:95], v[28:43]
  ds_read_b128 v[100:103], v7 offset:25600
  ds_read_b128 v[104:107], v7 offset:27648
  v_mfma_f32_32x32x16_bf16 v[60:75], v[112:115], v[92:95], v[60:75]
  ds_read_b128 v[116:119], v11 offset:26624
  ds_read_b128 v[120:123], v11 offset:27648
  v_mfma_f32_32x32x16_bf16 v[44:59], v[108:111], v[96:99], v[44:59]
  v_mfma_f32_32x32x16_bf16 v[76:91], v[112:115], v[96:99], v[76:91]
  s_waitcnt lgkmcnt(0)
  s_waitcnt vmcnt(9)
  s_barrier
  v_mfma_f32_32x32x16_bf16 v[28:43], v[116:119], v[100:103], v[28:43]
  ds_read_b128 v[92:95], v8 offset:0
  ds_read_b128 v[96:99], v8 offset:2048
  ds_read_b128 v[108:111], v12 offset:0
  ds_read_b128 v[112:115], v12 offset:1024
  v_mfma_f32_32x32x16_bf16 v[60:75], v[120:123], v[100:103], v[60:75]
  s_add_u32 s37, s42, 8
  s_lshl_b32 s30, s37, 11
  s_add_u32 m0, s29, 49152
  s_add_u32 s30, s30, s38
  v_mfma_f32_32x32x16_bf16 v[44:59], v[116:119], v[104:107], v[44:59]
  buffer_load_dwordx4 v4, s[16:19], s30 offen sc1 lds
  s_lshl_b32 s31, s37, 12
  s_add_u32 m0, s36, 57344
  s_add_u32 s31, s31, s39
  v_mfma_f32_32x32x16_bf16 v[76:91], v[120:123], v[104:107], v[76:91]
  buffer_load_dwordx4 v4, s[16:19], s31 offen sc1 lds
  s_add_u32 m0, s36, 58368
  s_add_u32 s35, s31, 1024
  buffer_load_dwordx4 v4, s[16:19], s35 offen sc1 lds
  s_waitcnt lgkmcnt(0)
  v_mfma_f32_32x32x16_bf16 v[28:43], v[108:111], v[92:95], v[28:43]
  ds_read_b128 v[100:103], v8 offset:1024
  ds_read_b128 v[104:107], v8 offset:3072
  v_mfma_f32_32x32x16_bf16 v[60:75], v[112:115], v[92:95], v[60:75]
  ds_read_b128 v[116:119], v12 offset:2048
  ds_read_b128 v[120:123], v12 offset:3072
  v_mfma_f32_32x32x16_bf16 v[44:59], v[108:111], v[96:99], v[44:59]
  v_mfma_f32_32x32x16_bf16 v[76:91], v[112:115], v[96:99], v[76:91]
  s_waitcnt lgkmcnt(0)
  s_waitcnt vmcnt(9)
  s_barrier
  v_mfma_f32_32x32x16_bf16 v[28:43], v[116:119], v[100:103], v[28:43]
  ds_read_b128 v[92:95], v8 offset:24576
  ds_read_b128 v[96:99], v8 offset:26624
  ds_read_b128 v[108:111], v12 offset:24576
  ds_read_b128 v[112:115], v12 offset:25600
  s_add_u32 s37, s42, 1
  v_mfma_f32_32x32x16_bf16 v[60:75], v[120:123], v[100:103], v[60:75]
  s_cmp_ge_u32 s37, 4
  s_cselect_b32 s100, 4, 0
  s_sub_u32 s37, s37, s100
  s_add_u32 s37, s37, 8
  s_lshl_b32 s30, s37, 11
  v_mfma_f32_32x32x16_bf16 v[44:59], v[116:119], v[104:107], v[44:59]
  s_add_u32 m0, s29, 73728
  s_add_u32 s30, s30, s38
  buffer_load_dwordx4 v4, s[16:19], s30 offen sc1 lds
  s_lshl_b32 s31, s37, 12
  s_add_u32 m0, s36, 81920
  v_mfma_f32_32x32x16_bf16 v[76:91], v[120:123], v[104:107], v[76:91]
  s_add_u32 s31, s31, s39
  buffer_load_dwordx4 v4, s[16:19], s31 offen sc1 lds
  s_add_u32 m0, s36, 82944
  s_add_u32 s35, s31, 1024
  buffer_load_dwordx4 v4, s[16:19], s35 offen sc1 lds
  s_waitcnt lgkmcnt(0)
  v_mfma_f32_32x32x16_bf16 v[28:43], v[108:111], v[92:95], v[28:43]
  ds_read_b128 v[100:103], v8 offset:25600
  ds_read_b128 v[104:107], v8 offset:27648
  v_mfma_f32_32x32x16_bf16 v[60:75], v[112:115], v[92:95], v[60:75]
  ds_read_b128 v[116:119], v12 offset:26624
  ds_read_b128 v[120:123], v12 offset:27648
  v_mfma_f32_32x32x16_bf16 v[44:59], v[108:111], v[96:99], v[44:59]
  v_mfma_f32_32x32x16_bf16 v[76:91], v[112:115], v[96:99], v[76:91]
  s_waitcnt lgkmcnt(0)
  s_waitcnt vmcnt(9)
  s_barrier
  v_mfma_f32_32x32x16_bf16 v[28:43], v[116:119], v[100:103], v[28:43]
  ds_read_b128 v[92:95], v6 offset:0
  ds_read_b128 v[96:99], v6 offset:2048
  ds_read_b128 v[108:111], v10 offset:0
  ds_read_b128 v[112:115], v10 offset:1024
  s_add_u32 s37, s42, 2
  v_mfma_f32_32x32x16_bf16 v[60:75], v[120:123], v[100:103], v[60:75]
  s_cmp_ge_u32 s37, 4
  s_cselect_b32 s100, 4, 0
  s_sub_u32 s37, s37, s100
  s_add_u32 s37, s37, 8
  s_lshl_b32 s30, s37, 11
  v_mfma_f32_32x32x16_bf16 v[44:59], v[116:119], v[104:107], v[44:59]
  s_add_u32 m0, s29, 98304
  s_add_u32 s30, s30, s38
  buffer_load_dwordx4 v4, s[16:19], s30 offen sc1 lds
  s_lshl_b32 s31, s37, 12
  s_add_u32 m0, s36, 106496
  v_mfma_f32_32x32x16_bf16 v[76:91], v[120:123], v[104:107], v[76:91]
  s_add_u32 s31, s31, s39
  buffer_load_dwordx4 v4, s[16:19], s31 offen sc1 lds
  s_add_u32 m0, s36, 107520
  s_add_u32 s35, s31, 1024
  buffer_load_dwordx4 v4, s[16:19], s35 offen sc1 lds
  s_waitcnt lgkmcnt(0)
  v_mfma_f32_32x32x16_bf16 v[28:43], v[108:111], v[92:95], v[28:43]
  ds_read_b128 v[100:103], v6 offset:1024
  ds_read_b128 v[104:107], v6 offset:3072
  v_mfma_f32_32x32x16_bf16 v[60:75], v[112:115], v[92:95], v[60:75]
  ds_read_b128 v[116:119], v10 offset:2048
  ds_read_b128 v[120:123], v10 offset:3072
  v_mfma_f32_32x32x16_bf16 v[44:59], v[108:111], v[96:99], v[44:59]
  v_mfma_f32_32x32x16_bf16 v[76:91], v[112:115], v[96:99], v[76:91]
  s_waitcnt lgkmcnt(0)
  s_waitcnt vmcnt(9)
  s_barrier
  v_mfma_f32_32x32x16_bf16 v[28:43], v[116:119], v[100:103], v[28:43]
  ds_read_b128 v[92:95], v6 offset:24576
  ds_read_b128 v[96:99], v6 offset:26624
  ds_read_b128 v[108:111], v10 offset:24576
  ds_read_b128 v[112:115], v10 offset:25600
  s_add_u32 s37, s42, 3
  v_mfma_f32_32x32x16_bf16 v[60:75], v[120:123], v[100:103], v[60:75]
  s_cmp_ge_u32 s37, 4
  s_cselect_b32 s100, 4, 0
  s_sub_u32 s37, s37, s100
  s_add_u32 s37, s37, 8
  s_lshl_b32 s30, s37, 11
  v_mfma_f32_32x32x16_bf16 v[44:59], v[116:119], v[104:107], v[44:59]
  s_add_u32 m0, s29, 122880
  s_add_u32 s30, s30, s38
  buffer_load_dwordx4 v4, s[16:19], s30 offen sc1 lds
  s_lshl_b32 s31, s37, 12
  s_add_u32 m0, s36, 131072
  v_mfma_f32_32x32x16_bf16 v[76:91], v[120:123], v[104:107], v[76:91]
  s_add_u32 s31, s31, s39
  buffer_load_dwordx4 v4, s[16:19], s31 offen sc1 lds
  s_add_u32 m0, s36, 132096
  s_add_u32 s35, s31, 1024
  buffer_load_dwordx4 v4, s[16:19], s35 offen sc1 lds
  s_waitcnt lgkmcnt(0)
  v_mfma_f32_32x32x16_bf16 v[28:43], v[108:111], v[92:95], v[28:43]
  ds_read_b128 v[100:103], v6 offset:25600
  ds_read_b128 v[104:107], v6 offset:27648
  v_mfma_f32_32x32x16_bf16 v[60:75], v[112:115], v[92:95], v[60:75]
  ds_read_b128 v[116:119], v10 offset:26624
  ds_read_b128 v[120:123], v10 offset:27648
  v_mfma_f32_32x32x16_bf16 v[44:59], v[108:111], v[96:99], v[44:59]
  v_mfma_f32_32x32x16_bf16 v[76:91], v[112:115], v[96:99], v[76:91]
  s_waitcnt lgkmcnt(0)
  s_waitcnt vmcnt(9)
  s_barrier
  v_mfma_f32_32x32x16_bf16 v[28:43], v[116:119], v[100:103], v[28:43]
  ds_read_b128 v[92:95], v7 offset:0
  ds_read_b128 v[96:99], v7 offset:2048
  ds_read_b128 v[108:111], v11 offset:0
  ds_read_b128 v[112:115], v11 offset:1024
  v_mfma_f32_32x32x16_bf16 v[60:75], v[120:123], v[100:103], v[60:75]
  s_add_u32 s37, s42, 12
  s_lshl_b32 s30, s37, 11
  s_add_u32 m0, s29, 0
  s_add_u32 s30, s30, s38
  v_mfma_f32_32x32x16_bf16 v[44:59], v[116:119], v[104:107], v[44:59]
  buffer_load_dwordx4 v4, s[16:19], s30 offen sc1 lds
  s_lshl_b32 s31, s37, 12
  s_add_u32 m0, s36, 8192
  s_add_u32 s31, s31, s39
  v_mfma_f32_32x32x16_bf16 v[76:91], v[120:123], v[104:107], v[76:91]
  buffer_load_dwordx4 v4, s[16:19], s31 offen sc1 lds
  s_add_u32 m0, s36, 9216
  s_add_u32 s35, s31, 1024
  buffer_load_dwordx4 v4, s[16:19], s35 offen sc1 lds
  s_waitcnt lgkmcnt(0)
  v_mfma_f32_32x32x16_bf16 v[28:43], v[108:111], v[92:95], v[28:43]
  ds_read_b128 v[100:103], v7 offset:1024
  ds_read_b128 v[104:107], v7 offset:3072
  v_mfma_f32_32x32x16_bf16 v[60:75], v[112:115], v[92:95], v[60:75]
  ds_read_b128 v[116:119], v11 offset:2048
  ds_read_b128 v[120:123], v11 offset:3072
  v_mfma_f32_32x32x16_bf16 v[44:59], v[108:111], v[96:99], v[44:59]
  v_mfma_f32_32x32x16_bf16 v[76:91], v[112:115], v[96:99], v[76:91]
  s_waitcnt lgkmcnt(0)
  s_waitcnt vmcnt(9)
  s_barrier
  v_mfma_f32_32x32x16_bf16 v[28:43], v[116:119], v[100:103], v[28:43]
  ds_read_b128 v[92:95], v7 offset:24576
  ds_read_b128 v[96:99], v7 offset:26624
  ds_read_b128 v[108:111], v11 offset:24576
  ds_read_b128 v[112:115], v11 offset:25600
  s_add_u32 s37, s42, 1
  v_mfma_f32_32x32x16_bf16 v[60:75], v[120:123], v[100:103], v[60:75]
  s_cmp_ge_u32 s37, 4
  s_cselect_b32 s100, 4, 0
  s_sub_u32 s37, s37, s100
  s_add_u32 s37, s37, 12
  s_lshl_b32 s30, s37, 11
  v_mfma_f32_32x32x16_bf16 v[44:59], v[116:119], v[104:107], v[44:59]
  s_add_u32 m0, s29, 24576
  s_add_u32 s30, s30, s38
  buffer_load_dwordx4 v4, s[16:19], s30 offen sc1 lds
  s_lshl_b32 s31, s37, 12
  s_add_u32 m0, s36, 32768
  v_mfma_f32_32x32x16_bf16 v[76:91], v[120:123], v[104:107], v[76:91]
  s_add_u32 s31, s31, s39
  buffer_load_dwordx4 v4, s[16:19], s31 offen sc1 lds
  s_add_u32 m0, s36, 33792
  s_add_u32 s35, s31, 1024
  buffer_load_dwordx4 v4, s[16:19], s35 offen sc1 lds
  s_waitcnt lgkmcnt(0)
  v_mfma_f32_32x32x16_bf16 v[28:43], v[108:111], v[92:95], v[28:43]
  ds_read_b128 v[100:103], v7 offset:25600
  ds_read_b128 v[104:107], v7 offset:27648
  v_mfma_f32_32x32x16_bf16 v[60:75], v[112:115], v[92:95], v[60:75]
  ds_read_b128 v[116:119], v11 offset:26624
  ds_read_b128 v[120:123], v11 offset:27648
  v_mfma_f32_32x32x16_bf16 v[44:59], v[108:111], v[96:99], v[44:59]
  v_mfma_f32_32x32x16_bf16 v[76:91], v[112:115], v[96:99], v[76:91]
  s_waitcnt lgkmcnt(0)
  s_waitcnt vmcnt(9)
  s_barrier
  v_mfma_f32_32x32x16_bf16 v[28:43], v[116:119], v[100:103], v[28:43]
  ds_read_b128 v[92:95], v8 offset:0
  ds_read_b128 v[96:99], v8 offset:2048
  ds_read_b128 v[108:111], v12 offset:0
  ds_read_b128 v[112:115], v12 offset:1024
  s_add_u32 s37, s42, 2
  v_mfma_f32_32x32x16_bf16 v[60:75], v[120:123], v[100:103], v[60:75]
  s_cmp_ge_u32 s37, 4
  s_cselect_b32 s100, 4, 0
  s_sub_u32 s37, s37, s100
  s_add_u32 s37, s37, 12
  s_lshl_b32 s30, s37, 11
  v_mfma_f32_32x32x16_bf16 v[44:59], v[116:119], v[104:107], v[44:59]
  s_add_u32 m0, s29, 49152
  s_add_u32 s30, s30, s38
  buffer_load_dwordx4 v4, s[16:19], s30 offen sc1 lds
  s_lshl_b32 s31, s37, 12
  s_add_u32 m0, s36, 57344
  v_mfma_f32_32x32x16_bf16 v[76:91], v[120:123], v[104:107], v[76:91]
  s_add_u32 s31, s31, s39
  buffer_load_dwordx4 v4, s[16:19], s31 offen sc1 lds
  s_add_u32 m0, s36, 58368
  s_add_u32 s35, s31, 1024
  buffer_load_dwordx4 v4, s[16:19], s35 offen sc1 lds
  s_waitcnt lgkmcnt(0)
  v_mfma_f32_32x32x16_bf16 v[28:43], v[108:111], v[92:95], v[28:43]
  ds_read_b128 v[100:103], v8 offset:1024
  ds_read_b128 v[104:107], v8 offset:3072
  v_mfma_f32_32x32x16_bf16 v[60:75], v[112:115], v[92:95], v[60:75]
  ds_read_b128 v[116:119], v12 offset:2048
  ds_read_b128 v[120:123], v12 offset:3072
  v_mfma_f32_32x32x16_bf16 v[44:59], v[108:111], v[96:99], v[44:59]
  v_mfma_f32_32x32x16_bf16 v[76:91], v[112:115], v[96:99], v[76:91]
  s_waitcnt lgkmcnt(0)
  s_waitcnt vmcnt(9)
  s_barrier
  v_mfma_f32_32x32x16_bf16 v[28:43], v[116:119], v[100:103], v[28:43]
  ds_read_b128 v[92:95], v8 offset:24576
  ds_read_b128 v[96:99], v8 offset:26624
  ds_read_b128 v[108:111], v12 offset:24576
  ds_read_b128 v[112:115], v12 offset:25600
  s_add_u32 s37, s42, 3
  v_mfma_f32_32x32x16_bf16 v[60:75], v[120:123], v[100:103], v[60:75]
  s_cmp_ge_u32 s37, 4
  s_cselect_b32 s100, 4, 0
  s_sub_u32 s37, s37, s100
  s_add_u32 s37, s37, 12
  s_lshl_b32 s30, s37, 11
  v_mfma_f32_32x32x16_bf16 v[44:59], v[116:119], v[104:107], v[44:59]
  s_add_u32 m0, s29, 73728
  s_add_u32 s30, s30, s38
  buffer_load_dwordx4 v4, s[16:19], s30 offen sc1 lds
  s_lshl_b32 s31, s37, 12
  s_add_u32 m0, s36, 81920
  v_mfma_f32_32x32x16_bf16 v[76:91], v[120:123], v[104:107], v[76:91]
  s_add_u32 s31, s31, s39
  buffer_load_dwordx4 v4, s[16:19], s31 offen sc1 lds
  s_add_u32 m0, s36, 82944
  s_add_u32 s35, s31, 1024
  buffer_load_dwordx4 v4, s[16:19], s35 offen sc1 lds
  s_waitcnt lgkmcnt(0)
  v_mfma_f32_32x32x16_bf16 v[28:43], v[108:111], v[92:95], v[28:43]
  ds_read_b128 v[100:103], v8 offset:25600
  ds_read_b128 v[104:107], v8 offset:27648
  v_mfma_f32_32x32x16_bf16 v[60:75], v[112:115], v[92:95], v[60:75]
  ds_read_b128 v[116:119], v12 offset:26624
  ds_read_b128 v[120:123], v12 offset:27648
  v_mfma_f32_32x32x16_bf16 v[44:59], v[108:111], v[96:99], v[44:59]
  v_mfma_f32_32x32x16_bf16 v[76:91], v[112:115], v[96:99], v[76:91]
  s_waitcnt lgkmcnt(0)
  s_waitcnt vmcnt(9)
  s_barrier
  v_mfma_f32_32x32x16_bf16 v[28:43], v[116:119], v[100:103], v[28:43]
  ds_read_b128 v[92:95], v6 offset:0
  ds_read_b128 v[96:99], v6 offset:2048
  ds_read_b128 v[108:111], v10 offset:0
  ds_read_b128 v[112:115], v10 offset:1024
  v_mfma_f32_32x32x16_bf16 v[60:75], v[120:123], v[100:103], v[60:75]
  s_add_u32 s37, s42, 16
  s_lshl_b32 s30, s37, 11
  s_add_u32 m0, s29, 98304
  s_add_u32 s30, s30, s38
  v_mfma_f32_32x32x16_bf16 v[44:59], v[116:119], v[104:107], v[44:59]
  buffer_load_dwordx4 v4, s[16:19], s30 offen sc1 lds
  s_lshl_b32 s31, s37, 12
  s_add_u32 m0, s36, 106496
  s_add_u32 s31, s31, s39
  v_mfma_f32_32x32x16_bf16 v[76:91], v[120:123], v[104:107], v[76:91]
  buffer_load_dwordx4 v4, s[16:19], s31 offen sc1 lds
  s_add_u32 m0, s36, 107520
  s_add_u32 s35, s31, 1024
  buffer_load_dwordx4 v4, s[16:19], s35 offen sc1 lds
  s_waitcnt lgkmcnt(0)
  v_mfma_f32_32x32x16_bf16 v[28:43], v[108:111], v[92:95], v[28:43]
  ds_read_b128 v[100:103], v6 offset:1024
  ds_read_b128 v[104:107], v6 offset:3072
  v_mfma_f32_32x32x16_bf16 v[60:75], v[112:115], v[92:95], v[60:75]
  ds_read_b128 v[116:119], v10 offset:2048
  ds_read_b128 v[120:123], v10 offset:3072
  v_mfma_f32_32x32x16_bf16 v[44:59], v[108:111], v[96:99], v[44:59]
  v_mfma_f32_32x32x16_bf16 v[76:91], v[112:115], v[96:99], v[76:91]
  s_waitcnt lgkmcnt(0)
  s_waitcnt vmcnt(9)
  s_barrier
  v_mfma_f32_32x32x16_bf16 v[28:43], v[116:119], v[100:103], v[28:43]
  ds_read_b128 v[92:95], v6 offset:24576
  ds_read_b128 v[96:99], v6 offset:26624
  ds_read_b128 v[108:111], v10 offset:24576
  ds_read_b128 v[112:115], v10 offset:25600
  s_add_u32 s37, s42, 1
  v_mfma_f32_32x32x16_bf16 v[60:75], v[120:123], v[100:103], v[60:75]
  s_cmp_ge_u32 s37, 4
  s_cselect_b32 s100, 4, 0
  s_sub_u32 s37, s37, s100
  s_add_u32 s37, s37, 16
  s_lshl_b32 s30, s37, 11
  v_mfma_f32_32x32x16_bf16 v[44:59], v[116:119], v[104:107], v[44:59]
  s_add_u32 m0, s29, 122880
  s_add_u32 s30, s30, s38
  buffer_load_dwordx4 v4, s[16:19], s30 offen sc1 lds
  s_lshl_b32 s31, s37, 12
  s_add_u32 m0, s36, 131072
  v_mfma_f32_32x32x16_bf16 v[76:91], v[120:123], v[104:107], v[76:91]
  s_add_u32 s31, s31, s39
  buffer_load_dwordx4 v4, s[16:19], s31 offen sc1 lds
  s_add_u32 m0, s36, 132096
  s_add_u32 s35, s31, 1024
  buffer_load_dwordx4 v4, s[16:19], s35 offen sc1 lds
  s_waitcnt lgkmcnt(0)
  v_mfma_f32_32x32x16_bf16 v[28:43], v[108:111], v[92:95], v[28:43]
  ds_read_b128 v[100:103], v6 offset:25600
  ds_read_b128 v[104:107], v6 offset:27648
  v_mfma_f32_32x32x16_bf16 v[60:75], v[112:115], v[92:95], v[60:75]
  ds_read_b128 v[116:119], v10 offset:26624
  ds_read_b128 v[120:123], v10 offset:27648
  v_mfma_f32_32x32x16_bf16 v[44:59], v[108:111], v[96:99], v[44:59]
  v_mfma_f32_32x32x16_bf16 v[76:91], v[112:115], v[96:99], v[76:91]
  s_waitcnt lgkmcnt(0)
  s_waitcnt vmcnt(9)
  s_barrier
  v_mfma_f32_32x32x16_bf16 v[28:43], v[116:119], v[100:103], v[28:43]
  ds_read_b128 v[92:95], v7 offset:0
  ds_read_b128 v[96:99], v7 offset:2048
  ds_read_b128 v[108:111], v11 offset:0
  ds_read_b128 v[112:115], v11 offset:1024
  s_add_u32 s37, s42, 2
  v_mfma_f32_32x32x16_bf16 v[60:75], v[120:123], v[100:103], v[60:75]
  s_cmp_ge_u32 s37, 4
  s_cselect_b32 s100, 4, 0
  s_sub_u32 s37, s37, s100
  s_add_u32 s37, s37, 16
  s_lshl_b32 s30, s37, 11
  v_mfma_f32_32x32x16_bf16 v[44:59], v[116:119], v[104:107], v[44:59]
  s_add_u32 m0, s29, 0
  s_add_u32 s30, s30, s38
  buffer_load_dwordx4 v4, s[16:19], s30 offen sc1 lds
  s_lshl_b32 s31, s37, 12
  s_add_u32 m0, s36, 8192
  v_mfma_f32_32x32x16_bf16 v[76:91], v[120:123], v[104:107], v[76:91]
  s_add_u32 s31, s31, s39
  buffer_load_dwordx4 v4, s[16:19], s31 offen sc1 lds
  s_add_u32 m0, s36, 9216
  s_add_u32 s35, s31, 1024
  buffer_load_dwordx4 v4, s[16:19], s35 offen sc1 lds
  s_waitcnt lgkmcnt(0)
  v_mfma_f32_32x32x16_bf16 v[28:43], v[108:111], v[92:95], v[28:43]
  ds_read_b128 v[100:103], v7 offset:1024
  ds_read_b128 v[104:107], v7 offset:3072
  v_mfma_f32_32x32x16_bf16 v[60:75], v[112:115], v[92:95], v[60:75]
  ds_read_b128 v[116:119], v11 offset:2048
  ds_read_b128 v[120:123], v11 offset:3072
  v_mfma_f32_32x32x16_bf16 v[44:59], v[108:111], v[96:99], v[44:59]
  v_mfma_f32_32x32x16_bf16 v[76:91], v[112:115], v[96:99], v[76:91]
  s_waitcnt lgkmcnt(0)
  s_waitcnt vmcnt(9)
  s_barrier
  v_mfma_f32_32x32x16_bf16 v[28:43], v[116:119], v[100:103], v[28:43]
  ds_read_b128 v[92:95], v7 offset:24576
  ds_read_b128 v[96:99], v7 offset:26624
  ds_read_b128 v[108:111], v11 offset:24576
  ds_read_b128 v[112:115], v11 offset:25600
  s_add_u32 s37, s42, 3
  v_mfma_f32_32x32x16_bf16 v[60:75], v[120:123], v[100:103], v[60:75]
  s_cmp_ge_u32 s37, 4
  s_cselect_b32 s100, 4, 0
  s_sub_u32 s37, s37, s100
  s_add_u32 s37, s37, 16
  s_lshl_b32 s30, s37, 11
  v_mfma_f32_32x32x16_bf16 v[44:59], v[116:119], v[104:107], v[44:59]
  s_add_u32 m0, s29, 24576
  s_add_u32 s30, s30, s38
  buffer_load_dwordx4 v4, s[16:19], s30 offen sc1 lds
  s_lshl_b32 s31, s37, 12
  s_add_u32 m0, s36, 32768
  v_mfma_f32_32x32x16_bf16 v[76:91], v[120:123], v[104:107], v[76:91]
  s_add_u32 s31, s31, s39
  buffer_load_dwordx4 v4, s[16:19], s31 offen sc1 lds
  s_add_u32 m0, s36, 33792
  s_add_u32 s35, s31, 1024
  buffer_load_dwordx4 v4, s[16:19], s35 offen sc1 lds
  s_waitcnt lgkmcnt(0)
  v_mfma_f32_32x32x16_bf16 v[28:43], v[108:111], v[92:95], v[28:43]
  ds_read_b128 v[100:103], v7 offset:25600
  ds_read_b128 v[104:107], v7 offset:27648
  v_mfma_f32_32x32x16_bf16 v[60:75], v[112:115], v[92:95], v[60:75]
  ds_read_b128 v[116:119], v11 offset:26624
  ds_read_b128 v[120:123], v11 offset:27648
  v_mfma_f32_32x32x16_bf16 v[44:59], v[108:111], v[96:99], v[44:59]
  v_mfma_f32_32x32x16_bf16 v[76:91], v[112:115], v[96:99], v[76:91]
  s_waitcnt lgkmcnt(0)
  s_waitcnt vmcnt(9)
  s_barrier
  v_mfma_f32_32x32x16_bf16 v[28:43], v[116:119], v[100:103], v[28:43]
  ds_read_b128 v[92:95], v8 offset:0
  ds_read_b128 v[96:99], v8 offset:2048
  v_mfma_f32_32x32x16_bf16 v[60:75], v[120:123], v[100:103], v[60:75]
  ds_read_b128 v[108:111], v12 offset:0
  ds_read_b128 v[112:115], v12 offset:1024
  v_mfma_f32_32x32x16_bf16 v[44:59], v[116:119], v[104:107], v[44:59]
  v_mfma_f32_32x32x16_bf16 v[76:91], v[120:123], v[104:107], v[76:91]
  s_waitcnt lgkmcnt(0)
  v_mfma_f32_32x32x16_bf16 v[28:43], v[108:111], v[92:95], v[28:43]
  ds_read_b128 v[100:103], v8 offset:1024
  ds_read_b128 v[104:107], v8 offset:3072
  v_mfma_f32_32x32x16_bf16 v[60:75], v[112:115], v[92:95], v[60:75]
  ds_read_b128 v[116:119], v12 offset:2048
  ds_read_b128 v[120:123], v12 offset:3072
  v_mfma_f32_32x32x16_bf16 v[44:59], v[108:111], v[96:99], v[44:59]
  v_mfma_f32_32x32x16_bf16 v[76:91], v[112:115], v[96:99], v[76:91]
  s_waitcnt lgkmcnt(0)
  s_waitcnt vmcnt(6)
  s_barrier
  v_mfma_f32_32x32x16_bf16 v[28:43], v[116:119], v[100:103], v[28:43]
  ds_read_b128 v[92:95], v8 offset:24576
  ds_read_b128 v[96:99], v8 offset:26624
  v_mfma_f32_32x32x16_bf16 v[60:75], v[120:123], v[100:103], v[60:75]
  ds_read_b128 v[108:111], v12 offset:24576
  ds_read_b128 v[112:115], v12 offset:25600
  v_mfma_f32_32x32x16_bf16 v[44:59], v[116:119], v[104:107], v[44:59]
  v_mfma_f32_32x32x16_bf16 v[76:91], v[120:123], v[104:107], v[76:91]
  s_waitcnt lgkmcnt(0)
  v_mfma_f32_32x32x16_bf16 v[28:43], v[108:111], v[92:95], v[28:43]
  ds_read_b128 v[100:103], v8 offset:25600
  ds_read_b128 v[104:107], v8 offset:27648
  v_mfma_f32_32x32x16_bf16 v[60:75], v[112:115], v[92:95], v[60:75]
  ds_read_b128 v[116:119], v12 offset:26624
  ds_read_b128 v[120:123], v12 offset:27648
  v_mfma_f32_32x32x16_bf16 v[44:59], v[108:111], v[96:99], v[44:59]
  v_mfma_f32_32x32x16_bf16 v[76:91], v[112:115], v[96:99], v[76:91]
  s_waitcnt lgkmcnt(0)
  s_waitcnt vmcnt(3)
  s_barrier
  v_mfma_f32_32x32x16_bf16 v[28:43], v[116:119], v[100:103], v[28:43]
  ds_read_b128 v[92:95], v6 offset:0
  ds_read_b128 v[96:99], v6 offset:2048
  v_mfma_f32_32x32x16_bf16 v[60:75], v[120:123], v[100:103], v[60:75]
  ds_read_b128 v[108:111], v10 offset:0
  ds_read_b128 v[112:115], v10 offset:1024
  v_mfma_f32_32x32x16_bf16 v[44:59], v[116:119], v[104:107], v[44:59]
  v_mfma_f32_32x32x16_bf16 v[76:91], v[120:123], v[104:107], v[76:91]
  s_waitcnt lgkmcnt(0)
  v_mfma_f32_32x32x16_bf16 v[28:43], v[108:111], v[92:95], v[28:43]
  ds_read_b128 v[100:103], v6 offset:1024
  ds_read_b128 v[104:107], v6 offset:3072
  v_mfma_f32_32x32x16_bf16 v[60:75], v[112:115], v[92:95], v[60:75]
  ds_read_b128 v[116:119], v10 offset:2048
  ds_read_b128 v[120:123], v10 offset:3072
  v_mfma_f32_32x32x16_bf16 v[44:59], v[108:111], v[96:99], v[44:59]
  v_mfma_f32_32x32x16_bf16 v[76:91], v[112:115], v[96:99], v[76:91]
  s_waitcnt lgkmcnt(0)
  s_waitcnt vmcnt(0)
  s_barrier
  v_mfma_f32_32x32x16_bf16 v[28:43], v[116:119], v[100:103], v[28:43]
  ds_read_b128 v[92:95], v6 offset:24576
  ds_read_b128 v[96:99], v6 offset:26624
  v_mfma_f32_32x32x16_bf16 v[60:75], v[120:123], v[100:103], v[60:75]
  ds_read_b128 v[108:111], v10 offset:24576
  ds_read_b128 v[112:115], v10 offset:25600
  v_mfma_f32_32x32x16_bf16 v[44:59], v[116:119], v[104:107], v[44:59]
  v_mfma_f32_32x32x16_bf16 v[76:91], v[120:123], v[104:107], v[76:91]
  s_waitcnt lgkmcnt(0)
  v_mfma_f32_32x32x16_bf16 v[28:43], v[108:111], v[92:95], v[28:43]
  ds_read_b128 v[100:103], v6 offset:25600
  ds_read_b128 v[104:107], v6 offset:27648
  v_mfma_f32_32x32x16_bf16 v[60:75], v[112:115], v[92:95], v[60:75]
  ds_read_b128 v[116:119], v10 offset:26624
  ds_read_b128 v[120:123], v10 offset:27648
  v_mfma_f32_32x32x16_bf16 v[44:59], v[108:111], v[96:99], v[44:59]
  v_mfma_f32_32x32x16_bf16 v[76:91], v[112:115], v[96:99], v[76:91]
  s_waitcnt lgkmcnt(0)
  v_mfma_f32_32x32x16_bf16 v[28:43], v[116:119], v[100:103], v[28:43]
  v_mfma_f32_32x32x16_bf16 v[60:75], v[120:123], v[100:103], v[60:75]
  v_mfma_f32_32x32x16_bf16 v[44:59], v[116:119], v[104:107], v[44:59]
  v_mfma_f32_32x32x16_bf16 v[76:91], v[120:123], v[104:107], v[76:91]
  s_lshl_b32 s32, s21, 2
  s_add_u32 s32, s32, s28
  s_cmp_ge_u32 s32, 54
  s_cbranch_scc1 p4_kernel_skip_6
  s_lshl_b32 s33, s23, 6
  v_add_u32 v20, s33, v2
  v_lshlrev_b32 v20, 3, v20
  v_add_u32 v20, 147456, v20
  ds_read_b64 v[24:25], v20 offset:0
  ds_read_b64 v[26:27], v20 offset:256
  s_lshl_b32 s33, s28, 7
  s_add_u32 s33, s33, 148480
  v_lshl_add_u32 v21, v3, 4, s33
  ds_read_b128 v[92:95], v21 offset:0
  ds_read_b128 v[108:111], v21 offset:512
  ds_read_b128 v[96:99], v21 offset:32
  ds_read_b128 v[112:115], v21 offset:544
  ds_read_b128 v[100:103], v21 offset:64
  ds_read_b128 v[116:119], v21 offset:576
  ds_read_b128 v[104:107], v21 offset:96
  ds_read_b128 v[120:123], v21 offset:608
  s_lshl_b32 s33, s20, 2
  s_lshl_b32 s34, s23, 1
  s_add_u32 s33, s33, s34
  s_lshl_b32 s33, s33, 1
  s_mul_i32 s33, s33, 54
  s_add_u32 s33, s33, s32
  s_lshl_b32 s33, s33, 10
  s_add_u32 s33, s33, 0xc80000
  v_lshrrev_b32 v22, 4, v2
  v_mul_u32_u24 v22, 55296, v22
  v_and_b32 v23, 15, v2
  v_lshl_add_u32 v22, v23, 4, v22
  v_lshl_add_u32 v22, v3, 8, v22
  s_add_u32 s34, s33, 110592
  s_waitcnt lgkmcnt(0)
  v_mul_f32 v25, 0xbfb8aa3b, v25
  v_fma_f32 v28, -v24, v92, v28
  v_fma_f32 v60, -v24, v108, v60
  v_fma_f32 v29, -v24, v93, v29
  v_fma_f32 v61, -v24, v109, v61
  v_fma_f32 v30, -v24, v94, v30
  v_fma_f32 v62, -v24, v110, v62
  v_fma_f32 v31, -v24, v95, v31
  v_fma_f32 v63, -v24, v111, v63
  v_fma_f32 v32, -v24, v96, v32
  v_fma_f32 v64, -v24, v112, v64
  v_fma_f32 v33, -v24, v97, v33
  v_fma_f32 v65, -v24, v113, v65
  v_fma_f32 v34, -v24, v98, v34
  v_fma_f32 v66, -v24, v114, v66
  v_fma_f32 v35, -v24, v99, v35
  v_fma_f32 v67, -v24, v115, v67
  v_fma_f32 v36, -v24, v100, v36
  v_fma_f32 v68, -v24, v116, v68
  v_fma_f32 v37, -v24, v101, v37
  v_fma_f32 v69, -v24, v117, v69
  v_fma_f32 v38, -v24, v102, v38
  v_fma_f32 v70, -v24, v118, v70
  v_fma_f32 v39, -v24, v103, v39
  v_fma_f32 v71, -v24, v119, v71
  v_fma_f32 v40, -v24, v104, v40
  v_fma_f32 v72, -v24, v120, v72
  v_fma_f32 v41, -v24, v105, v41
  v_fma_f32 v73, -v24, v121, v73
  v_fma_f32 v42, -v24, v106, v42
  v_fma_f32 v74, -v24, v122, v74
  v_fma_f32 v43, -v24, v107, v43
  v_fma_f32 v75, -v24, v123, v75
  v_mul_f32 v124, v25, v28
  v_mul_f32 v125, v25, v29
  v_mul_f32 v126, v25, v30
  v_mul_f32 v127, v25, v31
  v_mul_f32 v128, v25, v32
  v_mul_f32 v129, v25, v33
  v_mul_f32 v130, v25, v34
  v_mul_f32 v131, v25, v35
  v_mul_f32 v132, v25, v36
  v_mul_f32 v133, v25, v37
  v_mul_f32 v134, v25, v38
  v_mul_f32 v135, v25, v39
  v_mul_f32 v136, v25, v40
  v_mul_f32 v137, v25, v41
  v_mul_f32 v138, v25, v42
  v_mul_f32 v139, v25, v43
  v_exp_f32 v124, v124
  v_exp_f32 v125, v125
  v_exp_f32 v126, v126
  v_exp_f32 v127, v127
  v_exp_f32 v128, v128
  v_exp_f32 v129, v129
  v_exp_f32 v130, v130
  v_exp_f32 v131, v131
  v_exp_f32 v132, v132
  v_exp_f32 v133, v133
  v_exp_f32 v134, v134
  v_exp_f32 v135, v135
  v_exp_f32 v136, v136
  v_exp_f32 v137, v137
  v_exp_f32 v138, v138
  v_exp_f32 v139, v139
  v_mul_f32 v28, v28, v60
  v_mul_f32 v29, v29, v61
  v_mul_f32 v30, v30, v62
  v_mul_f32 v31, v31, v63
  v_mul_f32 v32, v32, v64
  v_mul_f32 v33, v33, v65
  v_mul_f32 v34, v34, v66
  v_mul_f32 v35, v35, v67
  v_mul_f32 v36, v36, v68
  v_mul_f32 v37, v37, v69
  v_mul_f32 v38, v38, v70
  v_mul_f32 v39, v39, v71
  v_mul_f32 v40, v40, v72
  v_mul_f32 v41, v41, v73
  v_mul_f32 v42, v42, v74
  v_mul_f32 v43, v43, v75
  v_add_f32 v124, 1.0, v124
  v_add_f32 v125, 1.0, v125
  v_add_f32 v126, 1.0, v126
  v_add_f32 v127, 1.0, v127
  v_add_f32 v128, 1.0, v128
  v_add_f32 v129, 1.0, v129
  v_add_f32 v130, 1.0, v130
  v_add_f32 v131, 1.0, v131
  v_add_f32 v132, 1.0, v132
  v_add_f32 v133, 1.0, v133
  v_add_f32 v134, 1.0, v134
  v_add_f32 v135, 1.0, v135
  v_add_f32 v136, 1.0, v136
  v_add_f32 v137, 1.0, v137
  v_add_f32 v138, 1.0, v138
  v_add_f32 v139, 1.0, v139
  v_rcp_f32 v124, v124
  v_rcp_f32 v125, v125
  v_rcp_f32 v126, v126
  v_rcp_f32 v127, v127
  v_rcp_f32 v128, v128
  v_rcp_f32 v129, v129
  v_rcp_f32 v130, v130
  v_rcp_f32 v131, v131
  v_rcp_f32 v132, v132
  v_rcp_f32 v133, v133
  v_rcp_f32 v134, v134
  v_rcp_f32 v135, v135
  v_rcp_f32 v136, v136
  v_rcp_f32 v137, v137
  v_rcp_f32 v138, v138
  v_rcp_f32 v139, v139
  s_nop 0
  v_mul_f32 v28, v28, v124
  v_mul_f32 v29, v29, v125
  v_mul_f32 v30, v30, v126
  v_mul_f32 v31, v31, v127
  v_mul_f32 v32, v32, v128
  v_mul_f32 v33, v33, v129
  v_mul_f32 v34, v34, v130
  v_mul_f32 v35, v35, v131
  v_mul_f32 v36, v36, v132
  v_mul_f32 v37, v37, v133
  v_mul_f32 v38, v38, v134
  v_mul_f32 v39, v39, v135
  v_mul_f32 v40, v40, v136
  v_mul_f32 v41, v41, v137
  v_mul_f32 v42, v42, v138
  v_mul_f32 v43, v43, v139
  v_cvt_pk_bf16_f32 v28, v28, v29
  v_cvt_pk_bf16_f32 v29, v30, v31
  v_cvt_pk_bf16_f32 v30, v32, v33
  v_cvt_pk_bf16_f32 v31, v34, v35
  v_cvt_pk_bf16_f32 v32, v36, v37
  v_cvt_pk_bf16_f32 v33, v38, v39
  v_cvt_pk_bf16_f32 v34, v40, v41
  v_cvt_pk_bf16_f32 v35, v42, v43
  buffer_store_dwordx4 v[28:31], v22, s[16:19], s33 offen sc1
  buffer_store_dwordx4 v[32:35], v22, s[16:19], s33 offen offset:512 sc1
  v_mul_f32 v27, 0xbfb8aa3b, v27
  v_fma_f32 v44, -v26, v92, v44
  v_fma_f32 v76, -v26, v108, v76
  v_fma_f32 v45, -v26, v93, v45
  v_fma_f32 v77, -v26, v109, v77
  v_fma_f32 v46, -v26, v94, v46
  v_fma_f32 v78, -v26, v110, v78
  v_fma_f32 v47, -v26, v95, v47
  v_fma_f32 v79, -v26, v111, v79
  v_fma_f32 v48, -v26, v96, v48
  v_fma_f32 v80, -v26, v112, v80
  v_fma_f32 v49, -v26, v97, v49
  v_fma_f32 v81, -v26, v113, v81
  v_fma_f32 v50, -v26, v98, v50
  v_fma_f32 v82, -v26, v114, v82
  v_fma_f32 v51, -v26, v99, v51
  v_fma_f32 v83, -v26, v115, v83
  v_fma_f32 v52, -v26, v100, v52
  v_fma_f32 v84, -v26, v116, v84
  v_fma_f32 v53, -v26, v101, v53
  v_fma_f32 v85, -v26, v117, v85
  v_fma_f32 v54, -v26, v102, v54
  v_fma_f32 v86, -v26, v118, v86
  v_fma_f32 v55, -v26, v103, v55
  v_fma_f32 v87, -v26, v119, v87
  v_fma_f32 v56, -v26, v104, v56
  v_fma_f32 v88, -v26, v120, v88
  v_fma_f32 v57, -v26, v105, v57
  v_fma_f32 v89, -v26, v121, v89
  v_fma_f32 v58, -v26, v106, v58
  v_fma_f32 v90, -v26, v122, v90
  v_fma_f32 v59, -v26, v107, v59
  v_fma_f32 v91, -v26, v123, v91
  v_mul_f32 v124, v27, v44
  v_mul_f32 v125, v27, v45
  v_mul_f32 v126, v27, v46
  v_mul_f32 v127, v27, v47
  v_mul_f32 v128, v27, v48
  v_mul_f32 v129, v27, v49
  v_mul_f32 v130, v27, v50
  v_mul_f32 v131, v27, v51
  v_mul_f32 v132, v27, v52
  v_mul_f32 v133, v27, v53
  v_mul_f32 v134, v27, v54
  v_mul_f32 v135, v27, v55
  v_mul_f32 v136, v27, v56
  v_mul_f32 v137, v27, v57
  v_mul_f32 v138, v27, v58
  v_mul_f32 v139, v27, v59
  v_exp_f32 v124, v124
  v_exp_f32 v125, v125
  v_exp_f32 v126, v126
  v_exp_f32 v127, v127
  v_exp_f32 v128, v128
  v_exp_f32 v129, v129
  v_exp_f32 v130, v130
  v_exp_f32 v131, v131
  v_exp_f32 v132, v132
  v_exp_f32 v133, v133
  v_exp_f32 v134, v134
  v_exp_f32 v135, v135
  v_exp_f32 v136, v136
  v_exp_f32 v137, v137
  v_exp_f32 v138, v138
  v_exp_f32 v139, v139
  v_mul_f32 v44, v44, v76
  v_mul_f32 v45, v45, v77
  v_mul_f32 v46, v46, v78
  v_mul_f32 v47, v47, v79
  v_mul_f32 v48, v48, v80
  v_mul_f32 v49, v49, v81
  v_mul_f32 v50, v50, v82
  v_mul_f32 v51, v51, v83
  v_mul_f32 v52, v52, v84
  v_mul_f32 v53, v53, v85
  v_mul_f32 v54, v54, v86
  v_mul_f32 v55, v55, v87
  v_mul_f32 v56, v56, v88
  v_mul_f32 v57, v57, v89
  v_mul_f32 v58, v58, v90
  v_mul_f32 v59, v59, v91
  v_add_f32 v124, 1.0, v124
  v_add_f32 v125, 1.0, v125
  v_add_f32 v126, 1.0, v126
  v_add_f32 v127, 1.0, v127
  v_add_f32 v128, 1.0, v128
  v_add_f32 v129, 1.0, v129
  v_add_f32 v130, 1.0, v130
  v_add_f32 v131, 1.0, v131
  v_add_f32 v132, 1.0, v132
  v_add_f32 v133, 1.0, v133
  v_add_f32 v134, 1.0, v134
  v_add_f32 v135, 1.0, v135
  v_add_f32 v136, 1.0, v136
  v_add_f32 v137, 1.0, v137
  v_add_f32 v138, 1.0, v138
  v_add_f32 v139, 1.0, v139
  v_rcp_f32 v124, v124
  v_rcp_f32 v125, v125
  v_rcp_f32 v126, v126
  v_rcp_f32 v127, v127
  v_rcp_f32 v128, v128
  v_rcp_f32 v129, v129
  v_rcp_f32 v130, v130
  v_rcp_f32 v131, v131
  v_rcp_f32 v132, v132
  v_rcp_f32 v133, v133
  v_rcp_f32 v134, v134
  v_rcp_f32 v135, v135
  v_rcp_f32 v136, v136
  v_rcp_f32 v137, v137
  v_rcp_f32 v138, v138
  v_rcp_f32 v139, v139
  s_nop 0
  v_mul_f32 v44, v44, v124
  v_mul_f32 v45, v45, v125
  v_mul_f32 v46, v46, v126
  v_mul_f32 v47, v47, v127
  v_mul_f32 v48, v48, v128
  v_mul_f32 v49, v49, v129
  v_mul_f32 v50, v50, v130
  v_mul_f32 v51, v51, v131
  v_mul_f32 v52, v52, v132
  v_mul_f32 v53, v53, v133
  v_mul_f32 v54, v54, v134
  v_mul_f32 v55, v55, v135
  v_mul_f32 v56, v56, v136
  v_mul_f32 v57, v57, v137
  v_mul_f32 v58, v58, v138
  v_mul_f32 v59, v59, v139
  v_cvt_pk_bf16_f32 v44, v44, v45
  v_cvt_pk_bf16_f32 v45, v46, v47
  v_cvt_pk_bf16_f32 v46, v48, v49
  v_cvt_pk_bf16_f32 v47, v50, v51
  v_cvt_pk_bf16_f32 v48, v52, v53
  v_cvt_pk_bf16_f32 v49, v54, v55
  v_cvt_pk_bf16_f32 v50, v56, v57
  v_cvt_pk_bf16_f32 v51, v58, v59
  buffer_store_dwordx4 v[44:47], v22, s[16:19], s34 offen sc1
  buffer_store_dwordx4 v[48:51], v22, s[16:19], s34 offen offset:512 sc1
  s_branch p4_kernel_join_7
p4_kernel_skip_6:
p4_kernel_join_7:
  s_mul_i32 s32, s20, 14
  s_add_u32 s32, s32, s21
  s_mov_b32 s94, s32
  s_mov_b32 s95, 1
  s_branch p4_kernel_END
p4_kernel_idle:
  s_waitcnt lgkmcnt(0)
  v_lshrrev_b32 v20, 6, v0
  s_nop 0
  v_readfirstlane_b32 s22, v20
  s_mov_b32 s16, s24
  s_and_b32 s17, s25, 0xffff
  s_mov_b32 s18, 0x1c00000
  s_mov_b32 s19, 0x20000
  s_waitcnt vmcnt(0)
  s_barrier
  s_cmp_eq_u32 s22, 0
  s_cbranch_scc0 p4_kernel_pub_8
  s_cmp_eq_u32 s95, 1
  s_cbranch_scc0 p4_kernel_pub_8
  s_lshl_b32 s33, s94, 7
  s_add_u32 s33, s33, 0x1bc8000
  v_mov_b32 v26, 0
  v_mov_b32 v27, s101
  s_mov_b64 exec, 1
  buffer_store_dword v27, v26, s[16:19], s33 offen sc1
  s_mov_b64 exec, -1
p4_kernel_pub_8:
  s_mov_b32 s95, 0
p4_kernel_END:
p4_kernel_CODE_END:
p5_kernel:
  s_load_dwordx2 s[6:7], s[0:1], 56
  s_load_dwordx2 s[24:25], s[0:1], 72
  s_and_b32 s32, s2, 7
  s_lshr_b32 s33, s2, 3
  s_lshr_b32 s34, s32, 1
  s_lshl_b32 s34, s34, 3
  s_and_b32 s35, s33, 7
  s_add_u32 s20, s34, s35
  s_and_b32 s34, s32, 1
  s_lshl_b32 s34, s34, 2
  s_lshr_b32 s35, s33, 3
  s_add_u32 s21, s34, s35
  v_lshrrev_b32 v14, 6, v0
  v_and_b32 v1, 63, v0
  v_readfirstlane_b32 s22, v14
  v_and_b32 v2, 15, v1
  v_lshrrev_b32 v3, 4, v1
  s_lshr_b32 s23, s22, 2
  s_and_b32 s28, s22, 3
  s_lshl_b32 s32, s20, 2
  s_add_u32 s28, s28, s32
  s_mov_b32 s38, -1
  s_mov_b32 s39, 0xff
  s_mul_i32 s36, s22, 640
  v_lshlrev_b32 v4, 4, v1
  v_add_u32 v4, s36, v4
  s_mul_i32 s42, s21, 276480
  s_add_u32 s42, s42, 0x1840000
  v_lshlrev_b32 v6, 4, v1
  s_lshl_b32 s32, s28, 4
  v_add_u32 v14, s32, v2
  s_mul_i32 s33, s21, 80
  s_mul_i32 s34, s23, 48
  s_add_u32 s33, s33, s34
  v_lshl_add_u32 v15, v3, 2, s33
  v_mul_u32_u24 v12, 1280, v14
  v_lshl_add_u32 v12, v15, 1, v12
  v_lshrrev_b32 v16, 5, v14
  v_mul_u32_u24 v16, 40, v16
  s_lshr_b32 s33, s33, 4
  v_add_u32 v16, s33, v16
  v_lshlrev_b32 v16, 10, v16
  v_and_b32 v17, 31, v14
  v_lshl_add_u32 v16, v17, 4, v16
  v_lshrrev_b32 v17, 1, v3
  v_lshl_add_u32 v16, v17, 9, v16
  v_and_b32 v17, 1, v3
  v_lshl_add_u32 v16, v17, 3, v16
  v_add_u32 v11, 0xa00000, v16
  v_lshlrev_b32 v13, 2, v14
  v_add_u32 v13, 0x1340000, v13
  s_waitcnt lgkmcnt(0)
  s_mov_b32 s12, s6
  s_and_b32 s13, s7, 0xffff
  s_mov_b32 s14, 0x280000
  s_mov_b32 s15, 0x20000
  s_mov_b32 s16, s24
  s_and_b32 s17, s25, 0xffff
  s_mov_b32 s18, 0x1c00000
  s_mov_b32 s19, 0x20000
  s_mul_i32 s40, s28, 55296
  s_lshl_b32 s32, s23, 10
  s_add_u32 s40, s40, s32
  s_add_u32 s40, s40, 0xc80000
  s_lshr_b32 s32, s2, 3
  s_and_b32 s33, s32, 7
  s_lshr_b32 s32, s32, 3
  s_add_u32 s32, s32, s33
  s_mul_i32 s33, s32, 86
  s_lshr_b32 s33, s33, 8
  s_mul_i32 s33, s33, 3
  s_sub_u32 s48, s32, s33
  s_waitcnt lgkmcnt(0)
  s_waitcnt vmcnt(0)
  s_barrier
  s_cmp_eq_u32 s22, 0
  s_cbranch_scc0 p5_kernel_pub_1
  s_cmp_eq_u32 s95, 1
  s_cbranch_scc0 p5_kernel_pub_1
  s_lshl_b32 s33, s94, 7
  s_add_u32 s33, s33, 0x1bd0000
  v_mov_b32 v14, 0
  v_mov_b32 v15, s101
  s_mov_b64 exec, 1
  buffer_store_dword v15, v14, s[16:19], s33 offen sc1
  s_mov_b64 exec, -1
p5_kernel_pub_1:
  s_mov_b32 s95, 0
  s_add_u32 s32, s22, 0
  s_mul_i32 s50, s32, 205
  s_lshr_b32 s50, s50, 11
  s_mul_i32 s33, s50, 10
  s_sub_u32 s32, s32, s33
  s_mul_i32 s60, s50, 10240
  s_lshl_b32 s33, s32, 10
  s_add_u32 s60, s60, s33
  s_add_u32 s55, s33, s42
  s_add_u32 s32, s22, 8
  s_mul_i32 s51, s32, 205
  s_lshr_b32 s51, s51, 11
  s_mul_i32 s33, s51, 10
  s_sub_u32 s32, s32, s33
  s_mul_i32 s61, s51, 10240
  s_lshl_b32 s33, s32, 10
  s_add_u32 s61, s61, s33
  s_add_u32 s56, s33, s42
  s_add_u32 s32, s22, 16
  s_mul_i32 s52, s32, 205
  s_lshr_b32 s52, s52, 11
  s_mul_i32 s33, s52, 10
  s_sub_u32 s32, s32, s33
  s_mul_i32 s62, s52, 10240
  s_lshl_b32 s33, s32, 10
  s_add_u32 s62, s62, s33
  s_add_u32 s57, s33, s42
  s_add_u32 s32, s22, 24
  s_mul_i32 s53, s32, 205
  s_lshr_b32 s53, s53, 11
  s_mul_i32 s33, s53, 10
  s_sub_u32 s32, s32, s33
  s_mul_i32 s63, s53, 10240
  s_lshl_b32 s33, s32, 10
  s_add_u32 s63, s63, s33
  s_add_u32 s58, s33, s42
  s_add_u32 s32, s22, 32
  s_mul_i32 s54, s32, 205
  s_lshr_b32 s54, s54, 11
  s_mul_i32 s33, s54, 10
  s_sub_u32 s32, s32, s33
  s_mul_i32 s64, s54, 10240
  s_lshl_b32 s33, s32, 10
  s_add_u32 s64, s64, s33
  s_add_u32 s59, s33, s42
  s_add_u32 s66, s48, 0
  s_mul_i32 s66, s66, 10240
  s_add_u32 s67, s48, 3
  s_mul_i32 s67, s67, 10240
  s_add_u32 s68, s48, 1
  s_cmp_ge_u32 s68, 3
  s_cselect_b32 s100, 3, 0
  s_sub_u32 s68, s68, s100
  s_mul_i32 s68, s68, 10240
  s_add_u32 s69, s48, 2
  s_cmp_ge_u32 s69, 3
  s_cselect_b32 s100, 3, 0
  s_sub_u32 s69, s69, s100
  s_mul_i32 s69, s69, 10240
  s_add_u32 s41, s66, s55
  s_add_u32 m0, s60, 0
  s_nop 0
  buffer_load_dwordx4 v6, s[16:19], s41 offen sc1 lds
  s_cmp_eq_u32 s51, 0
  s_cselect_b32 s41, s66, s67
  s_add_u32 s41, s41, s56
  s_add_u32 m0, s61, 0
  s_nop 0
  buffer_load_dwordx4 v6, s[16:19], s41 offen sc1 lds
  s_cmp_eq_u32 s52, 1
  s_cselect_b32 s41, s67, s68
  s_add_u32 s41, s41, s57
  s_add_u32 m0, s62, 0
  s_nop 0
  buffer_load_dwordx4 v6, s[16:19], s41 offen sc1 lds
  s_cmp_eq_u32 s53, 2
  s_cselect_b32 s41, s68, s69
  s_add_u32 s41, s41, s58
  s_add_u32 m0, s63, 0
  s_nop 0
  buffer_load_dwordx4 v6, s[16:19], s41 offen sc1 lds
  s_add_u32 s41, s69, s59
  s_add_u32 m0, s64, 0
  s_nop 0
  buffer_load_dwordx4 v6, s[16:19], s41 offen sc1 lds
  s_add_u32 s66, s48, 6
  s_mul_i32 s66, s66, 10240
  s_add_u32 s67, s48, 1
  s_cmp_ge_u32 s67, 3
  s_cselect_b32 s100, 3, 0
  s_sub_u32 s67, s67, s100
  s_add_u32 s67, s67, 3
  s_mul_i32 s67, s67, 10240
  s_add_u32 s68, s48, 2
  s_cmp_ge_u32 s68, 3
  s_cselect_b32 s100, 3, 0
  s_sub_u32 s68, s68, s100
  s_add_u32 s68, s68, 3
  s_mul_i32 s68, s68, 10240
  s_add_u32 s69, s48, 9
  s_mul_i32 s69, s69, 10240
  s_add_u32 s41, s66, s55
  s_add_u32 m0, s60, 40960
  s_nop 0
  buffer_load_dwordx4 v6, s[16:19], s41 offen sc1 lds
  s_cmp_eq_u32 s51, 0
  s_cselect_b32 s41, s66, s67
  s_add_u32 s41, s41, s56
  s_add_u32 m0, s61, 40960
  s_nop 0
  buffer_load_dwordx4 v6, s[16:19], s41 offen sc1 lds
  s_cmp_eq_u32 s52, 1
  s_cselect_b32 s41, s67, s68
  s_add_u32 s41, s41, s57
  s_add_u32 m0, s62, 40960
  s_nop 0
  buffer_load_dwordx4 v6, s[16:19], s41 offen sc1 lds
  s_cmp_eq_u32 s53, 2
  s_cselect_b32 s41, s68, s69
  s_add_u32 s41, s41, s58
  s_add_u32 m0, s63, 40960
  s_nop 0
  buffer_load_dwordx4 v6, s[16:19], s41 offen sc1 lds
  s_add_u32 s41, s69, s59
  s_add_u32 m0, s64, 40960
  s_nop 0
  buffer_load_dwordx4 v6, s[16:19], s41 offen sc1 lds
  s_add_u32 s66, s48, 1
  s_cmp_ge_u32 s66, 3
  s_cselect_b32 s100, 3, 0
  s_sub_u32 s66, s66, s100
  s_add_u32 s66, s66, 6
  s_mul_i32 s66, s66, 10240
  s_add_u32 s67, s48, 2
  s_cmp_ge_u32 s67, 3
  s_cselect_b32 s100, 3, 0
  s_sub_u32 s67, s67, s100
  s_add_u32 s67, s67, 6
  s_mul_i32 s67, s67, 10240
  s_add_u32 s68, s48, 12
  s_mul_i32 s68, s68, 10240
  s_add_u32 s69, s48, 1
  s_cmp_ge_u32 s69, 3
  s_cselect_b32 s100, 3, 0
  s_sub_u32 s69, s69, s100
  s_add_u32 s69, s69, 9
  s_mul_i32 s69, s69, 10240
  s_add_u32 s41, s66, s55
  s_add_u32 m0, s60, 81920
  s_nop 0
  buffer_load_dwordx4 v6, s[16:19], s41 offen sc1 lds
  s_cmp_eq_u32 s51, 0
  s_cselect_b32 s41, s66, s67
  s_add_u32 s41, s41, s56
  s_add_u32 m0, s61, 81920
  s_nop 0
  buffer_load_dwordx4 v6, s[16:19], s41 offen sc1 lds
  s_cmp_eq_u32 s52, 1
  s_cselect_b32 s41, s67, s68
  s_add_u32 s41, s41, s57
  s_add_u32 m0, s62, 81920
  s_nop 0
  buffer_load_dwordx4 v6, s[16:19], s41 offen sc1 lds
  s_cmp_eq_u32 s53, 2
  s_cselect_b32 s41, s68, s69
  s_add_u32 s41, s41, s58
  s_add_u32 m0, s63, 81920
  s_nop 0
  buffer_load_dwordx4 v6, s[16:19], s41 offen sc1 lds
  s_add_u32 s41, s69, s59
  s_add_u32 m0, s64, 81920
  s_nop 0
  buffer_load_dwordx4 v6, s[16:19], s41 offen sc1 lds
  s_lshr_b32 s32, s20, 1
  s_mul_i32 s32, s32, 14
  v_add_u32 v14, s32, v1
  v_lshlrev_b32 v14, 7, v14
  v_add_u32 v14, 0x1bd0000, v14
  v_mov_b32 v15, s101
  s_cmp_eq_u32 s22, 0
  s_cbranch_scc0 p5_kernel_wd_2
  s_mov_b32 s35, 0
  s_mov_b32 exec_lo, 0x3fff
  s_mov_b32 exec_hi, 0
p5_kernel_wp_3:
  buffer_load_dword v16, v14, s[16:19], 0 offen sc1
  s_waitcnt vmcnt(0)
  v_cmp_eq_u32 vcc, v16, v15
  s_cmp_eq_u64 vcc, exec
  s_cbranch_scc1 p5_kernel_wd_2_ok
  s_sleep 1
  s_add_u32 s35, s35, 1
  s_cmp_lt_u32 s35, 0x100000
  s_cbranch_scc1 p5_kernel_wp_3
p5_kernel_wd_2_ok:
  s_mov_b64 exec, -1
p5_kernel_wd_2:
  s_barrier
  s_add_u32 s43, s48, 0
  s_mul_i32 s32, s43, 2048
  s_add_u32 s32, s32, s40
  buffer_load_dwordx4 v[92:95], v6, s[16:19], s32 offen sc1
  s_add_u32 s43, s48, 3
  s_mul_i32 s32, s43, 2048
  s_add_u32 s32, s32, s40
  buffer_load_dwordx4 v[96:99], v6, s[16:19], s32 offen sc1
  s_add_u32 s43, s48, 1
  s_cmp_ge_u32 s43, 3
  s_cselect_b32 s100, 3, 0
  s_sub_u32 s43, s43, s100
  s_mul_i32 s32, s43, 2048
  s_add_u32 s32, s32, s40
  buffer_load_dwordx4 v[100:103], v6, s[16:19], s32 offen sc1
  s_add_u32 s43, s48, 2
  s_cmp_ge_u32 s43, 3
  s_cselect_b32 s100, 3, 0
  s_sub_u32 s43, s43, s100
  s_mul_i32 s32, s43, 2048
  s_add_u32 s32, s32, s40
  buffer_load_dwordx4 v[104:107], v6, s[16:19], s32 offen sc1
  s_add_u32 s43, s48, 6
  s_mul_i32 s32, s43, 2048
  s_add_u32 s32, s32, s40
  buffer_load_dwordx4 v[108:111], v6, s[16:19], s32 offen sc1
  s_add_u32 s43, s48, 1
  s_cmp_ge_u32 s43, 3
  s_cselect_b32 s100, 3, 0
  s_sub_u32 s43, s43, s100
  s_add_u32 s43, s43, 3
  s_mul_i32 s32, s43, 2048
  s_add_u32 s32, s32, s40
  buffer_load_dwordx4 v[112:115], v6, s[16:19], s32 offen sc1
  s_add_u32 s43, s48, 2
  s_cmp_ge_u32 s43, 3
  s_cselect_b32 s100, 3, 0
  s_sub_u32 s43, s43, s100
  s_add_u32 s43, s43, 3
  s_mul_i32 s32, s43, 2048
  s_add_u32 s32, s32, s40
  buffer_load_dwordx4 v[116:119], v6, s[16:19], s32 offen sc1
  s_add_u32 s43, s48, 9
  s_mul_i32 s32, s43, 2048
  s_add_u32 s32, s32, s40
  buffer_load_dwordx4 v[120:123], v6, s[16:19], s32 offen sc1
  s_mul_i32 s32, s23, 5120
  v_lshl_add_u32 v8, v1, 4, s32
  v_add_u32 v9, 61440, v8
  v_add_u32 v10, 122880, v8
  s_waitcnt vmcnt(4)
  s_barrier
  s_add_u32 s43, s48, 1
  s_cmp_ge_u32 s43, 3
  s_cselect_b32 s100, 3, 0
  s_sub_u32 s43, s43, s100
  s_add_u32 s43, s43, 6
  s_mul_i32 s32, s43, 2048
  s_add_u32 s32, s32, s40
  buffer_load_dwordx4 v[124:127], v6, s[16:19], s32 offen sc1
  s_add_u32 s43, s48, 2
  s_cmp_ge_u32 s43, 3
  s_cselect_b32 s100, 3, 0
  s_sub_u32 s43, s43, s100
  s_add_u32 s43, s43, 6
  s_mul_i32 s32, s43, 2048
  s_add_u32 s32, s32, s40
  buffer_load_dwordx4 v[128:131], v6, s[16:19], s32 offen sc1
  s_add_u32 s43, s48, 12
  s_mul_i32 s32, s43, 2048
  s_add_u32 s32, s32, s40
  buffer_load_dwordx4 v[132:135], v6, s[16:19], s32 offen sc1
  s_add_u32 s43, s48, 1
  s_cmp_ge_u32 s43, 3
  s_cselect_b32 s100, 3, 0
  s_sub_u32 s43, s43, s100
  s_add_u32 s43, s43, 9
  s_mul_i32 s32, s43, 2048
  s_add_u32 s32, s32, s40
  buffer_load_dwordx4 v[136:139], v6, s[16:19], s32 offen sc1
  buffer_load_dword v13, v13, s[16:19], 0 offen sc1
  buffer_load_dwordx2 v[22:23], v11, s[16:19], 0 offen offset:0 sc1
  buffer_load_dwordx2 v[24:25], v11, s[16:19], 0 offen offset:1024 sc1
  buffer_load_dwordx2 v[26:27], v11, s[16:19], 0 offen offset:2048 sc1
  ds_read_b128 v[52:55], v8 offset:0
  ds_read_b128 v[56:59], v8 offset:1024
  ds_read_b128 v[60:63], v8 offset:2048
  ds_read_b128 v[64:67], v8 offset:3072
  ds_read_b128 v[68:71], v8 offset:4096
  ds_read_b128 v[72:75], v8 offset:10240
  ds_read_b128 v[76:79], v8 offset:11264
  ds_read_b128 v[80:83], v8 offset:12288
  ds_read_b128 v[84:87], v8 offset:13312
  ds_read_b128 v[88:91], v8 offset:14336
  s_waitcnt lgkmcnt(9)
  v_mfma_f32_16x16x32_bf16 v[32:35], v[52:55], v[92:95], 0
  s_waitcnt lgkmcnt(8)
  v_mfma_f32_16x16x32_bf16 v[36:39], v[56:59], v[92:95], 0
  s_waitcnt lgkmcnt(7)
  v_mfma_f32_16x16x32_bf16 v[40:43], v[60:63], v[92:95], 0
  s_waitcnt lgkmcnt(6)
  v_mfma_f32_16x16x32_bf16 v[44:47], v[64:67], v[92:95], 0
  s_waitcnt lgkmcnt(5)
  v_mfma_f32_16x16x32_bf16 v[48:51], v[68:71], v[92:95], 0
  s_waitcnt lgkmcnt(4)
  v_mfma_f32_16x16x32_bf16 v[32:35], v[72:75], v[96:99], v[32:35]
  s_waitcnt lgkmcnt(3)
  v_mfma_f32_16x16x32_bf16 v[36:39], v[76:79], v[96:99], v[36:39]
  s_waitcnt lgkmcnt(2)
  v_mfma_f32_16x16x32_bf16 v[40:43], v[80:83], v[96:99], v[40:43]
  s_waitcnt lgkmcnt(1)
  v_mfma_f32_16x16x32_bf16 v[44:47], v[84:87], v[96:99], v[44:47]
  s_waitcnt lgkmcnt(0)
  v_mfma_f32_16x16x32_bf16 v[48:51], v[88:91], v[96:99], v[48:51]
  ds_read_b128 v[52:55], v8 offset:20480
  ds_read_b128 v[56:59], v8 offset:21504
  ds_read_b128 v[60:63], v8 offset:22528
  ds_read_b128 v[64:67], v8 offset:23552
  ds_read_b128 v[68:71], v8 offset:24576
  ds_read_b128 v[72:75], v8 offset:30720
  ds_read_b128 v[76:79], v8 offset:31744
  ds_read_b128 v[80:83], v8 offset:32768
  ds_read_b128 v[84:87], v8 offset:33792
  ds_read_b128 v[88:91], v8 offset:34816
  s_waitcnt lgkmcnt(9)
  v_mfma_f32_16x16x32_bf16 v[32:35], v[52:55], v[100:103], v[32:35]
  s_waitcnt lgkmcnt(8)
  v_mfma_f32_16x16x32_bf16 v[36:39], v[56:59], v[100:103], v[36:39]
  s_waitcnt lgkmcnt(7)
  v_mfma_f32_16x16x32_bf16 v[40:43], v[60:63], v[100:103], v[40:43]
  s_waitcnt lgkmcnt(6)
  v_mfma_f32_16x16x32_bf16 v[44:47], v[64:67], v[100:103], v[44:47]
  s_waitcnt lgkmcnt(5)
  v_mfma_f32_16x16x32_bf16 v[48:51], v[68:71], v[100:103], v[48:51]
  s_waitcnt lgkmcnt(4)
  v_mfma_f32_16x16x32_bf16 v[32:35], v[72:75], v[104:107], v[32:35]
  s_waitcnt lgkmcnt(3)
  v_mfma_f32_16x16x32_bf16 v[36:39], v[76:79], v[104:107], v[36:39]
  s_waitcnt lgkmcnt(2)
  v_mfma_f32_16x16x32_bf16 v[40:43], v[80:83], v[104:107], v[40:43]
  s_waitcnt lgkmcnt(1)
  v_mfma_f32_16x16x32_bf16 v[44:47], v[84:87], v[104:107], v[44:47]
  s_waitcnt lgkmcnt(0)
  v_mfma_f32_16x16x32_bf16 v[48:51], v[88:91], v[104:107], v[48:51]
  s_waitcnt vmcnt(8)
  s_barrier
  s_add_u32 s66, s48, 2
  s_cmp_ge_u32 s66, 3
  s_cselect_b32 s100, 3, 0
  s_sub_u32 s66, s66, s100
  s_add_u32 s66, s66, 9
  s_mul_i32 s66, s66, 10240
  s_add_u32 s67, s48, 15
  s_mul_i32 s67, s67, 10240
  s_add_u32 s68, s48, 1
  s_cmp_ge_u32 s68, 3
  s_cselect_b32 s100, 3, 0
  s_sub_u32 s68, s68, s100
  s_add_u32 s68, s68, 12
  s_mul_i32 s68, s68, 10240
  s_add_u32 s69, s48, 2
  s_cmp_ge_u32 s69, 3
  s_cselect_b32 s100, 3, 0
  s_sub_u32 s69, s69, s100
  s_add_u32 s69, s69, 12
  s_mul_i32 s69, s69, 10240
  s_add_u32 s41, s66, s55
  s_add_u32 m0, s60, 0
  s_nop 0
  buffer_load_dwordx4 v6, s[16:19], s41 offen sc1 lds
  s_cmp_eq_u32 s51, 0
  s_cselect_b32 s41, s66, s67
  s_add_u32 s41, s41, s56
  s_add_u32 m0, s61, 0
  s_nop 0
  buffer_load_dwordx4 v6, s[16:19], s41 offen sc1 lds
  s_cmp_eq_u32 s52, 1
  s_cselect_b32 s41, s67, s68
  s_add_u32 s41, s41, s57
  s_add_u32 m0, s62, 0
  s_nop 0
  buffer_load_dwordx4 v6, s[16:19], s41 offen sc1 lds
  s_cmp_eq_u32 s53, 2
  s_cselect_b32 s41, s68, s69
  s_add_u32 s41, s41, s58
  s_add_u32 m0, s63, 0
  s_nop 0
  buffer_load_dwordx4 v6, s[16:19], s41 offen sc1 lds
  s_add_u32 s41, s69, s59
  s_add_u32 m0, s64, 0
  s_nop 0
  buffer_load_dwordx4 v6, s[16:19], s41 offen sc1 lds
  s_add_u32 s43, s48, 2
  s_cmp_ge_u32 s43, 3
  s_cselect_b32 s100, 3, 0
  s_sub_u32 s43, s43, s100
  s_add_u32 s43, s43, 9
  s_mul_i32 s32, s43, 2048
  s_add_u32 s32, s32, s40
  buffer_load_dwordx4 v[92:95], v6, s[16:19], s32 offen sc1
  s_add_u32 s43, s48, 15
  s_mul_i32 s32, s43, 2048
  s_add_u32 s32, s32, s40
  buffer_load_dwordx4 v[96:99], v6, s[16:19], s32 offen sc1
  s_add_u32 s43, s48, 1
  s_cmp_ge_u32 s43, 3
  s_cselect_b32 s100, 3, 0
  s_sub_u32 s43, s43, s100
  s_add_u32 s43, s43, 12
  s_mul_i32 s32, s43, 2048
  s_add_u32 s32, s32, s40
  buffer_load_dwordx4 v[100:103], v6, s[16:19], s32 offen sc1
  s_add_u32 s43, s48, 2
  s_cmp_ge_u32 s43, 3
  s_cselect_b32 s100, 3, 0
  s_sub_u32 s43, s43, s100
  s_add_u32 s43, s43, 12
  s_mul_i32 s32, s43, 2048
  s_add_u32 s32, s32, s40
  buffer_load_dwordx4 v[104:107], v6, s[16:19], s32 offen sc1
  ds_read_b128 v[52:55], v8 offset:40960
  ds_read_b128 v[56:59], v8 offset:41984
  ds_read_b128 v[60:63], v8 offset:43008
  ds_read_b128 v[64:67], v8 offset:44032
  ds_read_b128 v[68:71], v8 offset:45056
  ds_read_b128 v[72:75], v8 offset:51200
  ds_read_b128 v[76:79], v8 offset:52224
  ds_read_b128 v[80:83], v8 offset:53248
  ds_read_b128 v[84:87], v8 offset:54272
  ds_read_b128 v[88:91], v8 offset:55296
  s_waitcnt lgkmcnt(9)
  v_mfma_f32_16x16x32_bf16 v[32:35], v[52:55], v[108:111], v[32:35]
  s_waitcnt lgkmcnt(8)
  v_mfma_f32_16x16x32_bf16 v[36:39], v[56:59], v[108:111], v[36:39]
  s_waitcnt lgkmcnt(7)
  v_mfma_f32_16x16x32_bf16 v[40:43], v[60:63], v[108:111], v[40:43]
  s_waitcnt lgkmcnt(6)
  v_mfma_f32_16x16x32_bf16 v[44:47], v[64:67], v[108:111], v[44:47]
  s_waitcnt lgkmcnt(5)
  v_mfma_f32_16x16x32_bf16 v[48:51], v[68:71], v[108:111], v[48:51]
  s_waitcnt lgkmcnt(4)
  v_mfma_f32_16x16x32_bf16 v[32:35], v[72:75], v[112:115], v[32:35]
  s_waitcnt lgkmcnt(3)
  v_mfma_f32_16x16x32_bf16 v[36:39], v[76:79], v[112:115], v[36:39]
  s_waitcnt lgkmcnt(2)
  v_mfma_f32_16x16x32_bf16 v[40:43], v[80:83], v[112:115], v[40:43]
  s_waitcnt lgkmcnt(1)
  v_mfma_f32_16x16x32_bf16 v[44:47], v[84:87], v[112:115], v[44:47]
  s_waitcnt lgkmcnt(0)
  v_mfma_f32_16x16x32_bf16 v[48:51], v[88:91], v[112:115], v[48:51]
  ds_read_b128 v[52:55], v9 offset:0
  ds_read_b128 v[56:59], v9 offset:1024
  ds_read_b128 v[60:63], v9 offset:2048
  ds_read_b128 v[64:67], v9 offset:3072
  ds_read_b128 v[68:71], v9 offset:4096
  ds_read_b128 v[72:75], v9 offset:10240
  ds_read_b128 v[76:79], v9 offset:11264
  ds_read_b128 v[80:83], v9 offset:12288
  ds_read_b128 v[84:87], v9 offset:13312
  ds_read_b128 v[88:91], v9 offset:14336
  s_waitcnt lgkmcnt(9)
  v_mfma_f32_16x16x32_bf16 v[32:35], v[52:55], v[116:119], v[32:35]
  s_waitcnt lgkmcnt(8)
  v_mfma_f32_16x16x32_bf16 v[36:39], v[56:59], v[116:119], v[36:39]
  s_waitcnt lgkmcnt(7)
  v_mfma_f32_16x16x32_bf16 v[40:43], v[60:63], v[116:119], v[40:43]
  s_waitcnt lgkmcnt(6)
  v_mfma_f32_16x16x32_bf16 v[44:47], v[64:67], v[116:119], v[44:47]
  s_waitcnt lgkmcnt(5)
  v_mfma_f32_16x16x32_bf16 v[48:51], v[68:71], v[116:119], v[48:51]
  s_waitcnt lgkmcnt(4)
  v_mfma_f32_16x16x32_bf16 v[32:35], v[72:75], v[120:123], v[32:35]
  s_waitcnt lgkmcnt(3)
  v_mfma_f32_16x16x32_bf16 v[36:39], v[76:79], v[120:123], v[36:39]
  s_waitcnt lgkmcnt(2)
  v_mfma_f32_16x16x32_bf16 v[40:43], v[80:83], v[120:123], v[40:43]
  s_waitcnt lgkmcnt(1)
  v_mfma_f32_16x16x32_bf16 v[44:47], v[84:87], v[120:123], v[44:47]
  s_waitcnt lgkmcnt(0)
  v_mfma_f32_16x16x32_bf16 v[48:51], v[88:91], v[120:123], v[48:51]
  s_waitcnt vmcnt(13)
  s_barrier
  s_add_u32 s66, s48, 18
  s_mul_i32 s66, s66, 10240
  s_add_u32 s67, s48, 1
  s_cmp_ge_u32 s67, 3
  s_cselect_b32 s100, 3, 0
  s_sub_u32 s67, s67, s100
  s_add_u32 s67, s67, 15
  s_mul_i32 s67, s67, 10240
  s_add_u32 s68, s48, 2
  s_cmp_ge_u32 s68, 3
  s_cselect_b32 s100, 3, 0
  s_sub_u32 s68, s68, s100
  s_add_u32 s68, s68, 15
  s_mul_i32 s68, s68, 10240
  s_add_u32 s69, s48, 21
  s_mul_i32 s69, s69, 10240
  s_add_u32 s41, s66, s55
  s_add_u32 m0, s60, 40960
  s_nop 0
  buffer_load_dwordx4 v6, s[16:19], s41 offen sc1 lds
  s_cmp_eq_u32 s51, 0
  s_cselect_b32 s41, s66, s67
  s_add_u32 s41, s41, s56
  s_add_u32 m0, s61, 40960
  s_nop 0
  buffer_load_dwordx4 v6, s[16:19], s41 offen sc1 lds
  s_cmp_eq_u32 s52, 1
  s_cselect_b32 s41, s67, s68
  s_add_u32 s41, s41, s57
  s_add_u32 m0, s62, 40960
  s_nop 0
  buffer_load_dwordx4 v6, s[16:19], s41 offen sc1 lds
  s_cmp_eq_u32 s53, 2
  s_cselect_b32 s41, s68, s69
  s_add_u32 s41, s41, s58
  s_add_u32 m0, s63, 40960
  s_nop 0
  buffer_load_dwordx4 v6, s[16:19], s41 offen sc1 lds
  s_add_u32 s41, s69, s59
  s_add_u32 m0, s64, 40960
  s_nop 0
  buffer_load_dwordx4 v6, s[16:19], s41 offen sc1 lds
  s_add_u32 s43, s48, 18
  s_mul_i32 s32, s43, 2048
  s_add_u32 s32, s32, s40
  buffer_load_dwordx4 v[108:111], v6, s[16:19], s32 offen sc1
  s_add_u32 s43, s48, 1
  s_cmp_ge_u32 s43, 3
  s_cselect_b32 s100, 3, 0
  s_sub_u32 s43, s43, s100
  s_add_u32 s43, s43, 15
  s_mul_i32 s32, s43, 2048
  s_add_u32 s32, s32, s40
  buffer_load_dwordx4 v[112:115], v6, s[16:19], s32 offen sc1
  s_add_u32 s43, s48, 2
  s_cmp_ge_u32 s43, 3
  s_cselect_b32 s100, 3, 0
  s_sub_u32 s43, s43, s100
  s_add_u32 s43, s43, 15
  s_mul_i32 s32, s43, 2048
  s_add_u32 s32, s32, s40
  buffer_load_dwordx4 v[116:119], v6, s[16:19], s32 offen sc1
  s_add_u32 s43, s48, 21
  s_mul_i32 s32, s43, 2048
  s_add_u32 s32, s32, s40
  buffer_load_dwordx4 v[120:123], v6, s[16:19], s32 offen sc1
  ds_read_b128 v[52:55], v9 offset:20480
  ds_read_b128 v[56:59], v9 offset:21504
  ds_read_b128 v[60:63], v9 offset:22528
  ds_read_b128 v[64:67], v9 offset:23552
  ds_read_b128 v[68:71], v9 offset:24576
  ds_read_b128 v[72:75], v9 offset:30720
  ds_read_b128 v[76:79], v9 offset:31744
  ds_read_b128 v[80:83], v9 offset:32768
  ds_read_b128 v[84:87], v9 offset:33792
  ds_read_b128 v[88:91], v9 offset:34816
  s_waitcnt lgkmcnt(9)
  v_mfma_f32_16x16x32_bf16 v[32:35], v[52:55], v[124:127], v[32:35]
  s_waitcnt lgkmcnt(8)
  v_mfma_f32_16x16x32_bf16 v[36:39], v[56:59], v[124:127], v[36:39]
  s_waitcnt lgkmcnt(7)
  v_mfma_f32_16x16x32_bf16 v[40:43], v[60:63], v[124:127], v[40:43]
  s_waitcnt lgkmcnt(6)
  v_mfma_f32_16x16x32_bf16 v[44:47], v[64:67], v[124:127], v[44:47]
  s_waitcnt lgkmcnt(5)
  v_mfma_f32_16x16x32_bf16 v[48:51], v[68:71], v[124:127], v[48:51]
  s_waitcnt lgkmcnt(4)
  v_mfma_f32_16x16x32_bf16 v[32:35], v[72:75], v[128:131], v[32:35]
  s_waitcnt lgkmcnt(3)
  v_mfma_f32_16x16x32_bf16 v[36:39], v[76:79], v[128:131], v[36:39]
  s_waitcnt lgkmcnt(2)
  v_mfma_f32_16x16x32_bf16 v[40:43], v[80:83], v[128:131], v[40:43]
  s_waitcnt lgkmcnt(1)
  v_mfma_f32_16x16x32_bf16 v[44:47], v[84:87], v[128:131], v[44:47]
  s_waitcnt lgkmcnt(0)
  v_mfma_f32_16x16x32_bf16 v[48:51], v[88:91], v[128:131], v[48:51]
  ds_read_b128 v[52:55], v9 offset:40960
  ds_read_b128 v[56:59], v9 offset:41984
  ds_read_b128 v[60:63], v9 offset:43008
  ds_read_b128 v[64:67], v9 offset:44032
  ds_read_b128 v[68:71], v9 offset:45056
  ds_read_b128 v[72:75], v9 offset:51200
  ds_read_b128 v[76:79], v9 offset:52224
  ds_read_b128 v[80:83], v9 offset:53248
  ds_read_b128 v[84:87], v9 offset:54272
  ds_read_b128 v[88:91], v9 offset:55296
  s_waitcnt lgkmcnt(9)
  v_mfma_f32_16x16x32_bf16 v[32:35], v[52:55], v[132:135], v[32:35]
  s_waitcnt lgkmcnt(8)
  v_mfma_f32_16x16x32_bf16 v[36:39], v[56:59], v[132:135], v[36:39]
  s_waitcnt lgkmcnt(7)
  v_mfma_f32_16x16x32_bf16 v[40:43], v[60:63], v[132:135], v[40:43]
  s_waitcnt lgkmcnt(6)
  v_mfma_f32_16x16x32_bf16 v[44:47], v[64:67], v[132:135], v[44:47]
  s_waitcnt lgkmcnt(5)
  v_mfma_f32_16x16x32_bf16 v[48:51], v[68:71], v[132:135], v[48:51]
  s_waitcnt lgkmcnt(4)
  v_mfma_f32_16x16x32_bf16 v[32:35], v[72:75], v[136:139], v[32:35]
  s_waitcnt lgkmcnt(3)
  v_mfma_f32_16x16x32_bf16 v[36:39], v[76:79], v[136:139], v[36:39]
  s_waitcnt lgkmcnt(2)
  v_mfma_f32_16x16x32_bf16 v[40:43], v[80:83], v[136:139], v[40:43]
  s_waitcnt lgkmcnt(1)
  v_mfma_f32_16x16x32_bf16 v[44:47], v[84:87], v[136:139], v[44:47]
  s_waitcnt lgkmcnt(0)
  v_mfma_f32_16x16x32_bf16 v[48:51], v[88:91], v[136:139], v[48:51]
  s_waitcnt vmcnt(9)
  s_barrier
  s_add_u32 s66, s48, 1
  s_cmp_ge_u32 s66, 3
  s_cselect_b32 s100, 3, 0
  s_sub_u32 s66, s66, s100
  s_add_u32 s66, s66, 18
  s_mul_i32 s66, s66, 10240
  s_add_u32 s67, s48, 2
  s_cmp_ge_u32 s67, 3
  s_cselect_b32 s100, 3, 0
  s_sub_u32 s67, s67, s100
  s_add_u32 s67, s67, 18
  s_mul_i32 s67, s67, 10240
  s_add_u32 s68, s48, 24
  s_mul_i32 s68, s68, 10240
  s_add_u32 s69, s48, 1
  s_cmp_ge_u32 s69, 3
  s_cselect_b32 s100, 3, 0
  s_sub_u32 s69, s69, s100
  s_add_u32 s69, s69, 21
  s_mul_i32 s69, s69, 10240
  s_add_u32 s41, s66, s55
  s_add_u32 m0, s60, 81920
  s_nop 0
  buffer_load_dwordx4 v6, s[16:19], s41 offen sc1 lds
  s_cmp_eq_u32 s51, 0
  s_cselect_b32 s41, s66, s67
  s_add_u32 s41, s41, s56
  s_add_u32 m0, s61, 81920
  s_nop 0
  buffer_load_dwordx4 v6, s[16:19], s41 offen sc1 lds
  s_cmp_eq_u32 s52, 1
  s_cselect_b32 s41, s67, s68
  s_add_u32 s41, s41, s57
  s_add_u32 m0, s62, 81920
  s_nop 0
  buffer_load_dwordx4 v6, s[16:19], s41 offen sc1 lds
  s_cmp_eq_u32 s53, 2
  s_cselect_b32 s41, s68, s69
  s_add_u32 s41, s41, s58
  s_add_u32 m0, s63, 81920
  s_nop 0
  buffer_load_dwordx4 v6, s[16:19], s41 offen sc1 lds
  s_add_u32 s41, s69, s59
  s_add_u32 m0, s64, 81920
  s_nop 0
  buffer_load_dwordx4 v6, s[16:19], s41 offen sc1 lds
  s_add_u32 s43, s48, 1
  s_cmp_ge_u32 s43, 3
  s_cselect_b32 s100, 3, 0
  s_sub_u32 s43, s43, s100
  s_add_u32 s43, s43, 18
  s_mul_i32 s32, s43, 2048
  s_add_u32 s32, s32, s40
  buffer_load_dwordx4 v[124:127], v6, s[16:19], s32 offen sc1
  s_add_u32 s43, s48, 2
  s_cmp_ge_u32 s43, 3
  s_cselect_b32 s100, 3, 0
  s_sub_u32 s43, s43, s100
  s_add_u32 s43, s43, 18
  s_mul_i32 s32, s43, 2048
  s_add_u32 s32, s32, s40
  buffer_load_dwordx4 v[128:131], v6, s[16:19], s32 offen sc1
  s_add_u32 s43, s48, 24
  s_mul_i32 s32, s43, 2048
  s_add_u32 s32, s32, s40
  buffer_load_dwordx4 v[132:135], v6, s[16:19], s32 offen sc1
  s_add_u32 s43, s48, 1
  s_cmp_ge_u32 s43, 3
  s_cselect_b32 s100, 3, 0
  s_sub_u32 s43, s43, s100
  s_add_u32 s43, s43, 21
  s_mul_i32 s32, s43, 2048
  s_add_u32 s32, s32, s40
  buffer_load_dwordx4 v[136:139], v6, s[16:19], s32 offen sc1
  ds_read_b128 v[52:55], v8 offset:0
  ds_read_b128 v[56:59], v8 offset:1024
  ds_read_b128 v[60:63], v8 offset:2048
  ds_read_b128 v[64:67], v8 offset:3072
  ds_read_b128 v[68:71], v8 offset:4096
  ds_read_b128 v[72:75], v8 offset:10240
  ds_read_b128 v[76:79], v8 offset:11264
  ds_read_b128 v[80:83], v8 offset:12288
  ds_read_b128 v[84:87], v8 offset:13312
  ds_read_b128 v[88:91], v8 offset:14336
  s_waitcnt lgkmcnt(9)
  v_mfma_f32_16x16x32_bf16 v[32:35], v[52:55], v[92:95], v[32:35]
  s_waitcnt lgkmcnt(8)
  v_mfma_f32_16x16x32_bf16 v[36:39], v[56:59], v[92:95], v[36:39]
  s_waitcnt lgkmcnt(7)
  v_mfma_f32_16x16x32_bf16 v[40:43], v[60:63], v[92:95], v[40:43]
  s_waitcnt lgkmcnt(6)
  v_mfma_f32_16x16x32_bf16 v[44:47], v[64:67], v[92:95], v[44:47]
  s_waitcnt lgkmcnt(5)
  v_mfma_f32_16x16x32_bf16 v[48:51], v[68:71], v[92:95], v[48:51]
  s_waitcnt lgkmcnt(4)
  v_mfma_f32_16x16x32_bf16 v[32:35], v[72:75], v[96:99], v[32:35]
  s_waitcnt lgkmcnt(3)
  v_mfma_f32_16x16x32_bf16 v[36:39], v[76:79], v[96:99], v[36:39]
  s_waitcnt lgkmcnt(2)
  v_mfma_f32_16x16x32_bf16 v[40:43], v[80:83], v[96:99], v[40:43]
  s_waitcnt lgkmcnt(1)
  v_mfma_f32_16x16x32_bf16 v[44:47], v[84:87], v[96:99], v[44:47]
  s_waitcnt lgkmcnt(0)
  v_mfma_f32_16x16x32_bf16 v[48:51], v[88:91], v[96:99], v[48:51]
  ds_read_b128 v[52:55], v8 offset:20480
  ds_read_b128 v[56:59], v8 offset:21504
  ds_read_b128 v[60:63], v8 offset:22528
  ds_read_b128 v[64:67], v8 offset:23552
  ds_read_b128 v[68:71], v8 offset:24576
  ds_read_b128 v[72:75], v8 offset:30720
  ds_read_b128 v[76:79], v8 offset:31744
  ds_read_b128 v[80:83], v8 offset:32768
  ds_read_b128 v[84:87], v8 offset:33792
  ds_read_b128 v[88:91], v8 offset:34816
  s_waitcnt lgkmcnt(9)
  v_mfma_f32_16x16x32_bf16 v[32:35], v[52:55], v[100:103], v[32:35]
  s_waitcnt lgkmcnt(8)
  v_mfma_f32_16x16x32_bf16 v[36:39], v[56:59], v[100:103], v[36:39]
  s_waitcnt lgkmcnt(7)
  v_mfma_f32_16x16x32_bf16 v[40:43], v[60:63], v[100:103], v[40:43]
  s_waitcnt lgkmcnt(6)
  v_mfma_f32_16x16x32_bf16 v[44:47], v[64:67], v[100:103], v[44:47]
  s_waitcnt lgkmcnt(5)
  v_mfma_f32_16x16x32_bf16 v[48:51], v[68:71], v[100:103], v[48:51]
  s_waitcnt lgkmcnt(4)
  v_mfma_f32_16x16x32_bf16 v[32:35], v[72:75], v[104:107], v[32:35]
  s_waitcnt lgkmcnt(3)
  v_mfma_f32_16x16x32_bf16 v[36:39], v[76:79], v[104:107], v[36:39]
  s_waitcnt lgkmcnt(2)
  v_mfma_f32_16x16x32_bf16 v[40:43], v[80:83], v[104:107], v[40:43]
  s_waitcnt lgkmcnt(1)
  v_mfma_f32_16x16x32_bf16 v[44:47], v[84:87], v[104:107], v[44:47]
  s_waitcnt lgkmcnt(0)
  v_mfma_f32_16x16x32_bf16 v[48:51], v[88:91], v[104:107], v[48:51]
  s_waitcnt vmcnt(9)
  s_barrier
  s_add_u32 s66, s48, 2
  s_cmp_ge_u32 s66, 3
  s_cselect_b32 s100, 3, 0
  s_sub_u32 s66, s66, s100
  s_add_u32 s66, s66, 21
  s_mul_i32 s66, s66, 10240
  s_add_u32 s67, s48, 1
  s_cmp_ge_u32 s67, 3
  s_cselect_b32 s100, 3, 0
  s_sub_u32 s67, s67, s100
  s_add_u32 s67, s67, 24
  s_mul_i32 s67, s67, 10240
  s_add_u32 s68, s48, 2
  s_cmp_ge_u32 s68, 3
  s_cselect_b32 s100, 3, 0
  s_sub_u32 s68, s68, s100
  s_add_u32 s68, s68, 24
  s_mul_i32 s68, s68, 10240
  s_add_u32 s41, s66, s55
  s_add_u32 m0, s60, 0
  s_nop 0
  buffer_load_dwordx4 v6, s[16:19], s41 offen sc1 lds
  s_cmp_eq_u32 s51, 0
  s_cselect_b32 s41, s66, s67
  s_add_u32 s41, s41, s56
  s_add_u32 m0, s61, 0
  s_nop 0
  buffer_load_dwordx4 v6, s[16:19], s41 offen sc1 lds
  s_cmp_eq_u32 s52, 1
  s_cselect_b32 s41, s67, s68
  s_add_u32 s41, s41, s57
  s_add_u32 m0, s62, 0
  s_nop 0
  buffer_load_dwordx4 v6, s[16:19], s41 offen sc1 lds
  s_cmp_ge_u32 s53, 3
  s_cbranch_scc1 p5_kernel_wgs_4
  s_cmp_eq_u32 s53, 2
  s_cselect_b32 s41, s68, s68
  s_add_u32 s41, s41, s58
  s_add_u32 m0, s63, 0
  s_nop 0
  buffer_load_dwordx4 v6, s[16:19], s41 offen sc1 lds
p5_kernel_wgs_4:
  s_add_u32 s43, s48, 2
  s_cmp_ge_u32 s43, 3
  s_cselect_b32 s100, 3, 0
  s_sub_u32 s43, s43, s100
  s_add_u32 s43, s43, 21
  s_mul_i32 s32, s43, 2048
  s_add_u32 s32, s32, s40
  buffer_load_dwordx4 v[92:95], v6, s[16:19], s32 offen sc1
  s_add_u32 s43, s48, 1
  s_cmp_ge_u32 s43, 3
  s_cselect_b32 s100, 3, 0
  s_sub_u32 s43, s43, s100
  s_add_u32 s43, s43, 24
  s_mul_i32 s32, s43, 2048
  s_add_u32 s32, s32, s40
  buffer_load_dwordx4 v[96:99], v6, s[16:19], s32 offen sc1
  s_add_u32 s43, s48, 2
  s_cmp_ge_u32 s43, 3
  s_cselect_b32 s100, 3, 0
  s_sub_u32 s43, s43, s100
  s_add_u32 s43, s43, 24
  s_mul_i32 s32, s43, 2048
  s_add_u32 s32, s32, s40
  buffer_load_dwordx4 v[100:103], v6, s[16:19], s32 offen sc1
  ds_read_b128 v[52:55], v8 offset:40960
  ds_read_b128 v[56:59], v8 offset:41984
  ds_read_b128 v[60:63], v8 offset:43008
  ds_read_b128 v[64:67], v8 offset:44032
  ds_read_b128 v[68:71], v8 offset:45056
  ds_read_b128 v[72:75], v8 offset:51200
  ds_read_b128 v[76:79], v8 offset:52224
  ds_read_b128 v[80:83], v8 offset:53248
  ds_read_b128 v[84:87], v8 offset:54272
  ds_read_b128 v[88:91], v8 offset:55296
  s_waitcnt lgkmcnt(9)
  v_mfma_f32_16x16x32_bf16 v[32:35], v[52:55], v[108:111], v[32:35]
  s_waitcnt lgkmcnt(8)
  v_mfma_f32_16x16x32_bf16 v[36:39], v[56:59], v[108:111], v[36:39]
  s_waitcnt lgkmcnt(7)
  v_mfma_f32_16x16x32_bf16 v[40:43], v[60:63], v[108:111], v[40:43]
  s_waitcnt lgkmcnt(6)
  v_mfma_f32_16x16x32_bf16 v[44:47], v[64:67], v[108:111], v[44:47]
  s_waitcnt lgkmcnt(5)
  v_mfma_f32_16x16x32_bf16 v[48:51], v[68:71], v[108:111], v[48:51]
  s_waitcnt lgkmcnt(4)
  v_mfma_f32_16x16x32_bf16 v[32:35], v[72:75], v[112:115], v[32:35]
  s_waitcnt lgkmcnt(3)
  v_mfma_f32_16x16x32_bf16 v[36:39], v[76:79], v[112:115], v[36:39]
  s_waitcnt lgkmcnt(2)
  v_mfma_f32_16x16x32_bf16 v[40:43], v[80:83], v[112:115], v[40:43]
  s_waitcnt lgkmcnt(1)
  v_mfma_f32_16x16x32_bf16 v[44:47], v[84:87], v[112:115], v[44:47]
  s_waitcnt lgkmcnt(0)
  v_mfma_f32_16x16x32_bf16 v[48:51], v[88:91], v[112:115], v[48:51]
  ds_read_b128 v[52:55], v9 offset:0
  ds_read_b128 v[56:59], v9 offset:1024
  ds_read_b128 v[60:63], v9 offset:2048
  ds_read_b128 v[64:67], v9 offset:3072
  ds_read_b128 v[68:71], v9 offset:4096
  ds_read_b128 v[72:75], v9 offset:10240
  ds_read_b128 v[76:79], v9 offset:11264
  ds_read_b128 v[80:83], v9 offset:12288
  ds_read_b128 v[84:87], v9 offset:13312
  ds_read_b128 v[88:91], v9 offset:14336
  s_waitcnt lgkmcnt(9)
  v_mfma_f32_16x16x32_bf16 v[32:35], v[52:55], v[116:119], v[32:35]
  s_waitcnt lgkmcnt(8)
  v_mfma_f32_16x16x32_bf16 v[36:39], v[56:59], v[116:119], v[36:39]
  s_waitcnt lgkmcnt(7)
  v_mfma_f32_16x16x32_bf16 v[40:43], v[60:63], v[116:119], v[40:43]
  s_waitcnt lgkmcnt(6)
  v_mfma_f32_16x16x32_bf16 v[44:47], v[64:67], v[116:119], v[44:47]
  s_waitcnt lgkmcnt(5)
  v_mfma_f32_16x16x32_bf16 v[48:51], v[68:71], v[116:119], v[48:51]
  s_waitcnt lgkmcnt(4)
  v_mfma_f32_16x16x32_bf16 v[32:35], v[72:75], v[120:123], v[32:35]
  s_waitcnt lgkmcnt(3)
  v_mfma_f32_16x16x32_bf16 v[36:39], v[76:79], v[120:123], v[36:39]
  s_waitcnt lgkmcnt(2)
  v_mfma_f32_16x16x32_bf16 v[40:43], v[80:83], v[120:123], v[40:43]
  s_waitcnt lgkmcnt(1)
  v_mfma_f32_16x16x32_bf16 v[44:47], v[84:87], v[120:123], v[44:47]
  s_waitcnt lgkmcnt(0)
  v_mfma_f32_16x16x32_bf16 v[48:51], v[88:91], v[120:123], v[48:51]
  s_waitcnt vmcnt(6)
  s_barrier
  ds_read_b128 v[52:55], v9 offset:20480
  ds_read_b128 v[56:59], v9 offset:21504
  ds_read_b128 v[60:63], v9 offset:22528
  ds_read_b128 v[64:67], v9 offset:23552
  ds_read_b128 v[68:71], v9 offset:24576
  ds_read_b128 v[72:75], v9 offset:30720
  ds_read_b128 v[76:79], v9 offset:31744
  ds_read_b128 v[80:83], v9 offset:32768
  ds_read_b128 v[84:87], v9 offset:33792
  ds_read_b128 v[88:91], v9 offset:34816
  s_waitcnt lgkmcnt(9)
  v_mfma_f32_16x16x32_bf16 v[32:35], v[52:55], v[124:127], v[32:35]
  s_waitcnt lgkmcnt(8)
  v_mfma_f32_16x16x32_bf16 v[36:39], v[56:59], v[124:127], v[36:39]
  s_waitcnt lgkmcnt(7)
  v_mfma_f32_16x16x32_bf16 v[40:43], v[60:63], v[124:127], v[40:43]
  s_waitcnt lgkmcnt(6)
  v_mfma_f32_16x16x32_bf16 v[44:47], v[64:67], v[124:127], v[44:47]
  s_waitcnt lgkmcnt(5)
  v_mfma_f32_16x16x32_bf16 v[48:51], v[68:71], v[124:127], v[48:51]
  s_waitcnt lgkmcnt(4)
  v_mfma_f32_16x16x32_bf16 v[32:35], v[72:75], v[128:131], v[32:35]
  s_waitcnt lgkmcnt(3)
  v_mfma_f32_16x16x32_bf16 v[36:39], v[76:79], v[128:131], v[36:39]
  s_waitcnt lgkmcnt(2)
  v_mfma_f32_16x16x32_bf16 v[40:43], v[80:83], v[128:131], v[40:43]
  s_waitcnt lgkmcnt(1)
  v_mfma_f32_16x16x32_bf16 v[44:47], v[84:87], v[128:131], v[44:47]
  s_waitcnt lgkmcnt(0)
  v_mfma_f32_16x16x32_bf16 v[48:51], v[88:91], v[128:131], v[48:51]
  ds_read_b128 v[52:55], v9 offset:40960
  ds_read_b128 v[56:59], v9 offset:41984
  ds_read_b128 v[60:63], v9 offset:43008
  ds_read_b128 v[64:67], v9 offset:44032
  ds_read_b128 v[68:71], v9 offset:45056
  ds_read_b128 v[72:75], v9 offset:51200
  ds_read_b128 v[76:79], v9 offset:52224
  ds_read_b128 v[80:83], v9 offset:53248
  ds_read_b128 v[84:87], v9 offset:54272
  ds_read_b128 v[88:91], v9 offset:55296
  s_waitcnt lgkmcnt(9)
  v_mfma_f32_16x16x32_bf16 v[32:35], v[52:55], v[132:135], v[32:35]
  s_waitcnt lgkmcnt(8)
  v_mfma_f32_16x16x32_bf16 v[36:39], v[56:59], v[132:135], v[36:39]
  s_waitcnt lgkmcnt(7)
  v_mfma_f32_16x16x32_bf16 v[40:43], v[60:63], v[132:135], v[40:43]
  s_waitcnt lgkmcnt(6)
  v_mfma_f32_16x16x32_bf16 v[44:47], v[64:67], v[132:135], v[44:47]
  s_waitcnt lgkmcnt(5)
  v_mfma_f32_16x16x32_bf16 v[48:51], v[68:71], v[132:135], v[48:51]
  s_waitcnt lgkmcnt(4)
  v_mfma_f32_16x16x32_bf16 v[32:35], v[72:75], v[136:139], v[32:35]
  s_waitcnt lgkmcnt(3)
  v_mfma_f32_16x16x32_bf16 v[36:39], v[76:79], v[136:139], v[36:39]
  s_waitcnt lgkmcnt(2)
  v_mfma_f32_16x16x32_bf16 v[40:43], v[80:83], v[136:139], v[40:43]
  s_waitcnt lgkmcnt(1)
  v_mfma_f32_16x16x32_bf16 v[44:47], v[84:87], v[136:139], v[44:47]
  s_waitcnt lgkmcnt(0)
  v_mfma_f32_16x16x32_bf16 v[48:51], v[88:91], v[136:139], v[48:51]
  s_waitcnt vmcnt(0)
  s_barrier
  ds_read_b128 v[52:55], v8 offset:0
  ds_read_b128 v[56:59], v8 offset:1024
  ds_read_b128 v[60:63], v8 offset:2048
  ds_read_b128 v[64:67], v8 offset:3072
  ds_read_b128 v[68:71], v8 offset:4096
  ds_read_b128 v[72:75], v8 offset:10240
  ds_read_b128 v[76:79], v8 offset:11264
  ds_read_b128 v[80:83], v8 offset:12288
  ds_read_b128 v[84:87], v8 offset:13312
  ds_read_b128 v[88:91], v8 offset:14336
  s_waitcnt lgkmcnt(9)
  v_mfma_f32_16x16x32_bf16 v[32:35], v[52:55], v[92:95], v[32:35]
  s_waitcnt lgkmcnt(8)
  v_mfma_f32_16x16x32_bf16 v[36:39], v[56:59], v[92:95], v[36:39]
  s_waitcnt lgkmcnt(7)
  v_mfma_f32_16x16x32_bf16 v[40:43], v[60:63], v[92:95], v[40:43]
  s_waitcnt lgkmcnt(6)
  v_mfma_f32_16x16x32_bf16 v[44:47], v[64:67], v[92:95], v[44:47]
  s_waitcnt lgkmcnt(5)
  v_mfma_f32_16x16x32_bf16 v[48:51], v[68:71], v[92:95], v[48:51]
  s_waitcnt lgkmcnt(4)
  v_mfma_f32_16x16x32_bf16 v[32:35], v[72:75], v[96:99], v[32:35]
  s_waitcnt lgkmcnt(3)
  v_mfma_f32_16x16x32_bf16 v[36:39], v[76:79], v[96:99], v[36:39]
  s_waitcnt lgkmcnt(2)
  v_mfma_f32_16x16x32_bf16 v[40:43], v[80:83], v[96:99], v[40:43]
  s_waitcnt lgkmcnt(1)
  v_mfma_f32_16x16x32_bf16 v[44:47], v[84:87], v[96:99], v[44:47]
  s_waitcnt lgkmcnt(0)
  v_mfma_f32_16x16x32_bf16 v[48:51], v[88:91], v[96:99], v[48:51]
  ds_read_b128 v[52:55], v8 offset:20480
  ds_read_b128 v[56:59], v8 offset:21504
  ds_read_b128 v[60:63], v8 offset:22528
  ds_read_b128 v[64:67], v8 offset:23552
  ds_read_b128 v[68:71], v8 offset:24576
  s_waitcnt lgkmcnt(4)
  v_mfma_f32_16x16x32_bf16 v[32:35], v[52:55], v[100:103], v[32:35]
  s_waitcnt lgkmcnt(3)
  v_mfma_f32_16x16x32_bf16 v[36:39], v[56:59], v[100:103], v[36:39]
  s_waitcnt lgkmcnt(2)
  v_mfma_f32_16x16x32_bf16 v[40:43], v[60:63], v[100:103], v[40:43]
  s_waitcnt lgkmcnt(1)
  v_mfma_f32_16x16x32_bf16 v[44:47], v[64:67], v[100:103], v[44:47]
  s_waitcnt lgkmcnt(0)
  v_mfma_f32_16x16x32_bf16 v[48:51], v[68:71], v[100:103], v[48:51]
  s_barrier
  s_and_b32 s32, s22, 3
  s_mul_i32 s32, s32, 5120
  v_lshl_add_u32 v14, v1, 4, s32
  s_nop 4
  s_cmp_eq_u32 s23, 0
  s_cbranch_scc0 p5_kernel_k1_5
  ds_write_b128 v14, v[44:47] offset:3072
  ds_write_b128 v14, v[48:51] offset:4096
  s_branch p5_kernel_k2_6
p5_kernel_k1_5:
  ds_write_b128 v14, v[32:35] offset:0
  ds_write_b128 v14, v[36:39] offset:1024
  ds_write_b128 v14, v[40:43] offset:2048
  v_mov_b32 v32, v44
  v_mov_b32 v36, v48
  v_mov_b32 v33, v45
  v_mov_b32 v37, v49
  v_mov_b32 v34, v46
  v_mov_b32 v38, v50
  v_mov_b32 v35, v47
  v_mov_b32 v39, v51
  v_add_u32 v14, 3072, v14
p5_kernel_k2_6:
  s_waitcnt lgkmcnt(0)
  s_barrier
  ds_read_b128 v[52:55], v14 offset:0
  ds_read_b128 v[56:59], v14 offset:1024
  ds_read_b128 v[60:63], v14 offset:2048
  s_waitcnt lgkmcnt(0) vmcnt(0)
  v_add_f32 v32, v32, v52
  v_add_f32 v33, v33, v53
  v_add_f32 v34, v34, v54
  v_add_f32 v35, v35, v55
  v_lshlrev_b32 v16, 16, v22
  v_and_b32 v17, 0xffff0000, v22
  v_lshlrev_b32 v18, 16, v23
  v_and_b32 v19, 0xffff0000, v23
  v_fma_f32 v32, v32, v13, v16
  v_fma_f32 v33, v33, v13, v17
  v_fma_f32 v34, v34, v13, v18
  v_fma_f32 v35, v35, v13, v19
  v_cvt_pk_bf16_f32 v32, v32, v33
  v_cvt_pk_bf16_f32 v33, v34, v35
  buffer_store_dwordx2 v[32:33], v12, s[12:15], 0 offen offset:0
  v_add_f32 v36, v36, v56
  v_add_f32 v37, v37, v57
  v_add_f32 v38, v38, v58
  v_add_f32 v39, v39, v59
  v_lshlrev_b32 v16, 16, v24
  v_and_b32 v17, 0xffff0000, v24
  v_lshlrev_b32 v18, 16, v25
  v_and_b32 v19, 0xffff0000, v25
  v_fma_f32 v36, v36, v13, v16
  v_fma_f32 v37, v37, v13, v17
  v_fma_f32 v38, v38, v13, v18
  v_fma_f32 v39, v39, v13, v19
  v_cvt_pk_bf16_f32 v36, v36, v37
  v_cvt_pk_bf16_f32 v37, v38, v39
  buffer_store_dwordx2 v[36:37], v12, s[12:15], 0 offen offset:32
  s_cmp_eq_u32 s23, 0
  s_cbranch_scc0 p5_kernel_k3_7
  v_add_f32 v40, v40, v60
  v_add_f32 v41, v41, v61
  v_add_f32 v42, v42, v62
  v_add_f32 v43, v43, v63
  v_lshlrev_b32 v16, 16, v26
  v_and_b32 v17, 0xffff0000, v26
  v_lshlrev_b32 v18, 16, v27
  v_and_b32 v19, 0xffff0000, v27
  v_fma_f32 v40, v40, v13, v16
  v_fma_f32 v41, v41, v13, v17
  v_fma_f32 v42, v42, v13, v18
  v_fma_f32 v43, v43, v13, v19
  v_cvt_pk_bf16_f32 v40, v40, v41
  v_cvt_pk_bf16_f32 v41, v42, v43
  buffer_store_dwordx2 v[40:41], v12, s[12:15], 0 offen offset:64
p5_kernel_k3_7:
mega_END:
  s_endpgm
p5_kernel_CODE_END:

sequential_preLN__softmax_full_mha__glu_gated_swiglu__prompt_kernel_CODE_END:
.section .rodata,"a"
.p2align 6
.amdhsa_kernel sequential_preLN__softmax_full_mha__glu_gated_swiglu__prompt_kernel
  .amdhsa_next_free_vgpr 256
  .amdhsa_next_free_sgpr 102
  .amdhsa_accum_offset 256
  .amdhsa_group_segment_fixed_size 0
  .amdhsa_kernarg_size 80
  .amdhsa_user_sgpr_count 2
  .amdhsa_user_sgpr_kernarg_segment_ptr 1
  .amdhsa_system_sgpr_workgroup_id_x 1
  .amdhsa_float_denorm_mode_32 3
.end_amdhsa_kernel
```
